```python
import torch

def _softmax(x, axis=-1):
    return torch.softmax(x, dim=axis)
def _gelu(x):
    return torch.nn.functional.gelu(x, approximate="tanh")
def _silu(x):
    return torch.nn.functional.silu(x)
def _sigmoid(x):
    return torch.sigmoid(x)
def _layernorm(x, axis=-1, eps=1e-5):
    m = x.mean(dim=axis, keepdim=True)
    v = x.var(dim=axis, keepdim=True, unbiased=False)
    return (x - m) / torch.sqrt(v + eps)
def _scatter_add(tgt, idx, src, axis=0):
    return tgt.clone().index_add_(axis, idx, src)
def _segment_sum(src, seg, n):
    out = torch.zeros((n,) + src.shape[1:], dtype=src.dtype)
    return out.index_add_(0, seg, src)
def _pad(x, pw):
    flat = tuple(v for pair in reversed(pw) for v in pair)
    return torch.nn.functional.pad(x, flat)

kernel_name = 'interleave_layers__ssm_conv_h3__glu_gated_geglu__prompt'

def setup_inputs():

    _w = (lambda a: (lambda t: t.to(torch.bfloat16) if t.is_floating_point() else t)(torch.as_tensor(a)))
    def _A_setup():
        B, S, D = 1, 2048, 640
        ks = 4
        return {
            "q": _w((lambda *s: torch.randn(*s, dtype=torch.bfloat16) * 0.05)(B, S, D)),
            "k": _w((lambda *s: torch.randn(*s, dtype=torch.bfloat16) * 0.2)(B, S, D)),
            "v": _w((lambda *s: torch.randn(*s, dtype=torch.bfloat16) * 0.2)(B, S, D)),
            "shift_k": _w((lambda *s: torch.randn(*s, dtype=torch.bfloat16) * 0.2)(D, ks) * 0.5),
            "ssm_k": _w((lambda *s: torch.randn(*s, dtype=torch.bfloat16) * 0.8)(D, S) * (1.0 / S ** 0.5)),
            "ssm_D": _w((lambda *s: torch.randn(*s, dtype=torch.bfloat16) * 0.2)(D)),
        }
    _A_in = _A_setup()

    def _B_setup():
        B, S, Dm, Df = 1, 2048, 640, 1728
        return {
            "x": _w((lambda *s: torch.randn(*s, dtype=torch.bfloat16) * 0.05)(B, S, Dm)),
            "w_gate": _w((lambda *s: torch.randn(*s, dtype=torch.bfloat16) * 0.4)(Dm, Df) * (Dm ** -0.5)),
            "w_up": _w((lambda *s: torch.randn(*s, dtype=torch.bfloat16) * 0.4)(Dm, Df) * (Dm ** -0.5)),
            "w_down": _w((lambda *s: torch.randn(*s, dtype=torch.bfloat16) * 0.4)(Df, Dm) * (Df ** -0.5)),
        }
    _B_in = _B_setup()

    return {
        "A_q": _A_in["q"],
        "A_k": _A_in["k"],
        "A_v": _A_in["v"],
        "A_shift_k": _A_in["shift_k"],
        "A_ssm_k": _A_in["ssm_k"],
        "A_ssm_D": _A_in["ssm_D"],
        "B_x": _B_in["x"],
        "B_w_gate": _B_in["w_gate"],
        "B_w_up": _B_in["w_up"],
        "B_w_down": _B_in["w_down"],
    }

def reference(A_q, A_k, A_v, A_shift_k, A_ssm_k, A_ssm_D, B_x, B_w_gate, B_w_up, B_w_down):
    def _A_ref(q, k, v, shift_k, ssm_k, ssm_D):
        B, S, D = q.shape
        ks = shift_k.shape[-1]
        k_pad = _pad(k, ((0, 0), (ks - 1, 0), (0, 0)))
        k_shift = torch.zeros_like(k)
        for t in range(ks):
            k_shift = k_shift + k_pad[:, t:t + S, :] * shift_k[:, ks - 1 - t][None, None, :]
        kv = k_shift * v
        L = 2 * S
        kv_pad = _pad(kv, ((0, 0), (0, S), (0, 0)))
        kf_pad = _pad(ssm_k, ((0, 0), (0, S)))
        kv_f = (lambda x, axes=(-2,-1): torch.fft.rfft2(x.float(), dim=axes))(kv_pad[:, None, :, :], axes=(1, 2))
        kf_f = (lambda x, axes=(-2,-1): torch.fft.rfft2(x.float(), dim=axes))(kf_pad[:, None, :], axes=(1, 2))
        kf_f = (lambda x, *d: x.permute(*d))(kf_f, 1, 2, 0)
        y_f = kv_f * kf_f[None, :, :, :]
        y = (lambda x, s, axes=(-2,-1): torch.fft.irfft2(x, s=s, dim=axes).to(torch.bfloat16))(y_f, (1, L), axes=(1, 2))[:, 0, :S, :]
        y = y + kv * ssm_D[None, None, :]
        return q * y

    def _B_ref(x, w_gate, w_up, w_down):
        g = torch.einsum("bsd,df->bsf", x, w_gate)
        u = torch.einsum("bsd,df->bsf", x, w_up)
        h = _gelu(g) * u
        return torch.einsum("bsf,fd->bsd", h, w_down)

    x = A_q
    x = x + _A_ref(_layernorm(x, axis=-1), A_k, A_v, A_shift_k, A_ssm_k, A_ssm_D)
    x = x + _B_ref(_layernorm(x, axis=-1), B_w_gate, B_w_up, B_w_down)
    x = x + _A_ref(_layernorm(x, axis=-1), A_k, A_v, A_shift_k, A_ssm_k, A_ssm_D)
    x = x + _B_ref(_layernorm(x, axis=-1), B_w_gate, B_w_up, B_w_down)
    return x
```

```asm
; @launch grid=(256,1,1) block=(256,1,1) lds=163840
.amdgcn_target "amdgcn-amd-amdhsa--gfx950"
.text
.globl interleave_layers__ssm_conv_h3__glu_gated_geglu__prompt_kernel
.p2align 8
.type interleave_layers__ssm_conv_h3__glu_gated_geglu__prompt_kernel,@function
interleave_layers__ssm_conv_h3__glu_gated_geglu__prompt_kernel:
    s_cmp_ge_u32 s2, 256
    s_cbranch_scc1 L_exit
    s_load_dwordx16 s[56:71], s[0:1], 0
    s_load_dwordx8 s[72:79], s[0:1], 64
    s_load_dwordx2 s[4:5], s[0:1], 96
    s_getpc_b64 s[40:41]
L_pc:
    s_lshr_b32 s21, s2, 3
    s_lshl_b32 s22, s21, 4
    v_add_u32 v1, s22, v0
    v_lshlrev_b32 v1, 7, v1
    v_cmp_gt_u32 vcc, L_code_end-L_pc, v1
    v_cmp_gt_u32 s[42:43], 16, v0
    s_and_b64 vcc, vcc, s[42:43]
    s_and_saveexec_b64 s[42:43], vcc
    s_cbranch_execz L_pc_x
    global_load_dword v255, v1, s[40:41]
L_pc_x:
    s_mov_b64 exec, s[42:43]
    v_lshrrev_b32 v1, 6, v0
    s_nop 0
    v_readfirstlane_b32 s20, v1
    s_and_b32 s22, s2, 7
    v_and_b32 v1, 63, v0
    s_mov_b32 s6, 33554432
    s_mov_b32 s7, 0x20000
    s_mov_b32 s10, 33554432
    s_mov_b32 s11, 0x20000
    s_mov_b32 s14, 2621440
    s_mov_b32 s15, 0x20000
    s_mov_b32 s18, 2621440
    s_mov_b32 s19, 0x20000
    s_mov_b32 s54, 19922944
    s_waitcnt lgkmcnt(0)
    s_mov_b64 s[16:17], s[56:57]
    s_mov_b64 s[12:13], s[76:77]
    s_mov_b32 s76, 0x3acccccd
    s_add_u32 s8, s4, 33554432
    s_addc_u32 s9, s5, 0
    s_cmp_ge_u32 s21, 20
    s_cbranch_scc1 L_side
    s_mul_i32 s101, s22, 20
    s_add_u32 s101, s101, s21
    s_and_b32 s24, s101, 15
    s_lshr_b32 s23, s101, 4
    s_lshl_b32 s25, s24, 2
    s_add_u32 s25, s25, s20
    s_lshl_b32 s25, s25, 5
    s_mov_b64 s[32:33], s[58:59]
    s_mov_b32 s34, 0x280000
    s_mov_b32 s35, 0x20000
    s_mov_b64 s[36:37], s[60:61]
    s_mov_b32 s38, 0x280000
    s_mov_b32 s39, 0x20000
    s_mov_b64 s[40:41], s[62:63]
    s_mov_b32 s42, 0x1400
    s_mov_b32 s43, 0x20000
    buffer_load_dword v181, off, s[4:7], s54 sc1
    v_and_b32 v2, 15, v1
    v_lshrrev_b32 v3, 4, v1
    v_lshl_add_u32 v3, v3, 3, s25
    s_lshl_b32 s26, s23, 6
    v_lshl_add_u32 v2, v2, 2, s26
    v_mul_u32_u24 v4, 1280, v3
    v_lshl_add_u32 v4, v2, 1, v4
    v_subrev_u32 v5, 3840, v4
    v_lshlrev_b32 v6, 3, v2
    s_movk_i32 s27, 5120
    buffer_load_dwordx2 v[192:193], v5, s[32:35], 0 offen offset:0
    buffer_load_dwordx2 v[194:195], v5, s[32:35], 0 offen offset:1280
    buffer_load_dwordx2 v[196:197], v5, s[32:35], 0 offen offset:2560
    buffer_load_dwordx4 v[184:187], v6, s[40:43], 0 offen offset:0
    buffer_load_dwordx4 v[188:191], v6, s[40:43], 0 offen offset:16
    buffer_load_dwordx2 v[198:199], v4, s[32:35], 0 offen offset:0
    buffer_load_dwordx2 v[216:217], v4, s[36:39], 0 offen offset:0
    buffer_load_dwordx2 v[200:201], v4, s[32:35], 0 offen offset:1280
    buffer_load_dwordx2 v[218:219], v4, s[36:39], 0 offen offset:1280
    buffer_load_dwordx2 v[202:203], v4, s[32:35], 0 offen offset:2560
    buffer_load_dwordx2 v[220:221], v4, s[36:39], 0 offen offset:2560
    buffer_load_dwordx2 v[204:205], v4, s[32:35], 0 offen offset:3840
    buffer_load_dwordx2 v[222:223], v4, s[36:39], 0 offen offset:3840
    buffer_load_dwordx2 v[206:207], v4, s[32:35], s27 offen offset:0
    buffer_load_dwordx2 v[224:225], v4, s[36:39], s27 offen offset:0
    buffer_load_dwordx2 v[208:209], v4, s[32:35], s27 offen offset:1280
    buffer_load_dwordx2 v[226:227], v4, s[36:39], s27 offen offset:1280
    buffer_load_dwordx2 v[210:211], v4, s[32:35], s27 offen offset:2560
    buffer_load_dwordx2 v[228:229], v4, s[36:39], s27 offen offset:2560
    buffer_load_dwordx2 v[212:213], v4, s[32:35], s27 offen offset:3840
    buffer_load_dwordx2 v[230:231], v4, s[36:39], s27 offen offset:3840
    v_mul_u32_u24 v158, 4224, v2
    v_sub_u32 v3, 2040, v3
    v_lshl_add_u32 v158, v3, 1, v158
    s_lshl_b32 s28, s101, 2
    s_add_u32 s28, s28, s20
    s_lshl_b32 s100, s28, 12
    s_mul_i32 s80, s28, 4224
    s_lshl_b32 s28, s28, 1
    s_mov_b64 s[48:49], s[66:67]
    s_mov_b32 s50, 0x500
    s_mov_b32 s51, 0x20000
    s_mov_b64 s[44:45], s[64:65]
    s_mov_b32 s46, 0x280000
    s_mov_b32 s47, 0x20000
    v_lshlrev_b32 v159, 4, v1
    s_waitcnt vmcnt(16)
    v_lshlrev_b32 v56, 16, v184
    v_and_b32 v60, 0xffff0000, v184
    v_lshlrev_b32 v64, 16, v185
    v_and_b32 v68, 0xffff0000, v185
    v_lshlrev_b32 v57, 16, v186
    v_and_b32 v61, 0xffff0000, v186
    v_lshlrev_b32 v65, 16, v187
    v_and_b32 v69, 0xffff0000, v187
    v_lshlrev_b32 v58, 16, v188
    v_and_b32 v62, 0xffff0000, v188
    v_lshlrev_b32 v66, 16, v189
    v_and_b32 v70, 0xffff0000, v189
    v_lshlrev_b32 v59, 16, v190
    v_and_b32 v63, 0xffff0000, v190
    v_lshlrev_b32 v67, 16, v191
    v_and_b32 v71, 0xffff0000, v191
    v_lshlrev_b32 v72, 16, v192
    v_and_b32 v73, 0xffff0000, v192
    v_lshlrev_b32 v74, 16, v193
    v_and_b32 v75, 0xffff0000, v193
    v_lshlrev_b32 v76, 16, v194
    v_and_b32 v77, 0xffff0000, v194
    v_lshlrev_b32 v78, 16, v195
    v_and_b32 v79, 0xffff0000, v195
    v_lshlrev_b32 v80, 16, v196
    v_and_b32 v81, 0xffff0000, v196
    v_lshlrev_b32 v82, 16, v197
    v_and_b32 v83, 0xffff0000, v197
    s_waitcnt vmcnt(14)
    v_lshlrev_b32 v84, 16, v198
    v_and_b32 v85, 0xffff0000, v198
    v_lshlrev_b32 v86, 16, v199
    v_and_b32 v87, 0xffff0000, v199
    v_lshlrev_b32 v116, 16, v216
    v_and_b32 v117, 0xffff0000, v216
    v_lshlrev_b32 v118, 16, v217
    v_and_b32 v119, 0xffff0000, v217
    v_pk_mul_f32 v[124:125], v[72:73], v[68:69]
    v_pk_fma_f32 v[124:125], v[76:77], v[64:65], v[124:125]
    v_pk_fma_f32 v[124:125], v[80:81], v[60:61], v[124:125]
    v_pk_fma_f32 v[124:125], v[84:85], v[56:57], v[124:125]
    v_pk_mul_f32 v[124:125], v[124:125], v[116:117]
    v_pk_mul_f32 v[126:127], v[74:75], v[70:71]
    v_pk_fma_f32 v[126:127], v[78:79], v[66:67], v[126:127]
    v_pk_fma_f32 v[126:127], v[82:83], v[62:63], v[126:127]
    v_pk_fma_f32 v[126:127], v[86:87], v[58:59], v[126:127]
    v_pk_mul_f32 v[126:127], v[126:127], v[118:119]
    s_waitcnt vmcnt(12)
    v_lshlrev_b32 v88, 16, v200
    v_and_b32 v89, 0xffff0000, v200
    v_lshlrev_b32 v90, 16, v201
    v_and_b32 v91, 0xffff0000, v201
    v_lshlrev_b32 v120, 16, v218
    v_and_b32 v121, 0xffff0000, v218
    v_lshlrev_b32 v122, 16, v219
    v_and_b32 v123, 0xffff0000, v219
    v_pk_mul_f32 v[128:129], v[76:77], v[68:69]
    v_pk_fma_f32 v[128:129], v[80:81], v[64:65], v[128:129]
    v_pk_fma_f32 v[128:129], v[84:85], v[60:61], v[128:129]
    v_pk_fma_f32 v[128:129], v[88:89], v[56:57], v[128:129]
    v_pk_mul_f32 v[128:129], v[128:129], v[120:121]
    v_pk_mul_f32 v[130:131], v[78:79], v[70:71]
    v_pk_fma_f32 v[130:131], v[82:83], v[66:67], v[130:131]
    v_pk_fma_f32 v[130:131], v[86:87], v[62:63], v[130:131]
    v_pk_fma_f32 v[130:131], v[90:91], v[58:59], v[130:131]
    v_pk_mul_f32 v[130:131], v[130:131], v[122:123]
    s_waitcnt vmcnt(10)
    v_lshlrev_b32 v92, 16, v202
    v_and_b32 v93, 0xffff0000, v202
    v_lshlrev_b32 v94, 16, v203
    v_and_b32 v95, 0xffff0000, v203
    v_lshlrev_b32 v116, 16, v220
    v_and_b32 v117, 0xffff0000, v220
    v_lshlrev_b32 v118, 16, v221
    v_and_b32 v119, 0xffff0000, v221
    v_pk_mul_f32 v[132:133], v[80:81], v[68:69]
    v_pk_fma_f32 v[132:133], v[84:85], v[64:65], v[132:133]
    v_pk_fma_f32 v[132:133], v[88:89], v[60:61], v[132:133]
    v_pk_fma_f32 v[132:133], v[92:93], v[56:57], v[132:133]
    v_pk_mul_f32 v[132:133], v[132:133], v[116:117]
    v_pk_mul_f32 v[134:135], v[82:83], v[70:71]
    v_pk_fma_f32 v[134:135], v[86:87], v[66:67], v[134:135]
    v_pk_fma_f32 v[134:135], v[90:91], v[62:63], v[134:135]
    v_pk_fma_f32 v[134:135], v[94:95], v[58:59], v[134:135]
    v_pk_mul_f32 v[134:135], v[134:135], v[118:119]
    s_waitcnt vmcnt(8)
    v_lshlrev_b32 v96, 16, v204
    v_and_b32 v97, 0xffff0000, v204
    v_lshlrev_b32 v98, 16, v205
    v_and_b32 v99, 0xffff0000, v205
    v_lshlrev_b32 v120, 16, v222
    v_and_b32 v121, 0xffff0000, v222
    v_lshlrev_b32 v122, 16, v223
    v_and_b32 v123, 0xffff0000, v223
    v_pk_mul_f32 v[136:137], v[84:85], v[68:69]
    v_pk_fma_f32 v[136:137], v[88:89], v[64:65], v[136:137]
    v_pk_fma_f32 v[136:137], v[92:93], v[60:61], v[136:137]
    v_pk_fma_f32 v[136:137], v[96:97], v[56:57], v[136:137]
    v_pk_mul_f32 v[136:137], v[136:137], v[120:121]
    v_pk_mul_f32 v[138:139], v[86:87], v[70:71]
    v_pk_fma_f32 v[138:139], v[90:91], v[66:67], v[138:139]
    v_pk_fma_f32 v[138:139], v[94:95], v[62:63], v[138:139]
    v_pk_fma_f32 v[138:139], v[98:99], v[58:59], v[138:139]
    v_pk_mul_f32 v[138:139], v[138:139], v[122:123]
    s_waitcnt vmcnt(6)
    v_lshlrev_b32 v100, 16, v206
    v_and_b32 v101, 0xffff0000, v206
    v_lshlrev_b32 v102, 16, v207
    v_and_b32 v103, 0xffff0000, v207
    v_lshlrev_b32 v116, 16, v224
    v_and_b32 v117, 0xffff0000, v224
    v_lshlrev_b32 v118, 16, v225
    v_and_b32 v119, 0xffff0000, v225
    v_pk_mul_f32 v[140:141], v[88:89], v[68:69]
    v_pk_fma_f32 v[140:141], v[92:93], v[64:65], v[140:141]
    v_pk_fma_f32 v[140:141], v[96:97], v[60:61], v[140:141]
    v_pk_fma_f32 v[140:141], v[100:101], v[56:57], v[140:141]
    v_pk_mul_f32 v[140:141], v[140:141], v[116:117]
    v_pk_mul_f32 v[142:143], v[90:91], v[70:71]
    v_pk_fma_f32 v[142:143], v[94:95], v[66:67], v[142:143]
    v_pk_fma_f32 v[142:143], v[98:99], v[62:63], v[142:143]
    v_pk_fma_f32 v[142:143], v[102:103], v[58:59], v[142:143]
    v_pk_mul_f32 v[142:143], v[142:143], v[118:119]
    s_waitcnt vmcnt(4)
    v_lshlrev_b32 v104, 16, v208
    v_and_b32 v105, 0xffff0000, v208
    v_lshlrev_b32 v106, 16, v209
    v_and_b32 v107, 0xffff0000, v209
    v_lshlrev_b32 v120, 16, v226
    v_and_b32 v121, 0xffff0000, v226
    v_lshlrev_b32 v122, 16, v227
    v_and_b32 v123, 0xffff0000, v227
    v_pk_mul_f32 v[144:145], v[92:93], v[68:69]
    v_pk_fma_f32 v[144:145], v[96:97], v[64:65], v[144:145]
    v_pk_fma_f32 v[144:145], v[100:101], v[60:61], v[144:145]
    v_pk_fma_f32 v[144:145], v[104:105], v[56:57], v[144:145]
    v_pk_mul_f32 v[144:145], v[144:145], v[120:121]
    v_pk_mul_f32 v[146:147], v[94:95], v[70:71]
    v_pk_fma_f32 v[146:147], v[98:99], v[66:67], v[146:147]
    v_pk_fma_f32 v[146:147], v[102:103], v[62:63], v[146:147]
    v_pk_fma_f32 v[146:147], v[106:107], v[58:59], v[146:147]
    v_pk_mul_f32 v[146:147], v[146:147], v[122:123]
    s_waitcnt vmcnt(2)
    v_lshlrev_b32 v108, 16, v210
    v_and_b32 v109, 0xffff0000, v210
    v_lshlrev_b32 v110, 16, v211
    v_and_b32 v111, 0xffff0000, v211
    v_lshlrev_b32 v116, 16, v228
    v_and_b32 v117, 0xffff0000, v228
    v_lshlrev_b32 v118, 16, v229
    v_and_b32 v119, 0xffff0000, v229
    v_pk_mul_f32 v[148:149], v[96:97], v[68:69]
    v_pk_fma_f32 v[148:149], v[100:101], v[64:65], v[148:149]
    v_pk_fma_f32 v[148:149], v[104:105], v[60:61], v[148:149]
    v_pk_fma_f32 v[148:149], v[108:109], v[56:57], v[148:149]
    v_pk_mul_f32 v[148:149], v[148:149], v[116:117]
    v_pk_mul_f32 v[150:151], v[98:99], v[70:71]
    v_pk_fma_f32 v[150:151], v[102:103], v[66:67], v[150:151]
    v_pk_fma_f32 v[150:151], v[106:107], v[62:63], v[150:151]
    v_pk_fma_f32 v[150:151], v[110:111], v[58:59], v[150:151]
    v_pk_mul_f32 v[150:151], v[150:151], v[118:119]
    s_waitcnt vmcnt(0)
    v_lshlrev_b32 v112, 16, v212
    v_and_b32 v113, 0xffff0000, v212
    v_lshlrev_b32 v114, 16, v213
    v_and_b32 v115, 0xffff0000, v213
    v_lshlrev_b32 v120, 16, v230
    v_and_b32 v121, 0xffff0000, v230
    v_lshlrev_b32 v122, 16, v231
    v_and_b32 v123, 0xffff0000, v231
    v_pk_mul_f32 v[152:153], v[100:101], v[68:69]
    v_pk_fma_f32 v[152:153], v[104:105], v[64:65], v[152:153]
    v_pk_fma_f32 v[152:153], v[108:109], v[60:61], v[152:153]
    v_pk_fma_f32 v[152:153], v[112:113], v[56:57], v[152:153]
    v_pk_mul_f32 v[152:153], v[152:153], v[120:121]
    v_pk_mul_f32 v[154:155], v[102:103], v[70:71]
    v_pk_fma_f32 v[154:155], v[106:107], v[66:67], v[154:155]
    v_pk_fma_f32 v[154:155], v[110:111], v[62:63], v[154:155]
    v_pk_fma_f32 v[154:155], v[114:115], v[58:59], v[154:155]
    v_pk_mul_f32 v[154:155], v[154:155], v[122:123]
    v_cvt_pk_bf16_f32 v232, v152, v148
    v_cvt_pk_bf16_f32 v233, v144, v140
    v_cvt_pk_bf16_f32 v234, v136, v132
    v_cvt_pk_bf16_f32 v235, v128, v124
    s_mov_b32 s24, 0
    buffer_store_dwordx4 v[232:235], v158, s[4:7], s24 offen sc1
    v_cvt_pk_bf16_f32 v236, v153, v149
    v_cvt_pk_bf16_f32 v237, v145, v141
    v_cvt_pk_bf16_f32 v238, v137, v133
    v_cvt_pk_bf16_f32 v239, v129, v125
    s_mov_b32 s24, 4224
    buffer_store_dwordx4 v[236:239], v158, s[4:7], s24 offen sc1
    v_cvt_pk_bf16_f32 v240, v154, v150
    v_cvt_pk_bf16_f32 v241, v146, v142
    v_cvt_pk_bf16_f32 v242, v138, v134
    v_cvt_pk_bf16_f32 v243, v130, v126
    s_mov_b32 s24, 8448
    buffer_store_dwordx4 v[240:243], v158, s[4:7], s24 offen sc1
    v_cvt_pk_bf16_f32 v244, v155, v151
    v_cvt_pk_bf16_f32 v245, v147, v143
    v_cvt_pk_bf16_f32 v246, v139, v135
    v_cvt_pk_bf16_f32 v247, v131, v127
    s_mov_b32 s24, 12672
    buffer_store_dwordx4 v[244:247], v158, s[4:7], s24 offen sc1
    s_mov_b32 s25, 19923200
    v_readfirstlane_b32 s83, v181
    buffer_load_dword v182, off, s[4:7], s25 offset:0 sc1
    buffer_load_dwordx4 v[160:163], v159, s[44:47], s100 offen offset:0
    buffer_load_dword v176, v159, s[44:47], s100 offen offset:16
    buffer_load_dwordx4 v[164:167], v159, s[44:47], s100 offen offset:1024
    buffer_load_dword v177, v159, s[44:47], s100 offen offset:1040
    buffer_load_dwordx4 v[168:171], v159, s[44:47], s100 offen offset:2048
    buffer_load_dword v178, v159, s[44:47], s100 offen offset:2064
    buffer_load_dwordx4 v[172:175], v159, s[44:47], s100 offen offset:3072
    buffer_load_dword v179, v159, s[44:47], s100 offen offset:3088
    buffer_load_ushort v180, off, s[48:51], s28
    s_add_u32 s83, s83, 1
    s_lshr_b32 s24, s2, 3
    s_and_b32 s22, s2, 1
    s_bfe_u32 s21, s2, 0x20001
    s_lshl_b32 s21, s21, 2
    s_lshr_b32 s25, s24, 3
    s_add_u32 s21, s21, s25
    s_and_b32 s23, s24, 7
    s_lshl_b32 s25, s25, 1
    s_add_u32 s25, s25, s23
    v_lshlrev_b32 v2, 4, v1
    v_lshlrev_b32 v3, 4, v0
    v_and_b32 v60, 15, v1
    v_lshrrev_b32 v61, 4, v1
    s_lshl_b32 s26, s21, 7
    s_lshl_b32 s27, s22, 6
    s_add_u32 s27, s27, s26
    s_lshl_b32 s28, s20, 4
    s_add_u32 s27, s27, s28
    v_add_u32 v62, s27, v60
    v_mul_u32_u24 v17, 1280, v62
    s_mul_i32 s28, s23, 160
    v_lshl_add_u32 v63, v61, 3, s28
    v_add_u32 v17, v17, v63
    s_lshl_b32 s71, s27, 3
    s_add_u32 s71, s71, 17825792
    s_mul_i32 s28, s23, 337920
    s_lshl_b32 s29, s27, 1
    s_add_u32 s28, s28, s29
    s_add_u32 s82, s28, 4194304
    s_lshl_b32 s28, s22, 3
    s_add_u32 s28, s28, s23
    s_mul_i32 s30, s28, 5
    s_lshl_b32 s31, s28, 2
    s_add_u32 s31, s31, 12
    s_min_u32 s30, s30, s31
    s_add_u32 s30, s30, 32
    s_lshl_b32 s77, s28, 11
    s_add_u32 s77, s77, 13631488
    s_lshl_b32 s78, s30, 10
    s_add_u32 s78, s78, 13631488
    s_mul_i32 s42, s28, 81920
    s_add_u32 s42, s42, 8388608
    s_mul_i32 s44, s30, 40960
    s_add_u32 s44, s44, 8388608
    s_lshl_b32 s75, s20, 10
    s_add_u32 s75, s75, 90112
    s_sub_u32 s30, s25, 10
    s_cselect_b32 s30, s25, s30
    s_lshl_b32 s32, s30, 12
    s_add_u32 s33, s32, 4096
    s_cmp_eq_u32 s33, 40960
    s_cselect_b32 s33, 0, s33
    s_add_u32 s34, s33, 4096
    s_cmp_eq_u32 s34, 40960
    s_cselect_b32 s34, 0, s34
    s_add_u32 s35, s34, 4096
    s_cmp_eq_u32 s35, 40960
    s_cselect_b32 s35, 0, s35
    s_add_u32 s36, s35, 4096
    s_cmp_eq_u32 s36, 40960
    s_cselect_b32 s36, 0, s36
    s_add_u32 s37, s36, 4096
    s_cmp_eq_u32 s37, 40960
    s_cselect_b32 s37, 0, s37
    s_add_u32 s38, s37, 4096
    s_cmp_eq_u32 s38, 40960
    s_cselect_b32 s38, 0, s38
    s_add_u32 s39, s38, 4096
    s_cmp_eq_u32 s39, 40960
    s_cselect_b32 s39, 0, s39
    s_add_u32 s40, s39, 4096
    s_cmp_eq_u32 s40, 40960
    s_cselect_b32 s40, 0, s40
    s_add_u32 s41, s40, 4096
    s_cmp_eq_u32 s41, 40960
    s_cselect_b32 s41, 0, s41
    v_add_u32 v4, 65536, v2
    v_add_u32 v5, 131072, v2
    s_lshl_b32 s28, s27, 6
    v_lshl_add_u32 v15, v60, 3, s28
    s_lshl_b32 s28, s23, 7
    v_add_u32 v14, s28, v15
    v_lshl_add_u32 v15, v61, 8, v15
    v_add_u32 v15, 18874368, v15
    v_lshrrev_b32 v63, 1, v61
    v_lshlrev_b32 v63, 5, v63
    v_add_u32 v63, v63, v60
    s_and_b32 s28, s20, 1
    s_lshl_b32 s28, s28, 4
    v_add_u32 v63, s28, v63
    v_lshlrev_b32 v63, 4, v63
    v_and_b32 v66, 1, v61
    v_lshl_add_u32 v13, v66, 10, v63
    s_lshr_b32 s28, s27, 5
    s_mul_i32 s28, s28, 40
    s_mul_i32 s29, s23, 5
    s_add_u32 s28, s28, s29
    s_lshl_b32 s72, s28, 10
    s_lshl_b32 s28, s21, 2
    s_add_u32 s28, s28, s20
    s_mul_i32 s73, s28, 40960
    s_lshl_b32 s70, s28, 11
    s_add_u32 s70, s70, 3145728
    v_lshrrev_b32 v66, 5, v1
    v_bfe_u32 v63, v1, 4, 1
    v_lshlrev_b32 v63, 10, v63
    v_lshl_add_u32 v63, v66, 8, v63
    v_lshl_add_u32 v7, v60, 4, v63
    s_mul_i32 s74, s21, 2048
    s_add_u32 s74, s74, 19939328
    s_and_b32 s3, s2, 7
    s_mul_i32 s3, s3, 256
    s_add_u32 s3, s3, 19935232
    s_mov_b32 s76, 0x3acccccd
    s_lshl_b32 s29, s21, 1
    s_add_u32 s29, s29, s22
    s_mul_i32 s29, s29, 276480
    s_add_u32 s29, s29, 4194304
    s_mul_i32 s28, s23, 276480
    s_add_u32 s28, s28, 14680064
    v_add_u32 v16, s28, v2
    v_add_u32 v12, 4096, v16
    v_add_u32 v47, s73, v2
    s_add_u32 s28, s20, 0
    s_and_b32 s28, s28, 3
    s_lshl_b32 s28, s28, 10
    s_add_u32 s28, s28, s29
    v_add_u32 v8, s28, v2
    s_add_u32 s28, s20, 1
    s_and_b32 s28, s28, 3
    s_lshl_b32 s28, s28, 10
    s_add_u32 s28, s28, s29
    v_add_u32 v9, s28, v2
    s_add_u32 s28, s20, 2
    s_and_b32 s28, s28, 3
    s_lshl_b32 s28, s28, 10
    s_add_u32 s28, s28, s29
    v_add_u32 v10, s28, v2
    s_add_u32 s28, s20, 3
    s_and_b32 s28, s28, 3
    s_lshl_b32 s28, s28, 10
    s_add_u32 s28, s28, s29
    v_add_u32 v11, s28, v2
    s_lshl_b32 s28, s22, 3
    s_add_u32 s28, s28, s23
    s_lshl_b32 s30, s28, 1
    s_add_u32 s31, s28, 12
    s_min_u32 s30, s30, s31
    s_lshl_b32 s31, s21, 1
    s_lshr_b32 s26, s20, 1
    s_add_u32 s26, s26, s31
    s_mul_i32 s26, s26, 276480
    s_and_b32 s24, s20, 1
    s_lshl_b32 s24, s24, 11
    s_add_u32 s26, s26, s24
    s_add_u32 s26, s26, 4194304
    s_add_u32 s43, s42, 40960
    s_add_u32 s45, s44, 40960
    s_add_u32 s46, s45, 40960
    s_add_u32 s47, s46, 40960
    s_add_u32 s48, s47, 40960
    s_mul_i32 s24, s28, 3
    s_add_u32 s24, s24, 0
    s_and_b32 s29, s24, 1
    s_lshl_b32 s29, s29, 9
    s_lshr_b32 s24, s24, 1
    s_mul_i32 s24, s24, 5120
    s_add_u32 s24, s24, s29
    s_add_u32 s49, s24, s26
    s_mul_i32 s24, s28, 3
    s_add_u32 s24, s24, 1
    s_and_b32 s29, s24, 1
    s_lshl_b32 s29, s29, 9
    s_lshr_b32 s24, s24, 1
    s_mul_i32 s24, s24, 5120
    s_add_u32 s24, s24, s29
    s_add_u32 s50, s24, s26
    s_mul_i32 s24, s28, 3
    s_add_u32 s24, s24, 2
    s_and_b32 s29, s24, 1
    s_lshl_b32 s29, s29, 9
    s_lshr_b32 s24, s24, 1
    s_mul_i32 s24, s24, 5120
    s_add_u32 s24, s24, s29
    s_add_u32 s51, s24, s26
    s_lshl_b32 s24, s28, 1
    s_add_u32 s24, s24, 48
    s_and_b32 s29, s24, 1
    s_lshl_b32 s29, s29, 9
    s_lshr_b32 s24, s24, 1
    s_mul_i32 s24, s24, 5120
    s_add_u32 s24, s24, s29
    s_add_u32 s52, s24, s26
    s_lshl_b32 s24, s28, 1
    s_add_u32 s24, s24, 49
    s_and_b32 s29, s24, 1
    s_lshl_b32 s29, s29, 9
    s_lshr_b32 s24, s24, 1
    s_mul_i32 s24, s24, 5120
    s_add_u32 s24, s24, s29
    s_add_u32 s53, s24, s26
    s_add_u32 s24, s30, 80
    s_and_b32 s29, s24, 1
    s_lshl_b32 s29, s29, 9
    s_lshr_b32 s24, s24, 1
    s_mul_i32 s24, s24, 5120
    s_add_u32 s24, s24, s29
    s_add_u32 s54, s24, s26
    s_add_u32 s24, s30, 81
    s_and_b32 s29, s24, 1
    s_lshl_b32 s29, s29, 9
    s_lshr_b32 s24, s24, 1
    s_mul_i32 s24, s24, 5120
    s_add_u32 s24, s24, s29
    s_add_u32 s55, s24, s26
    s_cmp_ge_u32 s28, 12
    s_cselect_b32 s48, 134217728, s48
    s_cselect_b32 s55, 134217728, s55
    s_mul_i32 s24, s25, 43
    s_lshr_b32 s24, s24, 8
    s_mul_i32 s24, s24, 6
    s_sub_u32 s24, s25, s24
    s_mul_i32 s26, s20, 6
    s_add_u32 s29, s24, s26
    s_mul_i32 s56, s29, 5120
    s_add_u32 s24, s24, 1
    s_cmp_eq_u32 s24, 6
    s_cselect_b32 s24, 0, s24
    s_add_u32 s29, s24, s26
    s_mul_i32 s57, s29, 5120
    s_add_u32 s24, s24, 1
    s_cmp_eq_u32 s24, 6
    s_cselect_b32 s24, 0, s24
    s_add_u32 s29, s24, s26
    s_mul_i32 s58, s29, 5120
    s_add_u32 s24, s24, 1
    s_cmp_eq_u32 s24, 6
    s_cselect_b32 s24, 0, s24
    s_add_u32 s29, s24, s26
    s_mul_i32 s59, s29, 5120
    s_add_u32 s24, s24, 1
    s_cmp_eq_u32 s24, 6
    s_cselect_b32 s24, 0, s24
    s_add_u32 s29, s24, s26
    s_mul_i32 s60, s29, 5120
    s_add_u32 s24, s24, 1
    s_cmp_eq_u32 s24, 6
    s_cselect_b32 s24, 0, s24
    s_add_u32 s29, s24, s26
    s_mul_i32 s61, s29, 5120
    s_add_u32 s24, s24, 1
    s_cmp_eq_u32 s24, 6
    s_cselect_b32 s24, 0, s24
    s_lshl_b32 s26, s20, 2
    s_add_u32 s26, s26, 24
    s_add_u32 s24, s25, 0
    s_and_b32 s24, s24, 3
    s_add_u32 s24, s24, s26
    s_mul_i32 s62, s24, 5120
    s_add_u32 s24, s25, 1
    s_and_b32 s24, s24, 3
    s_add_u32 s24, s24, s26
    s_mul_i32 s63, s24, 5120
    s_add_u32 s24, s25, 2
    s_and_b32 s24, s24, 3
    s_add_u32 s24, s24, s26
    s_mul_i32 s64, s24, 5120
    s_add_u32 s24, s25, 3
    s_and_b32 s24, s24, 3
    s_add_u32 s24, s24, s26
    s_mul_i32 s65, s24, 5120
    s_lshl_b32 s24, s20, 2
    s_min_u32 s24, s24, 11
    s_add_u32 s24, s24, 40
    s_mul_i32 s66, s24, 5120
    s_add_u32 s67, s66, 5120
    s_add_u32 s68, s67, 5120
    s_add_u32 s69, s68, 5120
    s_cmp_ge_u32 s20, 2
    s_cselect_b32 s69, 134217728, s69
    s_mov_b32 s25, 19923200
    v_mov_b32 v18, 1
    v_mul_u32_u24 v6, 256, v1
    s_waitcnt vmcnt(9)
    v_readfirstlane_b32 s24, v182
    s_cmp_eq_u32 s24, s83
    s_cbranch_scc0 L_slow_1
L_ok_2:
    s_barrier
    s_lshr_b32 s25, s101, 4
    s_mul_i32 s25, s25, 256
    s_add_u32 s25, s25, 19927040
    s_cmp_lg_u32 s20, 0
    s_cbranch_scc1 L_sig_3
    s_mov_b64 exec, 1
    buffer_atomic_add v18, off, s[4:7], s25 offset:0 sc1
    s_mov_b64 exec, -1
L_sig_3:
    s_mul_i32 s31, s20, 13312
    s_add_u32 s31, s31, 90112
    v_add_u32 v26, s31, v2
    v_mov_b32 v188, 0
    v_mov_b32 v189, 0
    v_mov_b32 v190, 0
    v_mov_b32 v191, 0
    s_mov_b64 exec, 0x3fffffff
    ds_write_b128 v26, v[188:191] offset:12416
    s_mov_b64 exec, 3
    ds_write_b128 v26, v[188:191]
    s_mov_b64 exec, -1
    s_waitcnt vmcnt(7)
    v_readfirstlane_b32 s30, v160
    ds_write_b128 v26, v[160:163] offset:32
    v_alignbit_b32 v192, v161, v160, 16
    v_alignbit_b32 v193, v162, v161, 16
    v_alignbit_b32 v194, v163, v162, 16
    v_alignbit_b32 v195, v176, v163, 16
    ds_write_b128 v26, v[192:195] offset:4192
    s_waitcnt vmcnt(5)
    ds_write_b128 v26, v[164:167] offset:1056
    v_alignbit_b32 v196, v165, v164, 16
    v_alignbit_b32 v197, v166, v165, 16
    v_alignbit_b32 v198, v167, v166, 16
    v_alignbit_b32 v199, v177, v167, 16
    ds_write_b128 v26, v[196:199] offset:5216
    s_waitcnt vmcnt(3)
    ds_write_b128 v26, v[168:171] offset:2080
    v_alignbit_b32 v192, v169, v168, 16
    v_alignbit_b32 v193, v170, v169, 16
    v_alignbit_b32 v194, v171, v170, 16
    v_alignbit_b32 v195, v178, v171, 16
    ds_write_b128 v26, v[192:195] offset:6240
    s_waitcnt vmcnt(1)
    ds_write_b128 v26, v[172:175] offset:3104
    v_alignbit_b32 v196, v173, v172, 16
    v_alignbit_b32 v197, v174, v173, 16
    v_alignbit_b32 v198, v175, v174, 16
    v_alignbit_b32 v199, v179, v175, 16
    ds_write_b128 v26, v[196:199] offset:7264
    s_waitcnt vmcnt(0)
    s_lshl_b32 s30, s30, 16
    v_cmp_eq_u32 vcc, 1, v1
    v_mov_b32 v181, s30
    s_nop 0
    v_cndmask_b32 v191, 0, v181, vcc
    s_mov_b64 exec, 3
    ds_write_b128 v26, v[188:191] offset:4160
    s_mov_b64 exec, -1
    v_and_b32 v181, 15, v1
    v_lshrrev_b32 v182, 4, v1
    v_lshl_add_u32 v183, v182, 3, v181
    v_sub_u32 v184, 15, v183
    v_lshlrev_b32 v156, 16, v180
    v_cmp_eq_u32 vcc, 0, v184
    s_nop 1
    v_cndmask_b32 v40, 0, v180, vcc
    v_cmp_eq_u32 vcc, 1, v184
    s_nop 1
    v_cndmask_b32 v40, v40, v156, vcc
    v_cmp_eq_u32 vcc, 2, v184
    s_nop 1
    v_cndmask_b32 v41, 0, v180, vcc
    v_cmp_eq_u32 vcc, 3, v184
    s_nop 1
    v_cndmask_b32 v41, v41, v156, vcc
    v_cmp_eq_u32 vcc, 4, v184
    s_nop 1
    v_cndmask_b32 v42, 0, v180, vcc
    v_cmp_eq_u32 vcc, 5, v184
    s_nop 1
    v_cndmask_b32 v42, v42, v156, vcc
    v_cmp_eq_u32 vcc, 6, v184
    s_nop 1
    v_cndmask_b32 v43, 0, v180, vcc
    v_cmp_eq_u32 vcc, 7, v184
    s_nop 1
    v_cndmask_b32 v43, v43, v156, vcc
    v_add_u32 v20, 1, v183
    v_and_b32 v21, 1, v20
    v_lshrrev_b32 v20, 1, v20
    v_lshlrev_b32 v20, 2, v20
    v_mul_u32_u24 v21, 4160, v21
    v_add3_u32 v20, v20, v21, s31
    v_add_u32 v21, 1024, v20
    v_add_u32 v22, 2048, v20
    v_add_u32 v23, 3072, v20
    v_lshlrev_b32 v24, 4, v182
    v_lshlrev_b32 v156, 5, v181
    v_sub_u32 v24, v24, v156
    s_add_u32 s30, s31, 8800
    v_add_u32 v24, s30, v24
    v_lshrrev_b32 v25, 1, v182
    v_lshl_add_u32 v25, v25, 4, v156
    v_and_b32 v182, 1, v182
    v_lshl_add_u32 v25, v182, 9, v25
    v_add_u32 v25, 4194304, v25
    s_lshr_b32 s25, s101, 4
    s_mul_i32 s25, s25, 256
    s_add_u32 s25, s25, 19927040
    s_cmp_lg_u32 s20, 0
    s_cbranch_scc1 L_got_4
    s_movk_i32 s79, 30000
L_spin_5:
    buffer_load_dword v19, off, s[4:7], s25 offset:0 sc1
    s_waitcnt vmcnt(0)
    v_readfirstlane_b32 s24, v19
    s_cmp_ge_u32 s24, 16
    s_cbranch_scc1 L_got_4
    s_sub_u32 s79, s79, 1
    s_cbranch_scc0 L_spin_5
    s_branch L_got_4
L_got_4:
    s_barrier
    buffer_load_dwordx4 v[104:107], v2, s[4:7], s80 offen offset:0 sc1
    buffer_load_dwordx4 v[108:111], v2, s[4:7], s80 offen offset:1024 sc1
    buffer_load_dwordx4 v[112:115], v2, s[4:7], s80 offen offset:2048 sc1
    buffer_load_dwordx4 v[116:119], v2, s[4:7], s80 offen offset:3072 sc1
    s_waitcnt lgkmcnt(0)
    ds_read2_b32 a[0:1], v20 offset0:0 offset1:1
    ds_read2_b32 a[2:3], v20 offset0:2 offset1:3
    ds_read2_b32 a[4:5], v20 offset0:128 offset1:129
    ds_read2_b32 a[6:7], v20 offset0:130 offset1:131
    ds_read2_b32 a[8:9], v21 offset0:0 offset1:1
    ds_read2_b32 a[10:11], v21 offset0:2 offset1:3
    ds_read2_b32 a[12:13], v21 offset0:128 offset1:129
    ds_read2_b32 a[14:15], v21 offset0:130 offset1:131
    ds_read2_b32 a[16:17], v22 offset0:0 offset1:1
    ds_read2_b32 a[18:19], v22 offset0:2 offset1:3
    ds_read2_b32 a[20:21], v22 offset0:128 offset1:129
    ds_read2_b32 a[22:23], v22 offset0:130 offset1:131
    ds_read2_b32 a[24:25], v23 offset0:0 offset1:1
    ds_read2_b32 a[26:27], v23 offset0:2 offset1:3
    ds_read2_b32 a[28:29], v23 offset0:128 offset1:129
    ds_read2_b32 a[30:31], v23 offset0:130 offset1:131
    s_waitcnt vmcnt(3)
    ds_write_b128 v26, v[104:107] offset:8320
    s_waitcnt vmcnt(2)
    ds_write_b128 v26, v[108:111] offset:9344
    s_waitcnt vmcnt(1)
    ds_write_b128 v26, v[112:115] offset:10368
    s_waitcnt vmcnt(0)
    ds_write_b128 v26, v[116:119] offset:11392
    s_waitcnt lgkmcnt(0)
    ds_read_b128 a[32:35], v24 offset:3584
    ds_read_b128 a[36:39], v24 offset:3072
    ds_read_b128 a[40:43], v24 offset:2560
    ds_read_b128 a[44:47], v24 offset:2048
    ds_read_b128 a[48:51], v24 offset:1536
    ds_read_b128 a[52:55], v24 offset:1024
    ds_read_b128 a[56:59], v24 offset:512
    ds_read_b128 a[60:63], v24 offset:0
    s_waitcnt lgkmcnt(0)
    v_mfma_f32_16x16x32_bf16 v[72:75], v[40:43], a[32:35], 0
    v_mfma_f32_16x16x32_bf16 v[76:79], v[40:43], a[36:39], 0
    v_mfma_f32_16x16x32_bf16 v[80:83], v[40:43], a[40:43], 0
    v_mfma_f32_16x16x32_bf16 v[84:87], v[40:43], a[44:47], 0
    v_mfma_f32_16x16x32_bf16 v[88:91], v[40:43], a[48:51], 0
    v_mfma_f32_16x16x32_bf16 v[92:95], v[40:43], a[52:55], 0
    v_mfma_f32_16x16x32_bf16 v[96:99], v[40:43], a[56:59], 0
    v_mfma_f32_16x16x32_bf16 v[100:103], v[40:43], a[60:63], 0
    v_mfma_f32_16x16x32_bf16 v[72:75], a[0:3], a[32:35], v[72:75]
    ds_read_b128 a[96:99], v24 offset:3648
    v_mfma_f32_16x16x32_bf16 v[76:79], a[0:3], a[36:39], v[76:79]
    ds_read2_b32 a[64:65], v20 offset0:16 offset1:17
    v_mfma_f32_16x16x32_bf16 v[80:83], a[0:3], a[40:43], v[80:83]
    ds_read2_b32 a[66:67], v20 offset0:18 offset1:19
    buffer_load_dwordx2 v[30:31], v17, s[16:19], 0 offen offset:0
    v_mfma_f32_16x16x32_bf16 v[84:87], a[0:3], a[44:47], v[84:87]
    ds_read_b128 a[100:103], v24 offset:3136
    v_mfma_f32_16x16x32_bf16 v[88:91], a[0:3], a[48:51], v[88:91]
    ds_read2_b32 a[68:69], v20 offset0:144 offset1:145
    v_mfma_f32_16x16x32_bf16 v[92:95], a[0:3], a[52:55], v[92:95]
    ds_read2_b32 a[70:71], v20 offset0:146 offset1:147
    v_mfma_f32_16x16x32_bf16 v[96:99], a[0:3], a[56:59], v[96:99]
    ds_read_b128 a[104:107], v24 offset:2624
    v_mfma_f32_16x16x32_bf16 v[100:103], a[0:3], a[60:63], v[100:103]
    ds_read2_b32 a[72:73], v21 offset0:16 offset1:17
    v_mfma_f32_16x16x32_bf16 v[76:79], a[4:7], a[32:35], v[76:79]
    buffer_load_dwordx2 v[32:33], v17, s[16:19], 0 offen offset:32
    ds_read2_b32 a[74:75], v21 offset0:18 offset1:19
    v_mfma_f32_16x16x32_bf16 v[80:83], a[4:7], a[36:39], v[80:83]
    ds_read_b128 a[108:111], v24 offset:2112
    v_mfma_f32_16x16x32_bf16 v[84:87], a[4:7], a[40:43], v[84:87]
    ds_read2_b32 a[76:77], v21 offset0:144 offset1:145
    v_mfma_f32_16x16x32_bf16 v[88:91], a[4:7], a[44:47], v[88:91]
    ds_read2_b32 a[78:79], v21 offset0:146 offset1:147
    v_mfma_f32_16x16x32_bf16 v[92:95], a[4:7], a[48:51], v[92:95]
    ds_read_b128 a[112:115], v24 offset:1600
    v_mfma_f32_16x16x32_bf16 v[96:99], a[4:7], a[52:55], v[96:99]
    buffer_load_dwordx2 v[34:35], v17, s[16:19], 0 offen offset:64
    ds_read2_b32 a[80:81], v22 offset0:16 offset1:17
    v_mfma_f32_16x16x32_bf16 v[100:103], a[4:7], a[56:59], v[100:103]
    v_mfma_f32_16x16x32_bf16 v[80:83], a[8:11], a[32:35], v[80:83]
    ds_read2_b32 a[82:83], v22 offset0:18 offset1:19
    v_mfma_f32_16x16x32_bf16 v[84:87], a[8:11], a[36:39], v[84:87]
    ds_read_b128 a[116:119], v24 offset:1088
    v_mfma_f32_16x16x32_bf16 v[88:91], a[8:11], a[40:43], v[88:91]
    ds_read2_b32 a[84:85], v22 offset0:144 offset1:145
    v_mfma_f32_16x16x32_bf16 v[92:95], a[8:11], a[44:47], v[92:95]
    ds_read2_b32 a[86:87], v22 offset0:146 offset1:147
    v_mfma_f32_16x16x32_bf16 v[96:99], a[8:11], a[48:51], v[96:99]
    buffer_load_dwordx2 v[36:37], v17, s[16:19], 0 offen offset:96
    ds_read_b128 a[120:123], v24 offset:576
    v_mfma_f32_16x16x32_bf16 v[100:103], a[8:11], a[52:55], v[100:103]
    ds_read2_b32 a[88:89], v23 offset0:16 offset1:17
    v_mfma_f32_16x16x32_bf16 v[84:87], a[12:15], a[32:35], v[84:87]
    ds_read2_b32 a[90:91], v23 offset0:18 offset1:19
    v_mfma_f32_16x16x32_bf16 v[88:91], a[12:15], a[36:39], v[88:91]
    ds_read_b128 a[124:127], v24 offset:64
    v_mfma_f32_16x16x32_bf16 v[92:95], a[12:15], a[40:43], v[92:95]
    ds_read2_b32 a[92:93], v23 offset0:144 offset1:145
    v_mfma_f32_16x16x32_bf16 v[96:99], a[12:15], a[44:47], v[96:99]
    buffer_load_dwordx2 v[38:39], v17, s[16:19], 0 offen offset:128
    ds_read2_b32 a[94:95], v23 offset0:146 offset1:147
    v_mfma_f32_16x16x32_bf16 v[100:103], a[12:15], a[48:51], v[100:103]
    v_add_u32 v20, 128, v20
    v_mfma_f32_16x16x32_bf16 v[88:91], a[16:19], a[32:35], v[88:91]
    v_add_u32 v21, 128, v21
    v_mfma_f32_16x16x32_bf16 v[92:95], a[16:19], a[36:39], v[92:95]
    v_add_u32 v22, 128, v22
    v_mfma_f32_16x16x32_bf16 v[96:99], a[16:19], a[40:43], v[96:99]
    v_add_u32 v23, 128, v23
    v_mfma_f32_16x16x32_bf16 v[100:103], a[16:19], a[44:47], v[100:103]
    v_mfma_f32_16x16x32_bf16 v[92:95], a[20:23], a[32:35], v[92:95]
    v_mfma_f32_16x16x32_bf16 v[96:99], a[20:23], a[36:39], v[96:99]
    v_mfma_f32_16x16x32_bf16 v[100:103], a[20:23], a[40:43], v[100:103]
    v_mfma_f32_16x16x32_bf16 v[96:99], a[24:27], a[32:35], v[96:99]
    v_mfma_f32_16x16x32_bf16 v[100:103], a[24:27], a[36:39], v[100:103]
    v_mfma_f32_16x16x32_bf16 v[100:103], a[28:31], a[32:35], v[100:103]
    s_waitcnt lgkmcnt(0)
    v_mfma_f32_16x16x32_bf16 v[72:75], a[64:67], a[96:99], v[72:75]
    ds_read_b128 a[32:35], v24 offset:3712
    v_mfma_f32_16x16x32_bf16 v[76:79], a[64:67], a[100:103], v[76:79]
    ds_read2_b32 a[0:1], v20 offset0:0 offset1:1
    v_mfma_f32_16x16x32_bf16 v[80:83], a[64:67], a[104:107], v[80:83]
    ds_read2_b32 a[2:3], v20 offset0:2 offset1:3
    v_mfma_f32_16x16x32_bf16 v[84:87], a[64:67], a[108:111], v[84:87]
    ds_read_b128 a[36:39], v24 offset:3200
    v_mfma_f32_16x16x32_bf16 v[88:91], a[64:67], a[112:115], v[88:91]
    v_mfma_f32_16x16x32_bf16 v[92:95], a[64:67], a[116:119], v[92:95]
    ds_read2_b32 a[4:5], v20 offset0:128 offset1:129
    v_mfma_f32_16x16x32_bf16 v[96:99], a[64:67], a[120:123], v[96:99]
    ds_read2_b32 a[6:7], v20 offset0:130 offset1:131
    v_mfma_f32_16x16x32_bf16 v[100:103], a[64:67], a[124:127], v[100:103]
    ds_read_b128 a[40:43], v24 offset:2688
    v_mfma_f32_16x16x32_bf16 v[76:79], a[68:71], a[96:99], v[76:79]
    ds_read2_b32 a[8:9], v21 offset0:0 offset1:1
    v_mfma_f32_16x16x32_bf16 v[80:83], a[68:71], a[100:103], v[80:83]
    v_mfma_f32_16x16x32_bf16 v[84:87], a[68:71], a[104:107], v[84:87]
    ds_read2_b32 a[10:11], v21 offset0:2 offset1:3
    v_mfma_f32_16x16x32_bf16 v[88:91], a[68:71], a[108:111], v[88:91]
    ds_read_b128 a[44:47], v24 offset:2176
    v_mfma_f32_16x16x32_bf16 v[92:95], a[68:71], a[112:115], v[92:95]
    ds_read2_b32 a[12:13], v21 offset0:128 offset1:129
    v_mfma_f32_16x16x32_bf16 v[96:99], a[68:71], a[116:119], v[96:99]
    ds_read2_b32 a[14:15], v21 offset0:130 offset1:131
    v_mfma_f32_16x16x32_bf16 v[100:103], a[68:71], a[120:123], v[100:103]
    v_mfma_f32_16x16x32_bf16 v[80:83], a[72:75], a[96:99], v[80:83]
    ds_read_b128 a[48:51], v24 offset:1664
    v_mfma_f32_16x16x32_bf16 v[84:87], a[72:75], a[100:103], v[84:87]
    ds_read2_b32 a[16:17], v22 offset0:0 offset1:1
    v_mfma_f32_16x16x32_bf16 v[88:91], a[72:75], a[104:107], v[88:91]
    ds_read2_b32 a[18:19], v22 offset0:2 offset1:3
    v_mfma_f32_16x16x32_bf16 v[92:95], a[72:75], a[108:111], v[92:95]
    ds_read_b128 a[52:55], v24 offset:1152
    v_mfma_f32_16x16x32_bf16 v[96:99], a[72:75], a[112:115], v[96:99]
    v_mfma_f32_16x16x32_bf16 v[100:103], a[72:75], a[116:119], v[100:103]
    ds_read2_b32 a[20:21], v22 offset0:128 offset1:129
    v_mfma_f32_16x16x32_bf16 v[84:87], a[76:79], a[96:99], v[84:87]
    ds_read2_b32 a[22:23], v22 offset0:130 offset1:131
    v_mfma_f32_16x16x32_bf16 v[88:91], a[76:79], a[100:103], v[88:91]
    ds_read_b128 a[56:59], v24 offset:640
    v_mfma_f32_16x16x32_bf16 v[92:95], a[76:79], a[104:107], v[92:95]
    ds_read2_b32 a[24:25], v23 offset0:0 offset1:1
    v_mfma_f32_16x16x32_bf16 v[96:99], a[76:79], a[108:111], v[96:99]
    v_mfma_f32_16x16x32_bf16 v[100:103], a[76:79], a[112:115], v[100:103]
    ds_read2_b32 a[26:27], v23 offset0:2 offset1:3
    v_mfma_f32_16x16x32_bf16 v[88:91], a[80:83], a[96:99], v[88:91]
    ds_read_b128 a[60:63], v24 offset:128
    v_mfma_f32_16x16x32_bf16 v[92:95], a[80:83], a[100:103], v[92:95]
    ds_read2_b32 a[28:29], v23 offset0:128 offset1:129
    v_mfma_f32_16x16x32_bf16 v[96:99], a[80:83], a[104:107], v[96:99]
    ds_read2_b32 a[30:31], v23 offset0:130 offset1:131
    v_mfma_f32_16x16x32_bf16 v[100:103], a[80:83], a[108:111], v[100:103]
    v_mfma_f32_16x16x32_bf16 v[92:95], a[84:87], a[96:99], v[92:95]
    v_mfma_f32_16x16x32_bf16 v[96:99], a[84:87], a[100:103], v[96:99]
    v_mfma_f32_16x16x32_bf16 v[100:103], a[84:87], a[104:107], v[100:103]
    v_mfma_f32_16x16x32_bf16 v[96:99], a[88:91], a[96:99], v[96:99]
    v_mfma_f32_16x16x32_bf16 v[100:103], a[88:91], a[100:103], v[100:103]
    v_mfma_f32_16x16x32_bf16 v[100:103], a[92:95], a[96:99], v[100:103]
    s_waitcnt lgkmcnt(0)
    v_mfma_f32_16x16x32_bf16 v[72:75], a[0:3], a[32:35], v[72:75]
    ds_read_b128 a[96:99], v24 offset:3776
    v_mfma_f32_16x16x32_bf16 v[76:79], a[0:3], a[36:39], v[76:79]
    ds_read2_b32 a[64:65], v20 offset0:16 offset1:17
    v_mfma_f32_16x16x32_bf16 v[80:83], a[0:3], a[40:43], v[80:83]
    ds_read2_b32 a[66:67], v20 offset0:18 offset1:19
    v_mfma_f32_16x16x32_bf16 v[84:87], a[0:3], a[44:47], v[84:87]
    ds_read_b128 a[100:103], v24 offset:3264
    v_mfma_f32_16x16x32_bf16 v[88:91], a[0:3], a[48:51], v[88:91]
    ds_read2_b32 a[68:69], v20 offset0:144 offset1:145
    v_mfma_f32_16x16x32_bf16 v[92:95], a[0:3], a[52:55], v[92:95]
    ds_read2_b32 a[70:71], v20 offset0:146 offset1:147
    v_mfma_f32_16x16x32_bf16 v[96:99], a[0:3], a[56:59], v[96:99]
    ds_read_b128 a[104:107], v24 offset:2752
    v_mfma_f32_16x16x32_bf16 v[100:103], a[0:3], a[60:63], v[100:103]
    ds_read2_b32 a[72:73], v21 offset0:16 offset1:17
    v_mfma_f32_16x16x32_bf16 v[76:79], a[4:7], a[32:35], v[76:79]
    ds_read2_b32 a[74:75], v21 offset0:18 offset1:19
    v_mfma_f32_16x16x32_bf16 v[80:83], a[4:7], a[36:39], v[80:83]
    ds_read_b128 a[108:111], v24 offset:2240
    v_mfma_f32_16x16x32_bf16 v[84:87], a[4:7], a[40:43], v[84:87]
    ds_read2_b32 a[76:77], v21 offset0:144 offset1:145
    v_mfma_f32_16x16x32_bf16 v[88:91], a[4:7], a[44:47], v[88:91]
    ds_read2_b32 a[78:79], v21 offset0:146 offset1:147
    v_mfma_f32_16x16x32_bf16 v[92:95], a[4:7], a[48:51], v[92:95]
    ds_read_b128 a[112:115], v24 offset:1728
    v_mfma_f32_16x16x32_bf16 v[96:99], a[4:7], a[52:55], v[96:99]
    ds_read2_b32 a[80:81], v22 offset0:16 offset1:17
    v_mfma_f32_16x16x32_bf16 v[100:103], a[4:7], a[56:59], v[100:103]
    v_mfma_f32_16x16x32_bf16 v[80:83], a[8:11], a[32:35], v[80:83]
    ds_read2_b32 a[82:83], v22 offset0:18 offset1:19
    v_mfma_f32_16x16x32_bf16 v[84:87], a[8:11], a[36:39], v[84:87]
    ds_read_b128 a[116:119], v24 offset:1216
    v_mfma_f32_16x16x32_bf16 v[88:91], a[8:11], a[40:43], v[88:91]
    ds_read2_b32 a[84:85], v22 offset0:144 offset1:145
    v_mfma_f32_16x16x32_bf16 v[92:95], a[8:11], a[44:47], v[92:95]
    ds_read2_b32 a[86:87], v22 offset0:146 offset1:147
    v_mfma_f32_16x16x32_bf16 v[96:99], a[8:11], a[48:51], v[96:99]
    ds_read_b128 a[120:123], v24 offset:704
    v_mfma_f32_16x16x32_bf16 v[100:103], a[8:11], a[52:55], v[100:103]
    ds_read2_b32 a[88:89], v23 offset0:16 offset1:17
    v_mfma_f32_16x16x32_bf16 v[84:87], a[12:15], a[32:35], v[84:87]
    ds_read2_b32 a[90:91], v23 offset0:18 offset1:19
    v_mfma_f32_16x16x32_bf16 v[88:91], a[12:15], a[36:39], v[88:91]
    ds_read_b128 a[124:127], v24 offset:192
    v_mfma_f32_16x16x32_bf16 v[92:95], a[12:15], a[40:43], v[92:95]
    ds_read2_b32 a[92:93], v23 offset0:144 offset1:145
    v_mfma_f32_16x16x32_bf16 v[96:99], a[12:15], a[44:47], v[96:99]
    ds_read2_b32 a[94:95], v23 offset0:146 offset1:147
    v_mfma_f32_16x16x32_bf16 v[100:103], a[12:15], a[48:51], v[100:103]
    v_add_u32 v20, 128, v20
    v_mfma_f32_16x16x32_bf16 v[88:91], a[16:19], a[32:35], v[88:91]
    v_add_u32 v21, 128, v21
    v_mfma_f32_16x16x32_bf16 v[92:95], a[16:19], a[36:39], v[92:95]
    v_add_u32 v22, 128, v22
    v_mfma_f32_16x16x32_bf16 v[96:99], a[16:19], a[40:43], v[96:99]
    v_add_u32 v23, 128, v23
    v_mfma_f32_16x16x32_bf16 v[100:103], a[16:19], a[44:47], v[100:103]
    v_mfma_f32_16x16x32_bf16 v[92:95], a[20:23], a[32:35], v[92:95]
    v_mfma_f32_16x16x32_bf16 v[96:99], a[20:23], a[36:39], v[96:99]
    v_mfma_f32_16x16x32_bf16 v[100:103], a[20:23], a[40:43], v[100:103]
    v_mfma_f32_16x16x32_bf16 v[96:99], a[24:27], a[32:35], v[96:99]
    v_mfma_f32_16x16x32_bf16 v[100:103], a[24:27], a[36:39], v[100:103]
    v_mfma_f32_16x16x32_bf16 v[100:103], a[28:31], a[32:35], v[100:103]
    s_waitcnt lgkmcnt(0)
    v_mfma_f32_16x16x32_bf16 v[72:75], a[64:67], a[96:99], v[72:75]
    ds_read_b128 a[32:35], v24 offset:3840
    v_mfma_f32_16x16x32_bf16 v[76:79], a[64:67], a[100:103], v[76:79]
    ds_read2_b32 a[0:1], v20 offset0:0 offset1:1
    v_mfma_f32_16x16x32_bf16 v[80:83], a[64:67], a[104:107], v[80:83]
    ds_read2_b32 a[2:3], v20 offset0:2 offset1:3
    v_mfma_f32_16x16x32_bf16 v[84:87], a[64:67], a[108:111], v[84:87]
    ds_read_b128 a[36:39], v24 offset:3328
    v_mfma_f32_16x16x32_bf16 v[88:91], a[64:67], a[112:115], v[88:91]
    v_mfma_f32_16x16x32_bf16 v[92:95], a[64:67], a[116:119], v[92:95]
    ds_read2_b32 a[4:5], v20 offset0:128 offset1:129
    v_mfma_f32_16x16x32_bf16 v[96:99], a[64:67], a[120:123], v[96:99]
    ds_read2_b32 a[6:7], v20 offset0:130 offset1:131
    v_mfma_f32_16x16x32_bf16 v[100:103], a[64:67], a[124:127], v[100:103]
    ds_read_b128 a[40:43], v24 offset:2816
    v_mfma_f32_16x16x32_bf16 v[76:79], a[68:71], a[96:99], v[76:79]
    ds_read2_b32 a[8:9], v21 offset0:0 offset1:1
    v_mfma_f32_16x16x32_bf16 v[80:83], a[68:71], a[100:103], v[80:83]
    v_mfma_f32_16x16x32_bf16 v[84:87], a[68:71], a[104:107], v[84:87]
    ds_read2_b32 a[10:11], v21 offset0:2 offset1:3
    v_mfma_f32_16x16x32_bf16 v[88:91], a[68:71], a[108:111], v[88:91]
    ds_read_b128 a[44:47], v24 offset:2304
    v_mfma_f32_16x16x32_bf16 v[92:95], a[68:71], a[112:115], v[92:95]
    ds_read2_b32 a[12:13], v21 offset0:128 offset1:129
    v_mfma_f32_16x16x32_bf16 v[96:99], a[68:71], a[116:119], v[96:99]
    ds_read2_b32 a[14:15], v21 offset0:130 offset1:131
    v_mfma_f32_16x16x32_bf16 v[100:103], a[68:71], a[120:123], v[100:103]
    v_mfma_f32_16x16x32_bf16 v[80:83], a[72:75], a[96:99], v[80:83]
    ds_read_b128 a[48:51], v24 offset:1792
    v_mfma_f32_16x16x32_bf16 v[84:87], a[72:75], a[100:103], v[84:87]
    ds_read2_b32 a[16:17], v22 offset0:0 offset1:1
    v_mfma_f32_16x16x32_bf16 v[88:91], a[72:75], a[104:107], v[88:91]
    ds_read2_b32 a[18:19], v22 offset0:2 offset1:3
    v_mfma_f32_16x16x32_bf16 v[92:95], a[72:75], a[108:111], v[92:95]
    ds_read_b128 a[52:55], v24 offset:1280
    v_mfma_f32_16x16x32_bf16 v[96:99], a[72:75], a[112:115], v[96:99]
    v_mfma_f32_16x16x32_bf16 v[100:103], a[72:75], a[116:119], v[100:103]
    ds_read2_b32 a[20:21], v22 offset0:128 offset1:129
    v_mfma_f32_16x16x32_bf16 v[84:87], a[76:79], a[96:99], v[84:87]
    ds_read2_b32 a[22:23], v22 offset0:130 offset1:131
    v_mfma_f32_16x16x32_bf16 v[88:91], a[76:79], a[100:103], v[88:91]
    ds_read_b128 a[56:59], v24 offset:768
    v_mfma_f32_16x16x32_bf16 v[92:95], a[76:79], a[104:107], v[92:95]
    ds_read2_b32 a[24:25], v23 offset0:0 offset1:1
    v_mfma_f32_16x16x32_bf16 v[96:99], a[76:79], a[108:111], v[96:99]
    v_mfma_f32_16x16x32_bf16 v[100:103], a[76:79], a[112:115], v[100:103]
    ds_read2_b32 a[26:27], v23 offset0:2 offset1:3
    v_mfma_f32_16x16x32_bf16 v[88:91], a[80:83], a[96:99], v[88:91]
    ds_read_b128 a[60:63], v24 offset:256
    v_mfma_f32_16x16x32_bf16 v[92:95], a[80:83], a[100:103], v[92:95]
    ds_read2_b32 a[28:29], v23 offset0:128 offset1:129
    v_mfma_f32_16x16x32_bf16 v[96:99], a[80:83], a[104:107], v[96:99]
    ds_read2_b32 a[30:31], v23 offset0:130 offset1:131
    v_mfma_f32_16x16x32_bf16 v[100:103], a[80:83], a[108:111], v[100:103]
    v_mfma_f32_16x16x32_bf16 v[92:95], a[84:87], a[96:99], v[92:95]
    v_mfma_f32_16x16x32_bf16 v[96:99], a[84:87], a[100:103], v[96:99]
    v_mfma_f32_16x16x32_bf16 v[100:103], a[84:87], a[104:107], v[100:103]
    v_mfma_f32_16x16x32_bf16 v[96:99], a[88:91], a[96:99], v[96:99]
    v_mfma_f32_16x16x32_bf16 v[100:103], a[88:91], a[100:103], v[100:103]
    v_mfma_f32_16x16x32_bf16 v[100:103], a[92:95], a[96:99], v[100:103]
    s_waitcnt lgkmcnt(0)
    v_mfma_f32_16x16x32_bf16 v[72:75], a[0:3], a[32:35], v[72:75]
    ds_read_b128 a[96:99], v24 offset:3904
    v_mfma_f32_16x16x32_bf16 v[76:79], a[0:3], a[36:39], v[76:79]
    ds_read2_b32 a[64:65], v20 offset0:16 offset1:17
    v_mfma_f32_16x16x32_bf16 v[80:83], a[0:3], a[40:43], v[80:83]
    ds_read2_b32 a[66:67], v20 offset0:18 offset1:19
    v_mfma_f32_16x16x32_bf16 v[84:87], a[0:3], a[44:47], v[84:87]
    ds_read_b128 a[100:103], v24 offset:3392
    v_mfma_f32_16x16x32_bf16 v[88:91], a[0:3], a[48:51], v[88:91]
    ds_read2_b32 a[68:69], v20 offset0:144 offset1:145
    v_mfma_f32_16x16x32_bf16 v[92:95], a[0:3], a[52:55], v[92:95]
    ds_read2_b32 a[70:71], v20 offset0:146 offset1:147
    v_mfma_f32_16x16x32_bf16 v[96:99], a[0:3], a[56:59], v[96:99]
    ds_read_b128 a[104:107], v24 offset:2880
    v_mfma_f32_16x16x32_bf16 v[100:103], a[0:3], a[60:63], v[100:103]
    ds_read2_b32 a[72:73], v21 offset0:16 offset1:17
    v_mfma_f32_16x16x32_bf16 v[76:79], a[4:7], a[32:35], v[76:79]
    ds_read2_b32 a[74:75], v21 offset0:18 offset1:19
    v_mfma_f32_16x16x32_bf16 v[80:83], a[4:7], a[36:39], v[80:83]
    ds_read_b128 a[108:111], v24 offset:2368
    v_mfma_f32_16x16x32_bf16 v[84:87], a[4:7], a[40:43], v[84:87]
    ds_read2_b32 a[76:77], v21 offset0:144 offset1:145
    v_mfma_f32_16x16x32_bf16 v[88:91], a[4:7], a[44:47], v[88:91]
    ds_read2_b32 a[78:79], v21 offset0:146 offset1:147
    v_mfma_f32_16x16x32_bf16 v[92:95], a[4:7], a[48:51], v[92:95]
    ds_read_b128 a[112:115], v24 offset:1856
    v_mfma_f32_16x16x32_bf16 v[96:99], a[4:7], a[52:55], v[96:99]
    ds_read2_b32 a[80:81], v22 offset0:16 offset1:17
    v_mfma_f32_16x16x32_bf16 v[100:103], a[4:7], a[56:59], v[100:103]
    v_mfma_f32_16x16x32_bf16 v[80:83], a[8:11], a[32:35], v[80:83]
    ds_read2_b32 a[82:83], v22 offset0:18 offset1:19
    v_mfma_f32_16x16x32_bf16 v[84:87], a[8:11], a[36:39], v[84:87]
    ds_read_b128 a[116:119], v24 offset:1344
    v_mfma_f32_16x16x32_bf16 v[88:91], a[8:11], a[40:43], v[88:91]
    ds_read2_b32 a[84:85], v22 offset0:144 offset1:145
    v_mfma_f32_16x16x32_bf16 v[92:95], a[8:11], a[44:47], v[92:95]
    ds_read2_b32 a[86:87], v22 offset0:146 offset1:147
    v_mfma_f32_16x16x32_bf16 v[96:99], a[8:11], a[48:51], v[96:99]
    ds_read_b128 a[120:123], v24 offset:832
    v_mfma_f32_16x16x32_bf16 v[100:103], a[8:11], a[52:55], v[100:103]
    ds_read2_b32 a[88:89], v23 offset0:16 offset1:17
    v_mfma_f32_16x16x32_bf16 v[84:87], a[12:15], a[32:35], v[84:87]
    ds_read2_b32 a[90:91], v23 offset0:18 offset1:19
    v_mfma_f32_16x16x32_bf16 v[88:91], a[12:15], a[36:39], v[88:91]
    ds_read_b128 a[124:127], v24 offset:320
    v_mfma_f32_16x16x32_bf16 v[92:95], a[12:15], a[40:43], v[92:95]
    ds_read2_b32 a[92:93], v23 offset0:144 offset1:145
    v_mfma_f32_16x16x32_bf16 v[96:99], a[12:15], a[44:47], v[96:99]
    ds_read2_b32 a[94:95], v23 offset0:146 offset1:147
    v_mfma_f32_16x16x32_bf16 v[100:103], a[12:15], a[48:51], v[100:103]
    v_add_u32 v20, 128, v20
    v_mfma_f32_16x16x32_bf16 v[88:91], a[16:19], a[32:35], v[88:91]
    v_add_u32 v21, 128, v21
    v_mfma_f32_16x16x32_bf16 v[92:95], a[16:19], a[36:39], v[92:95]
    v_add_u32 v22, 128, v22
    v_mfma_f32_16x16x32_bf16 v[96:99], a[16:19], a[40:43], v[96:99]
    v_add_u32 v23, 128, v23
    v_mfma_f32_16x16x32_bf16 v[100:103], a[16:19], a[44:47], v[100:103]
    v_mfma_f32_16x16x32_bf16 v[92:95], a[20:23], a[32:35], v[92:95]
    v_mfma_f32_16x16x32_bf16 v[96:99], a[20:23], a[36:39], v[96:99]
    v_mfma_f32_16x16x32_bf16 v[100:103], a[20:23], a[40:43], v[100:103]
    v_mfma_f32_16x16x32_bf16 v[96:99], a[24:27], a[32:35], v[96:99]
    v_mfma_f32_16x16x32_bf16 v[100:103], a[24:27], a[36:39], v[100:103]
    v_mfma_f32_16x16x32_bf16 v[100:103], a[28:31], a[32:35], v[100:103]
    s_waitcnt lgkmcnt(0)
    v_mfma_f32_16x16x32_bf16 v[72:75], a[64:67], a[96:99], v[72:75]
    ds_read_b128 a[32:35], v24 offset:3968
    v_mfma_f32_16x16x32_bf16 v[76:79], a[64:67], a[100:103], v[76:79]
    ds_read2_b32 a[0:1], v20 offset0:0 offset1:1
    v_mfma_f32_16x16x32_bf16 v[80:83], a[64:67], a[104:107], v[80:83]
    ds_read2_b32 a[2:3], v20 offset0:2 offset1:3
    v_mfma_f32_16x16x32_bf16 v[84:87], a[64:67], a[108:111], v[84:87]
    ds_read_b128 a[36:39], v24 offset:3456
    v_mfma_f32_16x16x32_bf16 v[88:91], a[64:67], a[112:115], v[88:91]
    v_mfma_f32_16x16x32_bf16 v[92:95], a[64:67], a[116:119], v[92:95]
    ds_read2_b32 a[4:5], v20 offset0:128 offset1:129
    v_mfma_f32_16x16x32_bf16 v[96:99], a[64:67], a[120:123], v[96:99]
    ds_read2_b32 a[6:7], v20 offset0:130 offset1:131
    v_mfma_f32_16x16x32_bf16 v[100:103], a[64:67], a[124:127], v[100:103]
    ds_read_b128 a[40:43], v24 offset:2944
    v_mfma_f32_16x16x32_bf16 v[76:79], a[68:71], a[96:99], v[76:79]
    ds_read2_b32 a[8:9], v21 offset0:0 offset1:1
    v_mfma_f32_16x16x32_bf16 v[80:83], a[68:71], a[100:103], v[80:83]
    v_mfma_f32_16x16x32_bf16 v[84:87], a[68:71], a[104:107], v[84:87]
    ds_read2_b32 a[10:11], v21 offset0:2 offset1:3
    v_mfma_f32_16x16x32_bf16 v[88:91], a[68:71], a[108:111], v[88:91]
    ds_read_b128 a[44:47], v24 offset:2432
    v_mfma_f32_16x16x32_bf16 v[92:95], a[68:71], a[112:115], v[92:95]
    ds_read2_b32 a[12:13], v21 offset0:128 offset1:129
    v_mfma_f32_16x16x32_bf16 v[96:99], a[68:71], a[116:119], v[96:99]
    ds_read2_b32 a[14:15], v21 offset0:130 offset1:131
    v_mfma_f32_16x16x32_bf16 v[100:103], a[68:71], a[120:123], v[100:103]
    v_mfma_f32_16x16x32_bf16 v[80:83], a[72:75], a[96:99], v[80:83]
    ds_read_b128 a[48:51], v24 offset:1920
    v_mfma_f32_16x16x32_bf16 v[84:87], a[72:75], a[100:103], v[84:87]
    ds_read2_b32 a[16:17], v22 offset0:0 offset1:1
    v_mfma_f32_16x16x32_bf16 v[88:91], a[72:75], a[104:107], v[88:91]
    ds_read2_b32 a[18:19], v22 offset0:2 offset1:3
    v_mfma_f32_16x16x32_bf16 v[92:95], a[72:75], a[108:111], v[92:95]
    ds_read_b128 a[52:55], v24 offset:1408
    v_mfma_f32_16x16x32_bf16 v[96:99], a[72:75], a[112:115], v[96:99]
    v_mfma_f32_16x16x32_bf16 v[100:103], a[72:75], a[116:119], v[100:103]
    ds_read2_b32 a[20:21], v22 offset0:128 offset1:129
    v_mfma_f32_16x16x32_bf16 v[84:87], a[76:79], a[96:99], v[84:87]
    ds_read2_b32 a[22:23], v22 offset0:130 offset1:131
    v_mfma_f32_16x16x32_bf16 v[88:91], a[76:79], a[100:103], v[88:91]
    ds_read_b128 a[56:59], v24 offset:896
    v_mfma_f32_16x16x32_bf16 v[92:95], a[76:79], a[104:107], v[92:95]
    ds_read2_b32 a[24:25], v23 offset0:0 offset1:1
    v_mfma_f32_16x16x32_bf16 v[96:99], a[76:79], a[108:111], v[96:99]
    v_mfma_f32_16x16x32_bf16 v[100:103], a[76:79], a[112:115], v[100:103]
    ds_read2_b32 a[26:27], v23 offset0:2 offset1:3
    v_mfma_f32_16x16x32_bf16 v[88:91], a[80:83], a[96:99], v[88:91]
    ds_read_b128 a[60:63], v24 offset:384
    v_mfma_f32_16x16x32_bf16 v[92:95], a[80:83], a[100:103], v[92:95]
    ds_read2_b32 a[28:29], v23 offset0:128 offset1:129
    v_mfma_f32_16x16x32_bf16 v[96:99], a[80:83], a[104:107], v[96:99]
    ds_read2_b32 a[30:31], v23 offset0:130 offset1:131
    v_mfma_f32_16x16x32_bf16 v[100:103], a[80:83], a[108:111], v[100:103]
    v_mfma_f32_16x16x32_bf16 v[92:95], a[84:87], a[96:99], v[92:95]
    v_mfma_f32_16x16x32_bf16 v[96:99], a[84:87], a[100:103], v[96:99]
    v_mfma_f32_16x16x32_bf16 v[100:103], a[84:87], a[104:107], v[100:103]
    v_mfma_f32_16x16x32_bf16 v[96:99], a[88:91], a[96:99], v[96:99]
    v_mfma_f32_16x16x32_bf16 v[100:103], a[88:91], a[100:103], v[100:103]
    v_mfma_f32_16x16x32_bf16 v[100:103], a[92:95], a[96:99], v[100:103]
    s_waitcnt lgkmcnt(0)
    v_mfma_f32_16x16x32_bf16 v[72:75], a[0:3], a[32:35], v[72:75]
    ds_read_b128 a[96:99], v24 offset:4032
    v_mfma_f32_16x16x32_bf16 v[76:79], a[0:3], a[36:39], v[76:79]
    ds_read2_b32 a[64:65], v20 offset0:16 offset1:17
    v_mfma_f32_16x16x32_bf16 v[80:83], a[0:3], a[40:43], v[80:83]
    ds_read2_b32 a[66:67], v20 offset0:18 offset1:19
    v_mfma_f32_16x16x32_bf16 v[84:87], a[0:3], a[44:47], v[84:87]
    ds_read_b128 a[100:103], v24 offset:3520
    v_mfma_f32_16x16x32_bf16 v[88:91], a[0:3], a[48:51], v[88:91]
    ds_read2_b32 a[68:69], v20 offset0:144 offset1:145
    v_mfma_f32_16x16x32_bf16 v[92:95], a[0:3], a[52:55], v[92:95]
    ds_read2_b32 a[70:71], v20 offset0:146 offset1:147
    v_mfma_f32_16x16x32_bf16 v[96:99], a[0:3], a[56:59], v[96:99]
    ds_read_b128 a[104:107], v24 offset:3008
    v_mfma_f32_16x16x32_bf16 v[100:103], a[0:3], a[60:63], v[100:103]
    ds_read2_b32 a[72:73], v21 offset0:16 offset1:17
    v_mfma_f32_16x16x32_bf16 v[76:79], a[4:7], a[32:35], v[76:79]
    ds_read2_b32 a[74:75], v21 offset0:18 offset1:19
    v_mfma_f32_16x16x32_bf16 v[80:83], a[4:7], a[36:39], v[80:83]
    ds_read_b128 a[108:111], v24 offset:2496
    v_mfma_f32_16x16x32_bf16 v[84:87], a[4:7], a[40:43], v[84:87]
    ds_read2_b32 a[76:77], v21 offset0:144 offset1:145
    v_mfma_f32_16x16x32_bf16 v[88:91], a[4:7], a[44:47], v[88:91]
    ds_read2_b32 a[78:79], v21 offset0:146 offset1:147
    v_mfma_f32_16x16x32_bf16 v[92:95], a[4:7], a[48:51], v[92:95]
    ds_read_b128 a[112:115], v24 offset:1984
    v_mfma_f32_16x16x32_bf16 v[96:99], a[4:7], a[52:55], v[96:99]
    ds_read2_b32 a[80:81], v22 offset0:16 offset1:17
    v_mfma_f32_16x16x32_bf16 v[100:103], a[4:7], a[56:59], v[100:103]
    v_mfma_f32_16x16x32_bf16 v[80:83], a[8:11], a[32:35], v[80:83]
    ds_read2_b32 a[82:83], v22 offset0:18 offset1:19
    v_mfma_f32_16x16x32_bf16 v[84:87], a[8:11], a[36:39], v[84:87]
    ds_read_b128 a[116:119], v24 offset:1472
    v_mfma_f32_16x16x32_bf16 v[88:91], a[8:11], a[40:43], v[88:91]
    ds_read2_b32 a[84:85], v22 offset0:144 offset1:145
    v_mfma_f32_16x16x32_bf16 v[92:95], a[8:11], a[44:47], v[92:95]
    ds_read2_b32 a[86:87], v22 offset0:146 offset1:147
    v_mfma_f32_16x16x32_bf16 v[96:99], a[8:11], a[48:51], v[96:99]
    ds_read_b128 a[120:123], v24 offset:960
    v_mfma_f32_16x16x32_bf16 v[100:103], a[8:11], a[52:55], v[100:103]
    ds_read2_b32 a[88:89], v23 offset0:16 offset1:17
    v_mfma_f32_16x16x32_bf16 v[84:87], a[12:15], a[32:35], v[84:87]
    ds_read2_b32 a[90:91], v23 offset0:18 offset1:19
    v_mfma_f32_16x16x32_bf16 v[88:91], a[12:15], a[36:39], v[88:91]
    ds_read_b128 a[124:127], v24 offset:448
    v_mfma_f32_16x16x32_bf16 v[92:95], a[12:15], a[40:43], v[92:95]
    ds_read2_b32 a[92:93], v23 offset0:144 offset1:145
    v_mfma_f32_16x16x32_bf16 v[96:99], a[12:15], a[44:47], v[96:99]
    ds_read2_b32 a[94:95], v23 offset0:146 offset1:147
    v_mfma_f32_16x16x32_bf16 v[100:103], a[12:15], a[48:51], v[100:103]
    v_add_u32 v20, 128, v20
    v_mfma_f32_16x16x32_bf16 v[88:91], a[16:19], a[32:35], v[88:91]
    v_add_u32 v21, 128, v21
    v_mfma_f32_16x16x32_bf16 v[92:95], a[16:19], a[36:39], v[92:95]
    v_add_u32 v22, 128, v22
    v_mfma_f32_16x16x32_bf16 v[96:99], a[16:19], a[40:43], v[96:99]
    v_add_u32 v23, 128, v23
    v_mfma_f32_16x16x32_bf16 v[100:103], a[16:19], a[44:47], v[100:103]
    v_mfma_f32_16x16x32_bf16 v[92:95], a[20:23], a[32:35], v[92:95]
    v_mfma_f32_16x16x32_bf16 v[96:99], a[20:23], a[36:39], v[96:99]
    v_mfma_f32_16x16x32_bf16 v[100:103], a[20:23], a[40:43], v[100:103]
    v_mfma_f32_16x16x32_bf16 v[96:99], a[24:27], a[32:35], v[96:99]
    v_mfma_f32_16x16x32_bf16 v[100:103], a[24:27], a[36:39], v[100:103]
    v_mfma_f32_16x16x32_bf16 v[100:103], a[28:31], a[32:35], v[100:103]
    s_waitcnt lgkmcnt(0)
    v_mfma_f32_16x16x32_bf16 v[72:75], a[64:67], a[96:99], v[72:75]
    v_mfma_f32_16x16x32_bf16 v[76:79], a[64:67], a[100:103], v[76:79]
    v_mfma_f32_16x16x32_bf16 v[76:79], a[68:71], a[96:99], v[76:79]
    v_mfma_f32_16x16x32_bf16 v[80:83], a[64:67], a[104:107], v[80:83]
    v_mfma_f32_16x16x32_bf16 v[80:83], a[68:71], a[100:103], v[80:83]
    v_mfma_f32_16x16x32_bf16 v[80:83], a[72:75], a[96:99], v[80:83]
    v_mfma_f32_16x16x32_bf16 v[84:87], a[64:67], a[108:111], v[84:87]
    v_mfma_f32_16x16x32_bf16 v[84:87], a[68:71], a[104:107], v[84:87]
    v_mfma_f32_16x16x32_bf16 v[84:87], a[72:75], a[100:103], v[84:87]
    v_cvt_pk_bf16_f32 v104, v72, v73
    v_mfma_f32_16x16x32_bf16 v[84:87], a[76:79], a[96:99], v[84:87]
    v_cvt_pk_bf16_f32 v105, v74, v75
    v_mfma_f32_16x16x32_bf16 v[88:91], a[64:67], a[112:115], v[88:91]
    v_cvt_pk_bf16_f32 v106, v76, v77
    buffer_load_dword v19, off, s[4:7], s3 offset:0 sc1
    v_mfma_f32_16x16x32_bf16 v[88:91], a[68:71], a[108:111], v[88:91]
    v_cvt_pk_bf16_f32 v107, v78, v79
    v_mfma_f32_16x16x32_bf16 v[88:91], a[72:75], a[104:107], v[88:91]
    s_nop 0
    v_mfma_f32_16x16x32_bf16 v[88:91], a[76:79], a[100:103], v[88:91]
    v_permlane16_swap_b32 v104, v106
    v_permlane16_swap_b32 v105, v107
    v_mfma_f32_16x16x32_bf16 v[88:91], a[80:83], a[96:99], v[88:91]
    buffer_store_dwordx4 v[104:107], v25, s[4:7], s80 offen offset:0 sc1
    v_mfma_f32_16x16x32_bf16 v[92:95], a[64:67], a[116:119], v[92:95]
    v_cvt_pk_bf16_f32 v108, v80, v81
    v_mfma_f32_16x16x32_bf16 v[92:95], a[68:71], a[112:115], v[92:95]
    v_cvt_pk_bf16_f32 v109, v82, v83
    v_mfma_f32_16x16x32_bf16 v[92:95], a[72:75], a[108:111], v[92:95]
    v_cvt_pk_bf16_f32 v110, v84, v85
    v_mfma_f32_16x16x32_bf16 v[92:95], a[76:79], a[104:107], v[92:95]
    v_cvt_pk_bf16_f32 v111, v86, v87
    v_mfma_f32_16x16x32_bf16 v[92:95], a[80:83], a[100:103], v[92:95]
    s_nop 0
    v_mfma_f32_16x16x32_bf16 v[92:95], a[84:87], a[96:99], v[92:95]
    v_permlane16_swap_b32 v108, v110
    v_permlane16_swap_b32 v109, v111
    v_mfma_f32_16x16x32_bf16 v[96:99], a[64:67], a[120:123], v[96:99]
    buffer_store_dwordx4 v[108:111], v25, s[4:7], s80 offen offset:1024 sc1
    v_mfma_f32_16x16x32_bf16 v[96:99], a[68:71], a[116:119], v[96:99]
    v_mfma_f32_16x16x32_bf16 v[96:99], a[72:75], a[112:115], v[96:99]
    v_mfma_f32_16x16x32_bf16 v[96:99], a[76:79], a[108:111], v[96:99]
    v_mfma_f32_16x16x32_bf16 v[96:99], a[80:83], a[104:107], v[96:99]
    v_mfma_f32_16x16x32_bf16 v[96:99], a[84:87], a[100:103], v[96:99]
    v_cvt_pk_bf16_f32 v112, v88, v89
    v_mfma_f32_16x16x32_bf16 v[96:99], a[88:91], a[96:99], v[96:99]
    v_cvt_pk_bf16_f32 v113, v90, v91
    v_mfma_f32_16x16x32_bf16 v[100:103], a[64:67], a[124:127], v[100:103]
    v_cvt_pk_bf16_f32 v114, v92, v93
    v_mfma_f32_16x16x32_bf16 v[100:103], a[68:71], a[120:123], v[100:103]
    v_cvt_pk_bf16_f32 v115, v94, v95
    v_mfma_f32_16x16x32_bf16 v[100:103], a[72:75], a[116:119], v[100:103]
    s_nop 0
    v_mfma_f32_16x16x32_bf16 v[100:103], a[76:79], a[112:115], v[100:103]
    v_permlane16_swap_b32 v112, v114
    v_permlane16_swap_b32 v113, v115
    v_mfma_f32_16x16x32_bf16 v[100:103], a[80:83], a[108:111], v[100:103]
    buffer_store_dwordx4 v[112:115], v25, s[4:7], s80 offen offset:2048 sc1
    v_mfma_f32_16x16x32_bf16 v[100:103], a[84:87], a[104:107], v[100:103]
    v_mfma_f32_16x16x32_bf16 v[100:103], a[88:91], a[100:103], v[100:103]
    v_mfma_f32_16x16x32_bf16 v[100:103], a[92:95], a[96:99], v[100:103]
    s_nop 5
    v_cvt_pk_bf16_f32 v116, v96, v97
    v_cvt_pk_bf16_f32 v117, v98, v99
    v_cvt_pk_bf16_f32 v118, v100, v101
    v_cvt_pk_bf16_f32 v119, v102, v103
    s_nop 0
    v_permlane16_swap_b32 v116, v118
    v_permlane16_swap_b32 v117, v119
    buffer_store_dwordx4 v[116:119], v25, s[4:7], s80 offen offset:3072 sc1
    s_waitcnt vmcnt(0)
    s_barrier
    s_mul_i32 s25, s101, 3277
    s_lshr_b32 s25, s25, 16
    s_mul_i32 s25, s25, 512
    s_add_u32 s25, s25, 19931136
    s_cmp_lg_u32 s20, 0
    s_cbranch_scc1 L_sig_6
    s_mov_b64 exec, 3
    buffer_atomic_add v18, v6, s[4:7], s25 offen offset:0 sc1
    s_mov_b64 exec, -1
L_sig_6:
    v_readfirstlane_b32 s24, v19
    s_cmp_ge_u32 s24, 96
    s_cbranch_scc0 L_slow_7
L_ok_8:
    v_and_b32 v44, 15, v1
    v_lshlrev_b32 v44, 3, v44
    buffer_load_dwordx2 v[44:45], v44, s[4:7], s71 offen sc1
    s_cmp_eq_u32 s20, 0
    s_cbranch_scc1 L_nores_9
    s_add_u32 s25, s42, s32
    s_mov_b32 s28, 8192
    s_add_u32 s26, s43, s32
    s_mov_b32 s29, 12288
    s_add_u32 s27, s42, s33
    s_mov_b32 s30, 16384
    s_cmp_eq_u32 s20, 2
    s_cselect_b32 s25, s26, s25
    s_cselect_b32 s28, s29, s28
    s_cmp_eq_u32 s20, 3
    s_cselect_b32 s25, s27, s25
    s_cselect_b32 s28, s30, s28
    s_mov_b32 m0, s28
    s_nop 0
    buffer_load_dwordx4 v2, s[4:7], s25 offen offset:0 sc1 lds
    buffer_load_dwordx4 v2, s[4:7], s25 offen offset:1024 sc1 lds
    buffer_load_dwordx4 v2, s[4:7], s25 offen offset:2048 sc1 lds
    buffer_load_dwordx4 v2, s[4:7], s25 offen offset:3072 sc1 lds
    s_add_u32 s25, s43, s33
    s_mov_b32 s28, 20480
    s_add_u32 s26, s42, s34
    s_mov_b32 s29, 24576
    s_add_u32 s27, s43, s34
    s_mov_b32 s30, 28672
    s_cmp_eq_u32 s20, 2
    s_cselect_b32 s25, s26, s25
    s_cselect_b32 s28, s29, s28
    s_cmp_eq_u32 s20, 3
    s_cselect_b32 s25, s27, s25
    s_cselect_b32 s28, s30, s28
    s_mov_b32 m0, s28
    s_nop 0
    buffer_load_dwordx4 v2, s[4:7], s25 offen offset:0 sc1 lds
    buffer_load_dwordx4 v2, s[4:7], s25 offen offset:1024 sc1 lds
    buffer_load_dwordx4 v2, s[4:7], s25 offen offset:2048 sc1 lds
    buffer_load_dwordx4 v2, s[4:7], s25 offen offset:3072 sc1 lds
    s_add_u32 s25, s42, s35
    s_mov_b32 s28, 32768
    s_add_u32 s26, s43, s35
    s_mov_b32 s29, 36864
    s_add_u32 s27, s42, s36
    s_mov_b32 s30, 40960
    s_cmp_eq_u32 s20, 2
    s_cselect_b32 s25, s26, s25
    s_cselect_b32 s28, s29, s28
    s_cmp_eq_u32 s20, 3
    s_cselect_b32 s25, s27, s25
    s_cselect_b32 s28, s30, s28
    s_mov_b32 m0, s28
    s_nop 0
    buffer_load_dwordx4 v2, s[4:7], s25 offen offset:0 sc1 lds
    buffer_load_dwordx4 v2, s[4:7], s25 offen offset:1024 sc1 lds
    buffer_load_dwordx4 v2, s[4:7], s25 offen offset:2048 sc1 lds
    buffer_load_dwordx4 v2, s[4:7], s25 offen offset:3072 sc1 lds
    s_add_u32 s25, s43, s36
    s_mov_b32 s28, 45056
    s_add_u32 s26, s42, s37
    s_mov_b32 s29, 49152
    s_add_u32 s27, s43, s37
    s_mov_b32 s30, 53248
    s_cmp_eq_u32 s20, 2
    s_cselect_b32 s25, s26, s25
    s_cselect_b32 s28, s29, s28
    s_cmp_eq_u32 s20, 3
    s_cselect_b32 s25, s27, s25
    s_cselect_b32 s28, s30, s28
    s_mov_b32 m0, s28
    s_nop 0
    buffer_load_dwordx4 v2, s[4:7], s25 offen offset:0 sc1 lds
    buffer_load_dwordx4 v2, s[4:7], s25 offen offset:1024 sc1 lds
    buffer_load_dwordx4 v2, s[4:7], s25 offen offset:2048 sc1 lds
    buffer_load_dwordx4 v2, s[4:7], s25 offen offset:3072 sc1 lds
    s_add_u32 s25, s42, s38
    s_mov_b32 s28, 57344
    s_add_u32 s26, s43, s38
    s_mov_b32 s29, 61440
    s_add_u32 s27, s42, s39
    s_mov_b32 s30, 65536
    s_cmp_eq_u32 s20, 2
    s_cselect_b32 s25, s26, s25
    s_cselect_b32 s28, s29, s28
    s_cmp_eq_u32 s20, 3
    s_cselect_b32 s25, s27, s25
    s_cselect_b32 s28, s30, s28
    s_mov_b32 m0, s28
    s_nop 0
    buffer_load_dwordx4 v2, s[4:7], s25 offen offset:0 sc1 lds
    buffer_load_dwordx4 v2, s[4:7], s25 offen offset:1024 sc1 lds
    buffer_load_dwordx4 v2, s[4:7], s25 offen offset:2048 sc1 lds
    buffer_load_dwordx4 v2, s[4:7], s25 offen offset:3072 sc1 lds
    s_add_u32 s25, s43, s39
    s_mov_b32 s28, 69632
    s_add_u32 s26, s42, s40
    s_mov_b32 s29, 73728
    s_add_u32 s27, s43, s40
    s_mov_b32 s30, 77824
    s_cmp_eq_u32 s20, 2
    s_cselect_b32 s25, s26, s25
    s_cselect_b32 s28, s29, s28
    s_cmp_eq_u32 s20, 3
    s_cselect_b32 s25, s27, s25
    s_cselect_b32 s28, s30, s28
    s_mov_b32 m0, s28
    s_nop 0
    buffer_load_dwordx4 v2, s[4:7], s25 offen offset:0 sc1 lds
    buffer_load_dwordx4 v2, s[4:7], s25 offen offset:1024 sc1 lds
    buffer_load_dwordx4 v2, s[4:7], s25 offen offset:2048 sc1 lds
    buffer_load_dwordx4 v2, s[4:7], s25 offen offset:3072 sc1 lds
    s_add_u32 s25, s42, s41
    s_mov_b32 s28, 81920
    s_add_u32 s26, s43, s41
    s_mov_b32 s29, 86016
    s_mov_b32 s27, s77
    s_mov_b32 s30, 0
    s_cmp_eq_u32 s20, 2
    s_cselect_b32 s25, s26, s25
    s_cselect_b32 s28, s29, s28
    s_cmp_eq_u32 s20, 3
    s_cselect_b32 s25, s27, s25
    s_cselect_b32 s28, s30, s28
    s_mov_b32 m0, s28
    s_nop 0
    buffer_load_dwordx4 v2, s[4:7], s25 offen offset:0 sc1 lds
    buffer_load_dwordx4 v2, s[4:7], s25 offen offset:1024 sc1 lds
    s_cbranch_scc1 L_nores_9
    buffer_load_dwordx4 v2, s[4:7], s25 offen offset:2048 sc1 lds
    buffer_load_dwordx4 v2, s[4:7], s25 offen offset:3072 sc1 lds
L_nores_9:
L_ywait:
    buffer_load_dword v19, off, s[4:7], s74 offset:0 sc1
    s_mul_i32 s25, s23, 512
    s_and_b32 s26, s2, 1
    s_mul_i32 s26, s26, 256
    s_add_u32 s25, s25, s26
    s_add_u32 s25, s25, 19931136
    s_cmp_lg_u32 s20, 0
    s_cbranch_scc1 L_got_10
    s_movk_i32 s79, 30000
L_spin_11:
    buffer_load_dword v19, off, s[4:7], s25 offset:0 sc1
    s_waitcnt vmcnt(0)
    v_readfirstlane_b32 s24, v19
    s_cmp_ge_u32 s24, 20
    s_cbranch_scc1 L_got_10
    s_sub_u32 s79, s79, 1
    s_cbranch_scc0 L_spin_11
    s_branch L_got_10
L_got_10:
    s_barrier
    v_lshrrev_b32 v60, 3, v0
    v_and_b32 v61, 7, v0
    v_mul_u32_u24 v62, 4224, v60
    v_lshl_add_u32 v62, v61, 4, v62
    s_lshl_b32 s26, s20, 5
    s_sub_u32 s26, s82, s26
    s_add_u32 s24, s26, 135168
    s_add_u32 s25, s26, 270336
    s_cmp_ge_u32 s20, 2
    s_cselect_b32 s25, 134217728, s25
    buffer_load_dwordx4 v[48:51], v62, s[4:7], s26 offen sc1
    buffer_load_dwordx4 v[52:55], v62, s[4:7], s24 offen sc1
    buffer_load_dwordx4 v[56:59], v62, s[4:7], s25 offen sc1
    v_mul_u32_u24 v60, 160, v60
    v_lshl_add_u32 v60, v61, 4, v60
    v_add_u32 v60, 131072, v60
    v_lshrrev_b32 v61, 2, v1
    v_mul_u32_u24 v61, 160, v61
    v_and_b32 v62, 3, v1
    v_lshl_add_u32 v61, v62, 3, v61
    s_lshl_b32 s24, s20, 5
    s_add_u32 s24, s24, 131072
    v_add_u32 v61, s24, v61
    v_lshlrev_b32 v72, 16, v30
    v_and_b32 v73, 0xffff0000, v30
    v_lshlrev_b32 v74, 16, v31
    v_and_b32 v75, 0xffff0000, v31
    v_lshlrev_b32 v76, 16, v32
    v_and_b32 v77, 0xffff0000, v32
    v_lshlrev_b32 v78, 16, v33
    v_and_b32 v79, 0xffff0000, v33
    v_lshlrev_b32 v80, 16, v34
    v_and_b32 v81, 0xffff0000, v34
    v_lshlrev_b32 v82, 16, v35
    v_and_b32 v83, 0xffff0000, v35
    v_lshlrev_b32 v84, 16, v36
    v_and_b32 v85, 0xffff0000, v36
    v_lshlrev_b32 v86, 16, v37
    v_and_b32 v87, 0xffff0000, v37
    v_lshlrev_b32 v88, 16, v38
    v_and_b32 v89, 0xffff0000, v38
    v_lshlrev_b32 v90, 16, v39
    v_and_b32 v91, 0xffff0000, v39
    s_waitcnt vmcnt(2)
    ds_write_b128 v60, v[48:51] offset:0
    s_waitcnt vmcnt(1)
    ds_write_b128 v60, v[52:55] offset:5120
    s_waitcnt vmcnt(0)
    ds_write_b128 v60, v[56:59] offset:10240
    s_waitcnt lgkmcnt(0)
    s_barrier
    ds_read_b64_tr_b16 v[20:21], v61 offset:0
    ds_read_b64_tr_b16 v[22:23], v61 offset:2560
    ds_read_b64_tr_b16 v[24:25], v61 offset:5120
    ds_read_b64_tr_b16 v[26:27], v61 offset:7680
    ds_read_b64_tr_b16 v[28:29], v61 offset:10240
    s_waitcnt lgkmcnt(0)
    v_mul_f32 v46, v44, v45
    v_lshlrev_b32 v92, 16, v20
    v_and_b32 v93, 0xffff0000, v20
    v_pk_fma_f32 v[94:95], v[72:73], v[44:45], v[46:47] op_sel:[0,1,0] op_sel_hi:[1,1,0] neg_lo:[0,0,1] neg_hi:[0,0,1]
    v_pk_fma_f32 v[72:73], v[94:95], v[92:93], v[72:73]
    v_cvt_pk_bf16_f32 v30, v72, v73
    v_lshlrev_b32 v92, 16, v21
    v_and_b32 v93, 0xffff0000, v21
    v_pk_fma_f32 v[94:95], v[74:75], v[44:45], v[46:47] op_sel:[0,1,0] op_sel_hi:[1,1,0] neg_lo:[0,0,1] neg_hi:[0,0,1]
    v_pk_fma_f32 v[74:75], v[94:95], v[92:93], v[74:75]
    v_cvt_pk_bf16_f32 v31, v74, v75
    v_lshlrev_b32 v92, 16, v22
    v_and_b32 v93, 0xffff0000, v22
    v_pk_fma_f32 v[94:95], v[76:77], v[44:45], v[46:47] op_sel:[0,1,0] op_sel_hi:[1,1,0] neg_lo:[0,0,1] neg_hi:[0,0,1]
    v_pk_fma_f32 v[76:77], v[94:95], v[92:93], v[76:77]
    v_cvt_pk_bf16_f32 v32, v76, v77
    v_lshlrev_b32 v92, 16, v23
    v_and_b32 v93, 0xffff0000, v23
    v_pk_fma_f32 v[94:95], v[78:79], v[44:45], v[46:47] op_sel:[0,1,0] op_sel_hi:[1,1,0] neg_lo:[0,0,1] neg_hi:[0,0,1]
    v_pk_fma_f32 v[78:79], v[94:95], v[92:93], v[78:79]
    v_cvt_pk_bf16_f32 v33, v78, v79
    s_nop 1
    v_permlane16_swap_b32 v30, v32
    v_permlane16_swap_b32 v31, v33
    buffer_store_dwordx4 v[30:33], v13, s[8:11], s72 offen offset:0 sc1
    v_lshlrev_b32 v92, 16, v24
    v_and_b32 v93, 0xffff0000, v24
    v_pk_fma_f32 v[94:95], v[80:81], v[44:45], v[46:47] op_sel:[0,1,0] op_sel_hi:[1,1,0] neg_lo:[0,0,1] neg_hi:[0,0,1]
    v_pk_fma_f32 v[80:81], v[94:95], v[92:93], v[80:81]
    v_cvt_pk_bf16_f32 v34, v80, v81
    v_lshlrev_b32 v92, 16, v25
    v_and_b32 v93, 0xffff0000, v25
    v_pk_fma_f32 v[94:95], v[82:83], v[44:45], v[46:47] op_sel:[0,1,0] op_sel_hi:[1,1,0] neg_lo:[0,0,1] neg_hi:[0,0,1]
    v_pk_fma_f32 v[82:83], v[94:95], v[92:93], v[82:83]
    v_cvt_pk_bf16_f32 v35, v82, v83
    v_lshlrev_b32 v92, 16, v26
    v_and_b32 v93, 0xffff0000, v26
    v_pk_fma_f32 v[94:95], v[84:85], v[44:45], v[46:47] op_sel:[0,1,0] op_sel_hi:[1,1,0] neg_lo:[0,0,1] neg_hi:[0,0,1]
    v_pk_fma_f32 v[84:85], v[94:95], v[92:93], v[84:85]
    v_cvt_pk_bf16_f32 v36, v84, v85
    v_lshlrev_b32 v92, 16, v27
    v_and_b32 v93, 0xffff0000, v27
    v_pk_fma_f32 v[94:95], v[86:87], v[44:45], v[46:47] op_sel:[0,1,0] op_sel_hi:[1,1,0] neg_lo:[0,0,1] neg_hi:[0,0,1]
    v_pk_fma_f32 v[86:87], v[94:95], v[92:93], v[86:87]
    v_cvt_pk_bf16_f32 v37, v86, v87
    s_nop 1
    v_permlane16_swap_b32 v34, v36
    v_permlane16_swap_b32 v35, v37
    buffer_store_dwordx4 v[34:37], v13, s[8:11], s72 offen offset:2048 sc1
    v_lshlrev_b32 v92, 16, v28
    v_and_b32 v93, 0xffff0000, v28
    v_pk_fma_f32 v[94:95], v[88:89], v[44:45], v[46:47] op_sel:[0,1,0] op_sel_hi:[1,1,0] neg_lo:[0,0,1] neg_hi:[0,0,1]
    v_pk_fma_f32 v[88:89], v[94:95], v[92:93], v[88:89]
    v_cvt_pk_bf16_f32 v38, v88, v89
    v_lshlrev_b32 v92, 16, v29
    v_and_b32 v93, 0xffff0000, v29
    v_pk_fma_f32 v[94:95], v[90:91], v[44:45], v[46:47] op_sel:[0,1,0] op_sel_hi:[1,1,0] neg_lo:[0,0,1] neg_hi:[0,0,1]
    v_pk_fma_f32 v[90:91], v[94:95], v[92:93], v[90:91]
    v_cvt_pk_bf16_f32 v39, v90, v91
    s_add_u32 s24, s72, 4096
    s_nop 1
    v_permlane16_swap_b32 v38, v40
    v_permlane16_swap_b32 v39, v41
    s_mov_b32 exec_lo, 0xffff
    s_mov_b32 exec_hi, 0xffff
    buffer_store_dwordx4 v[38:41], v13, s[8:11], s24 offen sc1
    s_mov_b64 exec, -1
    v_pk_add_f32 v[92:93], v[72:73], v[74:75]
    v_pk_mul_f32 v[94:95], v[72:73], v[72:73]
    v_pk_fma_f32 v[94:95], v[74:75], v[74:75], v[94:95]
    v_pk_add_f32 v[92:93], v[92:93], v[76:77]
    v_pk_fma_f32 v[94:95], v[76:77], v[76:77], v[94:95]
    v_pk_add_f32 v[92:93], v[92:93], v[78:79]
    v_pk_fma_f32 v[94:95], v[78:79], v[78:79], v[94:95]
    v_pk_add_f32 v[92:93], v[92:93], v[80:81]
    v_pk_fma_f32 v[94:95], v[80:81], v[80:81], v[94:95]
    v_pk_add_f32 v[92:93], v[92:93], v[82:83]
    v_pk_fma_f32 v[94:95], v[82:83], v[82:83], v[94:95]
    v_pk_add_f32 v[92:93], v[92:93], v[84:85]
    v_pk_fma_f32 v[94:95], v[84:85], v[84:85], v[94:95]
    v_pk_add_f32 v[92:93], v[92:93], v[86:87]
    v_pk_fma_f32 v[94:95], v[86:87], v[86:87], v[94:95]
    v_pk_add_f32 v[92:93], v[92:93], v[88:89]
    v_pk_fma_f32 v[94:95], v[88:89], v[88:89], v[94:95]
    v_pk_add_f32 v[92:93], v[92:93], v[90:91]
    v_pk_fma_f32 v[94:95], v[90:91], v[90:91], v[94:95]
    v_add_f32 v96, v92, v93
    v_add_f32 v97, v94, v95
    v_mov_b32 v92, v96
    v_mov_b32 v93, v97
    s_nop 0
    v_permlane16_swap_b32 v96, v92
    v_permlane16_swap_b32 v97, v93
    v_add_f32 v96, v96, v92
    v_add_f32 v97, v97, v93
    v_mov_b32 v92, v96
    v_mov_b32 v93, v97
    s_nop 0
    v_permlane32_swap_b32 v96, v92
    v_permlane32_swap_b32 v97, v93
    v_add_f32 v96, v96, v92
    v_add_f32 v97, v97, v93
    s_mov_b32 s24, 3145728
    s_mov_b64 exec, 0xffff
    buffer_store_dwordx2 v[96:97], v14, s[8:11], s24 offen sc1
    s_mov_b64 exec, -1
    s_waitcnt vmcnt(0)
    s_barrier
    s_cmp_lg_u32 s20, 0
    s_cbranch_scc1 L_sig_12
    s_mov_b64 exec, 1
    buffer_atomic_add v18, off, s[4:7], s74 offset:0 sc1
    s_mov_b64 exec, -1
L_sig_12:
    s_cmp_eq_u32 s20, 0
    s_cbranch_scc1 L_nosh_13
    s_cmp_eq_u32 s20, 2
    s_cselect_b32 s25, s33, s32
    s_cmp_eq_u32 s20, 3
    s_cselect_b32 s25, s34, s25
    s_lshl_b32 s26, s20, 12
    s_add_u32 m0, s26, 86016
    s_add_u32 s25, s25, s44
    buffer_load_dwordx4 v2, s[4:7], s25 offen offset:0 sc1 lds
    buffer_load_dwordx4 v2, s[4:7], s25 offen offset:1024 sc1 lds
    buffer_load_dwordx4 v2, s[4:7], s25 offen offset:2048 sc1 lds
    buffer_load_dwordx4 v2, s[4:7], s25 offen offset:3072 sc1 lds
    s_cmp_eq_u32 s20, 2
    s_cselect_b32 s25, s36, s35
    s_cmp_eq_u32 s20, 3
    s_cselect_b32 s25, s37, s25
    s_lshl_b32 s26, s20, 12
    s_add_u32 m0, s26, 98304
    s_add_u32 s25, s25, s44
    buffer_load_dwordx4 v2, s[4:7], s25 offen offset:0 sc1 lds
    buffer_load_dwordx4 v2, s[4:7], s25 offen offset:1024 sc1 lds
    buffer_load_dwordx4 v2, s[4:7], s25 offen offset:2048 sc1 lds
    buffer_load_dwordx4 v2, s[4:7], s25 offen offset:3072 sc1 lds
    s_cmp_eq_u32 s20, 2
    s_cselect_b32 s25, s39, s38
    s_cmp_eq_u32 s20, 3
    s_cselect_b32 s25, s40, s25
    s_lshl_b32 s26, s20, 12
    s_add_u32 m0, s26, 110592
    s_add_u32 s25, s25, s44
    buffer_load_dwordx4 v2, s[4:7], s25 offen offset:0 sc1 lds
    buffer_load_dwordx4 v2, s[4:7], s25 offen offset:1024 sc1 lds
    buffer_load_dwordx4 v2, s[4:7], s25 offen offset:2048 sc1 lds
    buffer_load_dwordx4 v2, s[4:7], s25 offen offset:3072 sc1 lds
    s_cmp_lg_u32 s20, 1
    s_cbranch_scc1 L_nosh_13
    s_mov_b32 s25, s41
    s_lshl_b32 s26, s20, 12
    s_add_u32 m0, s26, 122880
    s_add_u32 s25, s25, s44
    buffer_load_dwordx4 v2, s[4:7], s25 offen offset:0 sc1 lds
    buffer_load_dwordx4 v2, s[4:7], s25 offen offset:1024 sc1 lds
    buffer_load_dwordx4 v2, s[4:7], s25 offen offset:2048 sc1 lds
    buffer_load_dwordx4 v2, s[4:7], s25 offen offset:3072 sc1 lds
L_nosh_13:
    s_cmp_lg_u32 s20, 0
    s_cbranch_scc1 L_got_14
    s_movk_i32 s79, 30000
L_spin_15:
    buffer_load_dword v19, off, s[4:7], s74 offset:0 sc1
    s_waitcnt vmcnt(0)
    v_readfirstlane_b32 s24, v19
    s_cmp_ge_u32 s24, 16
    s_cbranch_scc1 L_got_14
    s_sub_u32 s79, s79, 1
    s_cbranch_scc0 L_spin_15
    s_branch L_got_14
L_got_14:
    s_barrier
    buffer_load_dwordx4 a[0:3], v47, s[8:11], s32 offen offset:0 sc1
    buffer_load_dwordx4 a[4:7], v47, s[8:11], s32 offen offset:1024 sc1
    buffer_load_dwordx4 a[8:11], v47, s[8:11], s32 offen offset:2048 sc1
    buffer_load_dwordx4 a[12:15], v47, s[8:11], s32 offen offset:3072 sc1
    buffer_load_dwordx4 a[16:19], v47, s[8:11], s33 offen offset:0 sc1
    buffer_load_dwordx4 a[20:23], v47, s[8:11], s33 offen offset:1024 sc1
    buffer_load_dwordx4 a[24:27], v47, s[8:11], s33 offen offset:2048 sc1
    buffer_load_dwordx4 a[28:31], v47, s[8:11], s33 offen offset:3072 sc1
    v_and_b32 v80, 15, v1
    v_lshlrev_b32 v80, 3, v80
    v_lshrrev_b32 v81, 5, v1
    v_lshl_add_u32 v80, v81, 9, v80
    v_bfe_u32 v81, v1, 4, 1
    v_lshl_add_u32 v80, v81, 10, v80
    buffer_load_dwordx2 v[72:73], v80, s[8:11], s70 offen offset:0 sc1
    buffer_load_dwordx2 v[74:75], v80, s[8:11], s70 offen offset:128 sc1
    buffer_load_dwordx2 v[76:77], v80, s[8:11], s70 offen offset:256 sc1
    buffer_load_dwordx2 v[78:79], v80, s[8:11], s70 offen offset:384 sc1
    s_waitcnt vmcnt(11)
    s_barrier
    ds_read_b128 v[48:51], v2 offset:8192
    ds_read_b128 v[52:55], v2 offset:12288
    ds_read_b128 v[56:59], v4 offset:24576
    ds_read_b128 v[60:63], v2 offset:9216
    ds_read_b128 v[64:67], v2 offset:13312
    ds_read_b128 v[68:71], v4 offset:25600
    s_waitcnt lgkmcnt(2)
    v_mfma_f32_32x32x16_bf16 v[92:107], v[48:51], a[0:3], 0
    ds_read_b128 v[84:87], v2 offset:10240
    buffer_load_dwordx4 a[32:35], v47, s[8:11], s34 offen offset:0 sc1
    v_mfma_f32_32x32x16_bf16 v[108:123], v[52:55], a[0:3], 0
    ds_read_b128 v[88:91], v2 offset:14336
    s_sub_u32 m0, s75, 88064
    s_nop 0
    buffer_load_dwordx4 v3, s[4:7], s78 offen sc1 lds
    s_cmp_lg_u32 s20, 0
    s_cbranch_scc1 L_ex_16
    s_add_u32 s29, s78, 4096
    s_cmp_eq_u32 s48, 134217728
    s_cselect_b32 s29, 134217728, s29
    s_movk_i32 m0, 6144
    s_nop 0
    buffer_load_dwordx4 v2, s[4:7], s29 offen sc1 lds
L_ex_16:
    v_mfma_f32_32x32x16_bf16 v[124:139], v[56:59], a[0:3], 0
    ds_read_b128 v[48:51], v4 offset:26624
    buffer_load_dwordx4 a[36:39], v47, s[8:11], s34 offen offset:1024 sc1
    v_permlane16_swap_b32 v30, v32
    s_waitcnt vmcnt(13)
    v_mfma_f32_32x32x16_bf16 v[92:107], v[60:63], a[4:7], v[92:107]
    ds_read_b128 v[52:55], v2 offset:11264
    v_permlane16_swap_b32 v31, v33
    s_waitcnt lgkmcnt(2)
    v_mfma_f32_32x32x16_bf16 v[108:123], v[64:67], a[4:7], v[108:123]
    ds_read_b128 v[56:59], v2 offset:15360
    v_add_u32 v6, s45, v3
    s_add_u32 m0, s75, 40960
    v_permlane16_swap_b32 v34, v36
    v_mfma_f32_32x32x16_bf16 v[124:139], v[68:71], a[4:7], v[124:139]
    ds_read_b128 v[60:63], v4 offset:27648
    buffer_load_dwordx4 a[40:43], v47, s[8:11], s34 offen offset:2048 sc1
    v_permlane16_swap_b32 v35, v37
    s_waitcnt vmcnt(13)
    v_mfma_f32_32x32x16_bf16 v[92:107], v[84:87], a[8:11], v[92:107]
    ds_read_b128 v[64:67], v2 offset:16384
    buffer_load_dwordx4 v6, s[4:7], s32 offen sc1 lds
    v_mfma_f32_32x32x16_bf16 v[108:123], v[88:91], a[8:11], v[108:123]
    ds_read_b128 v[68:71], v2 offset:20480
    buffer_load_dwordx4 a[44:47], v47, s[8:11], s34 offen offset:3072 sc1
    v_permlane16_swap_b32 v38, v40
    s_waitcnt lgkmcnt(2)
    v_mfma_f32_32x32x16_bf16 v[124:139], v[48:51], a[8:11], v[124:139]
    ds_read_b128 v[84:87], v4 offset:28672
    s_add_u32 m0, s75, 45056
    s_nop 0
    buffer_load_dwordx4 v6, s[4:7], s33 offen sc1 lds
    v_permlane16_swap_b32 v39, v41
    s_waitcnt vmcnt(15)
    v_mfma_f32_32x32x16_bf16 v[92:107], v[52:55], a[12:15], v[92:107]
    ds_read_b128 v[88:91], v2 offset:17408
    v_mfma_f32_32x32x16_bf16 v[108:123], v[56:59], a[12:15], v[108:123]
    ds_read_b128 v[48:51], v2 offset:21504
    buffer_load_dwordx4 a[48:51], v47, s[8:11], s35 offen offset:0 sc1
    v_mfma_f32_32x32x16_bf16 v[124:139], v[60:63], a[12:15], v[124:139]
    ds_read_b128 v[52:55], v4 offset:29696
    s_add_u32 m0, s75, 49152
    s_waitcnt lgkmcnt(2)
    s_waitcnt vmcnt(15)
    v_mfma_f32_32x32x16_bf16 v[92:107], v[64:67], a[16:19], v[92:107]
    ds_read_b128 v[56:59], v2 offset:18432
    buffer_load_dwordx4 a[52:55], v47, s[8:11], s35 offen offset:1024 sc1
    v_mfma_f32_32x32x16_bf16 v[108:123], v[68:71], a[16:19], v[108:123]
    ds_read_b128 v[60:63], v2 offset:22528
    buffer_load_dwordx4 v6, s[4:7], s34 offen sc1 lds
    v_mfma_f32_32x32x16_bf16 v[124:139], v[84:87], a[16:19], v[124:139]
    ds_read_b128 v[64:67], v4 offset:30720
    s_add_u32 m0, s75, 53248
    s_waitcnt vmcnt(16)
    v_mfma_f32_32x32x16_bf16 v[92:107], v[88:91], a[20:23], v[92:107]
    ds_read_b128 v[68:71], v2 offset:19456
    buffer_load_dwordx4 a[56:59], v47, s[8:11], s35 offen offset:2048 sc1
    s_waitcnt lgkmcnt(2)
    v_mfma_f32_32x32x16_bf16 v[108:123], v[48:51], a[20:23], v[108:123]
    ds_read_b128 v[84:87], v2 offset:23552
    buffer_load_dwordx4 v6, s[4:7], s35 offen sc1 lds
    v_mfma_f32_32x32x16_bf16 v[124:139], v[52:55], a[20:23], v[124:139]
    ds_read_b128 v[88:91], v4 offset:31744
    buffer_load_dwordx4 a[60:63], v47, s[8:11], s35 offen offset:3072 sc1
    s_waitcnt vmcnt(18)
    v_mfma_f32_32x32x16_bf16 v[92:107], v[56:59], a[24:27], v[92:107]
    ds_read_b128 v[48:51], v2 offset:24576
    s_add_u32 m0, s75, 57344
    v_mfma_f32_32x32x16_bf16 v[108:123], v[60:63], a[24:27], v[108:123]
    ds_read_b128 v[52:55], v2 offset:28672
    buffer_load_dwordx4 v6, s[4:7], s36 offen sc1 lds
    s_waitcnt lgkmcnt(2)
    v_mfma_f32_32x32x16_bf16 v[124:139], v[64:67], a[24:27], v[124:139]
    ds_read_b128 v[56:59], v4 offset:32768
    s_waitcnt vmcnt(14)
    v_add_f32 v72, v72, v74
    v_add_f32 v73, v73, v75
    v_add_f32 v76, v76, v78
    v_mfma_f32_32x32x16_bf16 v[92:107], v[68:71], a[28:31], v[92:107]
    ds_read_b128 v[60:63], v2 offset:25600
    buffer_load_dwordx4 a[64:67], v47, s[8:11], s36 offen offset:0 sc1
    v_add_f32 v77, v77, v79
    s_add_u32 m0, s75, 61440
    v_mfma_f32_32x32x16_bf16 v[108:123], v[84:87], a[28:31], v[108:123]
    ds_read_b128 v[64:67], v2 offset:29696
    v_add_f32 v72, v72, v76
    v_add_f32 v73, v73, v77
    v_mov_b32 v74, v72
    v_mfma_f32_32x32x16_bf16 v[124:139], v[88:91], a[28:31], v[124:139]
    ds_read_b128 v[68:71], v4 offset:33792
    buffer_load_dwordx4 a[68:71], v47, s[8:11], s36 offen offset:1024 sc1
    v_mov_b32 v75, v73
    s_waitcnt lgkmcnt(2)
    s_waitcnt vmcnt(15)
    v_mfma_f32_32x32x16_bf16 v[92:107], v[48:51], a[32:35], v[92:107]
    ds_read_b128 v[84:87], v2 offset:26624
    buffer_load_dwordx4 v6, s[4:7], s37 offen sc1 lds
    s_nop 0
    v_mfma_f32_32x32x16_bf16 v[108:123], v[52:55], a[32:35], v[108:123]
    ds_read_b128 v[88:91], v2 offset:30720
    s_add_u32 m0, s75, 65536
    v_permlane32_swap_b32 v72, v74
    v_mfma_f32_32x32x16_bf16 v[124:139], v[56:59], a[32:35], v[124:139]
    ds_read_b128 v[48:51], v4 offset:34816
    buffer_load_dwordx4 a[72:75], v47, s[8:11], s36 offen offset:2048 sc1
    s_waitcnt vmcnt(15)
    v_mfma_f32_32x32x16_bf16 v[92:107], v[60:63], a[36:39], v[92:107]
    ds_read_b128 v[52:55], v2 offset:27648
    buffer_load_dwordx4 v6, s[4:7], s38 offen sc1 lds
    v_permlane32_swap_b32 v73, v75
    s_waitcnt lgkmcnt(2)
    v_mfma_f32_32x32x16_bf16 v[108:123], v[64:67], a[36:39], v[108:123]
    ds_read_b128 v[56:59], v2 offset:31744
    buffer_load_dwordx4 a[76:79], v47, s[8:11], s36 offen offset:3072 sc1
    v_add_f32 v72, v72, v74
    v_mfma_f32_32x32x16_bf16 v[124:139], v[68:71], a[36:39], v[124:139]
    ds_read_b128 v[60:63], v4 offset:35840
    s_add_u32 m0, s75, 69632
    s_nop 0
    buffer_load_dwordx4 v6, s[4:7], s39 offen sc1 lds
    s_waitcnt vmcnt(17)
    v_mfma_f32_32x32x16_bf16 v[92:107], v[84:87], a[40:43], v[92:107]
    ds_read_b128 v[64:67], v2 offset:32768
    v_add_f32 v73, v73, v75
    v_mfma_f32_32x32x16_bf16 v[108:123], v[88:91], a[40:43], v[108:123]
    ds_read_b128 v[68:71], v2 offset:36864
    buffer_load_dwordx4 a[80:83], v47, s[8:11], s37 offen offset:0 sc1
    s_waitcnt lgkmcnt(2)
    v_mfma_f32_32x32x16_bf16 v[124:139], v[48:51], a[40:43], v[124:139]
    ds_read_b128 v[84:87], v4 offset:36864
    v_mul_f32 v72, s76, v72
    s_waitcnt vmcnt(16)
    v_mfma_f32_32x32x16_bf16 v[92:107], v[52:55], a[44:47], v[92:107]
    ds_read_b128 v[88:91], v2 offset:33792
    buffer_load_dwordx4 a[84:87], v47, s[8:11], s37 offen offset:1024 sc1
    v_mul_f32 v74, v72, v72
    v_mfma_f32_32x32x16_bf16 v[108:123], v[56:59], a[44:47], v[108:123]
    ds_read_b128 v[48:51], v2 offset:37888
    v_mfma_f32_32x32x16_bf16 v[124:139], v[60:63], a[44:47], v[124:139]
    ds_read_b128 v[52:55], v4 offset:37888
    v_fma_f32 v73, v73, s76, -v74
    s_waitcnt lgkmcnt(2)
    s_waitcnt vmcnt(15)
    v_mfma_f32_32x32x16_bf16 v[92:107], v[64:67], a[48:51], v[92:107]
    ds_read_b128 v[56:59], v2 offset:34816
    buffer_load_dwordx4 a[88:91], v47, s[8:11], s37 offen offset:2048 sc1
    v_max_f32 v73, 0, v73
    v_mfma_f32_32x32x16_bf16 v[108:123], v[68:71], a[48:51], v[108:123]
    ds_read_b128 v[60:63], v2 offset:38912
    v_mfma_f32_32x32x16_bf16 v[124:139], v[84:87], a[48:51], v[124:139]
    ds_read_b128 v[64:67], v4 offset:38912
    buffer_load_dwordx4 a[92:95], v47, s[8:11], s37 offen offset:3072 sc1
    v_cvt_pk_bf16_f32 v72, v72, v72
    s_waitcnt vmcnt(16)
    v_mfma_f32_32x32x16_bf16 v[92:107], v[88:91], a[52:55], v[92:107]
    ds_read_b128 v[68:71], v2 offset:35840
    v_lshlrev_b32 v72, 16, v72
    s_waitcnt lgkmcnt(2)
    v_mfma_f32_32x32x16_bf16 v[108:123], v[48:51], a[52:55], v[108:123]
    ds_read_b128 v[84:87], v2 offset:39936
    v_mfma_f32_32x32x16_bf16 v[124:139], v[52:55], a[52:55], v[124:139]
    ds_read_b128 v[88:91], v4 offset:39936
    v_cvt_pk_bf16_f32 v73, v73, v73
    s_waitcnt vmcnt(14)
    v_mfma_f32_32x32x16_bf16 v[92:107], v[56:59], a[56:59], v[92:107]
    ds_read_b128 v[48:51], v2 offset:40960
    buffer_load_dwordx4 a[96:99], v47, s[8:11], s38 offen offset:0 sc1
    v_mfma_f32_32x32x16_bf16 v[108:123], v[60:63], a[56:59], v[108:123]
    ds_read_b128 v[52:55], v2 offset:45056
    v_lshlrev_b32 v73, 16, v73
    s_waitcnt lgkmcnt(2)
    v_mfma_f32_32x32x16_bf16 v[124:139], v[64:67], a[56:59], v[124:139]
    ds_read_b128 v[56:59], v4 offset:40960
    buffer_load_dwordx4 a[100:103], v47, s[8:11], s38 offen offset:1024 sc1
    v_add_f32 v73, 0x3727c5ac, v73
    s_waitcnt vmcnt(14)
    v_mfma_f32_32x32x16_bf16 v[92:107], v[68:71], a[60:63], v[92:107]
    ds_read_b128 v[60:63], v2 offset:41984
    v_mfma_f32_32x32x16_bf16 v[108:123], v[84:87], a[60:63], v[108:123]
    ds_read_b128 v[64:67], v2 offset:46080
    v_cvt_pk_bf16_f32 v73, v73, v73
    v_mfma_f32_32x32x16_bf16 v[124:139], v[88:91], a[60:63], v[124:139]
    ds_read_b128 v[68:71], v4 offset:41984
    buffer_load_dwordx4 a[104:107], v47, s[8:11], s38 offen offset:2048 sc1
    s_barrier
    s_waitcnt lgkmcnt(2)
    s_waitcnt vmcnt(13)
    v_mfma_f32_32x32x16_bf16 v[92:107], v[48:51], a[64:67], v[92:107]
    ds_read_b128 v[84:87], v2 offset:43008
    s_add_u32 m0, s75, 0
    s_nop 0
    buffer_load_dwordx4 v6, s[4:7], s40 offen sc1 lds
    v_lshlrev_b32 v73, 16, v73
    v_mfma_f32_32x32x16_bf16 v[108:123], v[52:55], a[64:67], v[108:123]
    ds_read_b128 v[88:91], v2 offset:47104
    buffer_load_dwordx4 a[108:111], v47, s[8:11], s38 offen offset:3072 sc1
    v_mfma_f32_32x32x16_bf16 v[124:139], v[56:59], a[64:67], v[124:139]
    ds_read_b128 v[48:51], v4 offset:43008
    v_sqrt_f32 v73, v73
    s_add_u32 m0, s75, 4096
    s_waitcnt vmcnt(14)
    v_mfma_f32_32x32x16_bf16 v[92:107], v[60:63], a[68:71], v[92:107]
    ds_read_b128 v[52:55], v2 offset:44032
    buffer_load_dwordx4 v6, s[4:7], s41 offen sc1 lds
    s_waitcnt lgkmcnt(2)
    v_mfma_f32_32x32x16_bf16 v[108:123], v[64:67], a[68:71], v[108:123]
    ds_read_b128 v[56:59], v2 offset:48128
    buffer_load_dwordx4 a[112:115], v47, s[8:11], s39 offen offset:0 sc1
    s_nop 0
    v_mfma_f32_32x32x16_bf16 v[124:139], v[68:71], a[68:71], v[124:139]
    ds_read_b128 v[60:63], v4 offset:44032
    v_cvt_pk_bf16_f32 v73, v73, v73
    s_waitcnt vmcnt(14)
    v_mfma_f32_32x32x16_bf16 v[92:107], v[84:87], a[72:75], v[92:107]
    ds_read_b128 v[64:67], v2 offset:49152
    buffer_load_dwordx4 a[116:119], v47, s[8:11], s39 offen offset:1024 sc1
    v_add_u32 v6, s46, v3
    v_mfma_f32_32x32x16_bf16 v[108:123], v[88:91], a[72:75], v[108:123]
    ds_read_b128 v[68:71], v2 offset:53248
    s_add_u32 m0, s75, 8192
    v_lshlrev_b32 v73, 16, v73
    s_waitcnt lgkmcnt(2)
    v_mfma_f32_32x32x16_bf16 v[124:139], v[48:51], a[72:75], v[124:139]
    ds_read_b128 v[84:87], v4 offset:45056
    buffer_load_dwordx4 v6, s[4:7], s32 offen sc1 lds
    s_waitcnt vmcnt(14)
    v_mfma_f32_32x32x16_bf16 v[92:107], v[52:55], a[76:79], v[92:107]
    ds_read_b128 v[88:91], v2 offset:50176
    buffer_load_dwordx4 a[120:123], v47, s[8:11], s39 offen offset:2048 sc1
    v_mfma_f32_32x32x16_bf16 v[108:123], v[56:59], a[76:79], v[108:123]
    ds_read_b128 v[48:51], v2 offset:54272
    v_rcp_f32 v74, v73
    s_add_u32 m0, s75, 12288
    v_mfma_f32_32x32x16_bf16 v[124:139], v[60:63], a[76:79], v[124:139]
    ds_read_b128 v[52:55], v4 offset:46080
    buffer_load_dwordx4 a[124:127], v47, s[8:11], s39 offen offset:3072 sc1
    s_waitcnt lgkmcnt(2)
    s_waitcnt vmcnt(14)
    v_mfma_f32_32x32x16_bf16 v[92:107], v[64:67], a[80:83], v[92:107]
    ds_read_b128 v[56:59], v2 offset:51200
    buffer_load_dwordx4 v6, s[4:7], s33 offen sc1 lds
    v_mul_f32 v46, v73, v73
    v_mfma_f32_32x32x16_bf16 v[108:123], v[68:71], a[80:83], v[108:123]
    ds_read_b128 v[60:63], v2 offset:55296
    v_xor_b32 v72, 0x80000000, v72
    v_mfma_f32_32x32x16_bf16 v[124:139], v[84:87], a[80:83], v[124:139]
    ds_read_b128 v[64:67], v4 offset:47104
    s_waitcnt vmcnt(14)
    v_mfma_f32_32x32x16_bf16 v[92:107], v[88:91], a[84:87], v[92:107]
    ds_read_b128 v[68:71], v2 offset:52224
    buffer_load_dwordx4 a[128:131], v47, s[8:11], s40 offen offset:0 sc1
    v_mul_f32 v44, 0xc0135761, v74
    s_waitcnt lgkmcnt(2)
    v_mfma_f32_32x32x16_bf16 v[108:123], v[48:51], a[84:87], v[108:123]
    ds_read_b128 v[84:87], v2 offset:56320
    v_mul_f32 v75, v74, v74
    v_mfma_f32_32x32x16_bf16 v[124:139], v[52:55], a[84:87], v[124:139]
    ds_read_b128 v[88:91], v4 offset:48128
    buffer_load_dwordx4 a[132:135], v47, s[8:11], s40 offen offset:1024 sc1
    s_waitcnt vmcnt(15)
    v_mfma_f32_32x32x16_bf16 v[92:107], v[56:59], a[88:91], v[92:107]
    ds_read_b128 v[48:51], v2 offset:57344
    v_lshrrev_b32 v76, 16, v72
    v_mfma_f32_32x32x16_bf16 v[108:123], v[60:63], a[88:91], v[108:123]
    ds_read_b128 v[52:55], v2 offset:61440
    v_mul_f32 v75, v75, v74
    s_waitcnt lgkmcnt(2)
    v_mfma_f32_32x32x16_bf16 v[124:139], v[64:67], a[88:91], v[124:139]
    ds_read_b128 v[56:59], v4 offset:49152
    buffer_load_dwordx4 a[136:139], v47, s[8:11], s40 offen offset:2048 sc1
    s_waitcnt vmcnt(15)
    v_mfma_f32_32x32x16_bf16 v[92:107], v[68:71], a[92:95], v[92:107]
    ds_read_b128 v[60:63], v2 offset:58368
    v_or_b32 v72, v72, v76
    v_mfma_f32_32x32x16_bf16 v[108:123], v[84:87], a[92:95], v[108:123]
    ds_read_b128 v[64:67], v2 offset:62464
    buffer_load_dwordx4 a[140:143], v47, s[8:11], s40 offen offset:3072 sc1
    v_mfma_f32_32x32x16_bf16 v[124:139], v[88:91], a[92:95], v[124:139]
    ds_read_b128 v[68:71], v4 offset:50176
    v_mul_f32 v45, 0xbdd2d3e8, v75
    s_waitcnt lgkmcnt(2)
    s_waitcnt vmcnt(15)
    v_mfma_f32_32x32x16_bf16 v[92:107], v[48:51], a[96:99], v[92:107]
    ds_read_b128 v[84:87], v2 offset:59392
    v_mov_b32 v40, v72
    v_mfma_f32_32x32x16_bf16 v[108:123], v[52:55], a[96:99], v[108:123]
    ds_read_b128 v[88:91], v2 offset:63488
    buffer_load_dwordx4 a[144:147], v47, s[8:11], s41 offen offset:0 sc1
    v_mfma_f32_32x32x16_bf16 v[124:139], v[56:59], a[96:99], v[124:139]
    ds_read_b128 v[48:51], v4 offset:51200
    v_mov_b32 v41, v76
    s_waitcnt vmcnt(15)
    v_mfma_f32_32x32x16_bf16 v[92:107], v[60:63], a[100:103], v[92:107]
    ds_read_b128 v[52:55], v2 offset:60416
    buffer_load_dwordx4 a[148:151], v47, s[8:11], s41 offen offset:1024 sc1
    v_mov_b32 v42, v72
    s_waitcnt lgkmcnt(2)
    v_mfma_f32_32x32x16_bf16 v[108:123], v[64:67], a[100:103], v[108:123]
    ds_read_b128 v[56:59], v2 offset:64512
    v_mfma_f32_32x32x16_bf16 v[124:139], v[68:71], a[100:103], v[124:139]
    ds_read_b128 v[60:63], v4 offset:52224
    v_mov_b32 v43, v76
    s_waitcnt vmcnt(15)
    v_mfma_f32_32x32x16_bf16 v[92:107], v[84:87], a[104:107], v[92:107]
    ds_read_b128 v[64:67], v4 offset:0
    buffer_load_dwordx4 a[152:155], v47, s[8:11], s41 offen offset:2048 sc1
    v_mfma_f32_32x32x16_bf16 v[108:123], v[88:91], a[104:107], v[108:123]
    ds_read_b128 v[68:71], v4 offset:4096
    buffer_load_dword v19, off, s[4:7], s3 offset:2048 sc1
    s_waitcnt lgkmcnt(2)
    v_mfma_f32_32x32x16_bf16 v[124:139], v[48:51], a[104:107], v[124:139]
    ds_read_b128 v[84:87], v4 offset:53248
    buffer_load_dwordx4 a[156:159], v47, s[8:11], s41 offen offset:3072 sc1
    s_waitcnt vmcnt(16)
    v_mfma_f32_32x32x16_bf16 v[92:107], v[52:55], a[108:111], v[92:107]
    ds_read_b128 v[88:91], v4 offset:1024
    v_mfma_f32_32x32x16_bf16 v[108:123], v[56:59], a[108:111], v[108:123]
    ds_read_b128 v[48:51], v4 offset:5120
    v_mfma_f32_32x32x16_bf16 v[124:139], v[60:63], a[108:111], v[124:139]
    ds_read_b128 v[52:55], v4 offset:54272
    s_waitcnt lgkmcnt(2)
    s_waitcnt vmcnt(14)
    v_mfma_f32_32x32x16_bf16 v[92:107], v[64:67], a[112:115], v[92:107]
    ds_read_b128 v[56:59], v4 offset:2048
    v_mfma_f32_32x32x16_bf16 v[108:123], v[68:71], a[112:115], v[108:123]
    ds_read_b128 v[60:63], v4 offset:6144
    v_mfma_f32_32x32x16_bf16 v[124:139], v[84:87], a[112:115], v[124:139]
    ds_read_b128 v[64:67], v4 offset:55296
    s_waitcnt vmcnt(13)
    v_mfma_f32_32x32x16_bf16 v[92:107], v[88:91], a[116:119], v[92:107]
    ds_read_b128 v[68:71], v4 offset:3072
    s_waitcnt lgkmcnt(2)
    v_mfma_f32_32x32x16_bf16 v[108:123], v[48:51], a[116:119], v[108:123]
    ds_read_b128 v[84:87], v4 offset:7168
    v_mfma_f32_32x32x16_bf16 v[124:139], v[52:55], a[116:119], v[124:139]
    ds_read_b128 v[88:91], v4 offset:56320
    s_waitcnt vmcnt(11)
    v_mfma_f32_32x32x16_bf16 v[92:107], v[56:59], a[120:123], v[92:107]
    ds_read_b128 v[48:51], v4 offset:8192
    v_mfma_f32_32x32x16_bf16 v[108:123], v[60:63], a[120:123], v[108:123]
    ds_read_b128 v[52:55], v4 offset:9216
    s_waitcnt lgkmcnt(2)
    v_mfma_f32_32x32x16_bf16 v[124:139], v[64:67], a[120:123], v[124:139]
    ds_read_b128 v[56:59], v4 offset:10240
    s_waitcnt vmcnt(10)
    v_mfma_f32_32x32x16_bf16 v[92:107], v[68:71], a[124:127], v[92:107]
    ds_read_b128 v[60:63], v4 offset:11264
    v_mfma_f32_32x32x16_bf16 v[108:123], v[84:87], a[124:127], v[108:123]
    ds_read_b128 v[64:67], v4 offset:16384
    v_mfma_f32_32x32x16_bf16 v[124:139], v[88:91], a[124:127], v[124:139]
    ds_read_b128 v[68:71], v4 offset:17408
    s_barrier
    s_waitcnt lgkmcnt(2)
    s_waitcnt vmcnt(8)
    v_mfma_f32_32x32x16_bf16 v[92:107], v[48:51], a[128:131], v[92:107]
    ds_read_b128 v[84:87], v4 offset:18432
    s_add_u32 m0, s75, 16384
    s_nop 0
    buffer_load_dwordx4 v6, s[4:7], s34 offen sc1 lds
    s_waitcnt vmcnt(8)
    v_mfma_f32_32x32x16_bf16 v[92:107], v[52:55], a[132:135], v[92:107]
    ds_read_b128 v[88:91], v4 offset:19456
    s_waitcnt vmcnt(7)
    v_mfma_f32_32x32x16_bf16 v[92:107], v[56:59], a[136:139], v[92:107]
    ds_read_b128 v[48:51], v2 offset:0
    s_add_u32 m0, s75, 20480
    s_waitcnt vmcnt(6)
    v_mfma_f32_32x32x16_bf16 v[92:107], v[60:63], a[140:143], v[92:107]
    ds_read_b128 v[52:55], v4 offset:12288
    buffer_load_dwordx4 v6, s[4:7], s35 offen sc1 lds
    s_waitcnt vmcnt(3)
    v_readfirstlane_b32 s24, v19
    s_cmp_ge_u32 s24, 92
    s_cbranch_scc0 L_slow_17
L_ok_18:
    s_waitcnt lgkmcnt(2)
    v_mfma_f32_32x32x16_bf16 v[92:107], v[64:67], a[144:147], v[92:107]
    ds_read_b128 v[56:59], v4 offset:13312
    v_mov_b32 v80, -1
    v_mov_b32 v81, -1
    s_mov_b32 s30, 18874368
    s_mov_b64 exec, 0xffff
    buffer_store_dwordx2 v[80:81], v14, s[4:7], s30 offen sc1
    s_mov_b64 exec, -1
    v_mfma_f32_32x32x16_bf16 v[92:107], v[68:71], a[148:151], v[92:107]
    ds_read_b128 v[60:63], v4 offset:14336
    buffer_load_dwordx4 v[156:159], v16, s[4:7], s56 offen offset:0 sc1
    v_mfma_f32_32x32x16_bf16 v[92:107], v[84:87], a[152:155], v[92:107]
    ds_read_b128 v[64:67], v4 offset:15360
    buffer_load_dwordx4 v[160:163], v16, s[4:7], s56 offen offset:1024 sc1
    s_add_u32 m0, s75, 24576
    s_waitcnt vmcnt(5)
    v_mfma_f32_32x32x16_bf16 v[92:107], v[88:91], a[156:159], v[92:107]
    ds_read_b128 v[68:71], v4 offset:20480
    buffer_load_dwordx4 v6, s[4:7], s36 offen sc1 lds
    s_waitcnt lgkmcnt(2)
    v_mfma_f32_32x32x16_bf16 v[92:107], v[48:51], v[40:43], v[92:107]
    ds_read_b128 v[84:87], v4 offset:21504
    buffer_load_dwordx4 v[164:167], v16, s[4:7], s56 offen offset:2048 sc1
    v_mfma_f32_32x32x16_bf16 v[108:123], v[52:55], a[128:131], v[108:123]
    ds_read_b128 v[88:91], v4 offset:22528
    s_add_u32 m0, s75, 28672
    v_mfma_f32_32x32x16_bf16 v[108:123], v[56:59], a[132:135], v[108:123]
    ds_read_b128 v[48:51], v4 offset:23552
    buffer_load_dwordx4 v6, s[4:7], s37 offen sc1 lds
    v_mfma_f32_32x32x16_bf16 v[108:123], v[60:63], a[136:139], v[108:123]
    ds_read_b128 v[52:55], v2 offset:1024
    buffer_load_dwordx4 v[168:171], v16, s[4:7], s56 offen offset:3072 sc1
    s_waitcnt lgkmcnt(2)
    v_mfma_f32_32x32x16_bf16 v[108:123], v[64:67], a[140:143], v[108:123]
    ds_read_b128 v[56:59], v4 offset:57344
    v_mul_f32 v72, v92, v92
    v_mul_f32 v73, v93, v93
    v_fma_f32 v72, v72, v45, v44
    v_fma_f32 v73, v73, v45, v44
    v_mfma_f32_32x32x16_bf16 v[108:123], v[68:71], a[144:147], v[108:123]
    ds_read_b128 v[60:63], v4 offset:58368
    v_mul_f32 v72, v72, v92
    v_mul_f32 v73, v73, v93
    v_exp_f32 v72, v72
    v_mfma_f32_32x32x16_bf16 v[108:123], v[84:87], a[148:151], v[108:123]
    ds_read_b128 v[64:67], v4 offset:59392
    v_exp_f32 v73, v73
    v_mul_f32 v100, v92, v100
    v_fma_f32 v72, v72, v46, v46
    v_mfma_f32_32x32x16_bf16 v[108:123], v[88:91], a[152:155], v[108:123]
    ds_read_b128 v[68:71], v4 offset:60416
    v_fma_f32 v73, v73, v46, v46
    v_rcp_f32 v72, v72
    s_waitcnt lgkmcnt(2)
    v_mfma_f32_32x32x16_bf16 v[108:123], v[48:51], a[156:159], v[108:123]
    ds_read_b128 v[84:87], v4 offset:61440
    buffer_load_dwordx4 v[172:175], v12, s[4:7], s56 offen offset:0 sc1
    v_mfma_f32_32x32x16_bf16 v[108:123], v[52:55], v[40:43], v[108:123]
    ds_read_b128 v[88:91], v4 offset:62464
    v_rcp_f32 v73, v73
    v_mul_f32 v101, v93, v101
    v_mul_f32 v100, v100, v72
    v_mfma_f32_32x32x16_bf16 v[124:139], v[56:59], a[128:131], v[124:139]
    ds_read_b128 v[48:51], v4 offset:63488
    v_mul_f32 v101, v101, v73
    v_cvt_pk_bf16_f32 v76, v100, v101
    v_mul_f32 v74, v94, v94
    v_mul_f32 v75, v95, v95
    v_mfma_f32_32x32x16_bf16 v[124:139], v[60:63], a[132:135], v[124:139]
    ds_read_b128 v[52:55], v4 offset:64512
    v_fma_f32 v74, v74, v45, v44
    v_fma_f32 v75, v75, v45, v44
    v_mul_f32 v74, v74, v94
    s_waitcnt lgkmcnt(2)
    v_mfma_f32_32x32x16_bf16 v[124:139], v[64:67], a[136:139], v[124:139]
    ds_read_b128 v[56:59], v2 offset:2048
    v_mul_f32 v75, v75, v95
    s_barrier
    v_mfma_f32_32x32x16_bf16 v[124:139], v[68:71], a[140:143], v[124:139]
    ds_read_b128 v[60:63], v5 offset:0
    buffer_load_dwordx4 v[176:179], v16, s[4:7], s57 offen offset:0 sc1
    v_mfma_f32_32x32x16_bf16 v[124:139], v[84:87], a[144:147], v[124:139]
    ds_read_b128 v[64:67], v5 offset:1024
    v_exp_f32 v74, v74
    v_exp_f32 v75, v75
    v_mfma_f32_32x32x16_bf16 v[124:139], v[88:91], a[148:151], v[124:139]
    ds_read_b128 v[68:71], v5 offset:2048
    v_mul_f32 v102, v94, v102
    v_fma_f32 v74, v74, v46, v46
    v_fma_f32 v75, v75, v46, v46
    s_waitcnt lgkmcnt(2)
    v_mfma_f32_32x32x16_bf16 v[124:139], v[48:51], a[152:155], v[124:139]
    ds_read_b128 v[84:87], v5 offset:3072
    v_rcp_f32 v74, v74
    v_rcp_f32 v75, v75
    v_mfma_f32_32x32x16_bf16 v[124:139], v[52:55], a[156:159], v[124:139]
    ds_read_b128 v[88:91], v5 offset:4096
    buffer_load_dwordx4 v[180:183], v16, s[4:7], s57 offen offset:1024 sc1
    v_mul_f32 v103, v95, v103
    v_mfma_f32_32x32x16_bf16 v[124:139], v[56:59], v[40:43], v[124:139]
    ds_read_b128 v[48:51], v5 offset:5120
    v_mul_f32 v102, v102, v74
    v_mul_f32 v103, v103, v75
    v_cvt_pk_bf16_f32 v77, v102, v103
    v_mul_f32 v72, v96, v96
    v_mfma_f32_32x32x16_bf16 v[140:155], v[60:63], a[0:3], 0
    ds_read_b128 v[52:55], v5 offset:6144
    v_mul_f32 v73, v97, v97
    v_fma_f32 v72, v72, v45, v44
    v_fma_f32 v73, v73, v45, v44
    s_waitcnt lgkmcnt(2)
    v_mfma_f32_32x32x16_bf16 v[140:155], v[64:67], a[4:7], v[140:155]
    ds_read_b128 v[56:59], v5 offset:7168
    buffer_load_dwordx4 v[184:187], v16, s[4:7], s57 offen offset:2048 sc1
    v_mul_f32 v72, v72, v96
    v_mfma_f32_32x32x16_bf16 v[140:155], v[68:71], a[8:11], v[140:155]
    ds_read_b128 v[60:63], v5 offset:8192
    v_mul_f32 v73, v73, v97
    v_exp_f32 v72, v72
    v_mfma_f32_32x32x16_bf16 v[140:155], v[84:87], a[12:15], v[140:155]
    ds_read_b128 v[64:67], v5 offset:9216
    v_exp_f32 v73, v73
    v_mul_f32 v104, v96, v104
    v_fma_f32 v72, v72, v46, v46
    v_mfma_f32_32x32x16_bf16 v[140:155], v[88:91], a[16:19], v[140:155]
    ds_read_b128 v[68:71], v5 offset:10240
    v_fma_f32 v73, v73, v46, v46
    v_rcp_f32 v72, v72
    s_waitcnt lgkmcnt(2)
    v_mfma_f32_32x32x16_bf16 v[140:155], v[48:51], a[20:23], v[140:155]
    ds_read_b128 v[84:87], v5 offset:11264
    buffer_load_dwordx4 v[188:191], v16, s[4:7], s57 offen offset:3072 sc1
    v_mfma_f32_32x32x16_bf16 v[140:155], v[52:55], a[24:27], v[140:155]
    ds_read_b128 v[88:91], v5 offset:12288
    v_rcp_f32 v73, v73
    v_mul_f32 v105, v97, v105
    v_mul_f32 v104, v104, v72
    v_mfma_f32_32x32x16_bf16 v[140:155], v[56:59], a[28:31], v[140:155]
    ds_read_b128 v[48:51], v5 offset:13312
    v_mul_f32 v105, v105, v73
    v_cvt_pk_bf16_f32 v78, v104, v105
    v_mul_f32 v74, v98, v98
    v_mul_f32 v75, v99, v99
    v_mfma_f32_32x32x16_bf16 v[140:155], v[60:63], a[32:35], v[140:155]
    ds_read_b128 v[52:55], v5 offset:14336
    v_fma_f32 v74, v74, v45, v44
    buffer_load_dwordx4 v[192:195], v12, s[4:7], s57 offen offset:0 sc1
    s_waitcnt lgkmcnt(2)
    v_mfma_f32_32x32x16_bf16 v[140:155], v[64:67], a[36:39], v[140:155]
    ds_read_b128 v[56:59], v5 offset:15360
    v_fma_f32 v75, v75, v45, v44
    v_mul_f32 v74, v74, v98
    v_mul_f32 v75, v75, v99
    v_mul_f32 v72, v108, v108
    v_mfma_f32_32x32x16_bf16 v[140:155], v[68:71], a[40:43], v[140:155]
    ds_read_b128 v[60:63], v5 offset:16384
    v_exp_f32 v74, v74
    v_exp_f32 v75, v75
    v_mfma_f32_32x32x16_bf16 v[140:155], v[84:87], a[44:47], v[140:155]
    ds_read_b128 v[64:67], v5 offset:17408
    v_mul_f32 v106, v98, v106
    v_fma_f32 v74, v74, v46, v46
    v_fma_f32 v75, v75, v46, v46
    v_mul_f32 v73, v109, v109
    v_mfma_f32_32x32x16_bf16 v[140:155], v[88:91], a[48:51], v[140:155]
    ds_read_b128 v[68:71], v5 offset:18432
    v_rcp_f32 v74, v74
    buffer_load_dwordx4 v[196:199], v16, s[4:7], s58 offen offset:0 sc1
    s_waitcnt lgkmcnt(2)
    v_mfma_f32_32x32x16_bf16 v[140:155], v[48:51], a[52:55], v[140:155]
    ds_read_b128 v[84:87], v5 offset:19456
    v_rcp_f32 v75, v75
    v_mul_f32 v107, v99, v107
    v_mul_f32 v106, v106, v74
    v_mfma_f32_32x32x16_bf16 v[140:155], v[52:55], a[56:59], v[140:155]
    ds_read_b128 v[88:91], v5 offset:20480
    v_mul_f32 v107, v107, v75
    v_cvt_pk_bf16_f32 v79, v106, v107
    buffer_store_dwordx4 v[76:79], v7, s[8:11], s49 offen sc1
    v_mfma_f32_32x32x16_bf16 v[140:155], v[56:59], a[60:63], v[140:155]
    ds_read_b128 v[48:51], v5 offset:21504
    v_fma_f32 v72, v72, v45, v44
    buffer_load_dwordx4 v[200:203], v16, s[4:7], s58 offen offset:1024 sc1
    v_fma_f32 v73, v73, v45, v44
    v_mfma_f32_32x32x16_bf16 v[140:155], v[60:63], a[64:67], v[140:155]
    ds_read_b128 v[52:55], v5 offset:22528
    v_mul_f32 v72, v72, v108
    v_mul_f32 v73, v73, v109
    v_exp_f32 v72, v72
    s_waitcnt lgkmcnt(2)
    v_mfma_f32_32x32x16_bf16 v[140:155], v[64:67], a[68:71], v[140:155]
    ds_read_b128 v[56:59], v5 offset:23552
    v_exp_f32 v73, v73
    v_mul_f32 v116, v108, v116
    v_fma_f32 v72, v72, v46, v46
    v_mfma_f32_32x32x16_bf16 v[140:155], v[68:71], a[72:75], v[140:155]
    ds_read_b128 v[60:63], v5 offset:24576
    v_fma_f32 v73, v73, v46, v46
    buffer_load_dwordx4 v[204:207], v16, s[4:7], s58 offen offset:2048 sc1
    v_rcp_f32 v72, v72
    v_mfma_f32_32x32x16_bf16 v[140:155], v[84:87], a[76:79], v[140:155]
    ds_read_b128 v[64:67], v5 offset:25600
    v_rcp_f32 v73, v73
    v_mul_f32 v117, v109, v117
    s_barrier
    v_mfma_f32_32x32x16_bf16 v[140:155], v[88:91], a[80:83], v[140:155]
    ds_read_b128 v[68:71], v5 offset:26624
    v_mul_f32 v116, v116, v72
    v_mul_f32 v117, v117, v73
    v_cvt_pk_bf16_f32 v80, v116, v117
    s_waitcnt lgkmcnt(2)
    v_mfma_f32_32x32x16_bf16 v[140:155], v[48:51], a[84:87], v[140:155]
    ds_read_b128 v[84:87], v5 offset:27648
    v_mul_f32 v74, v110, v110
    v_mul_f32 v75, v111, v111
    buffer_load_dwordx4 v[208:211], v16, s[4:7], s58 offen offset:3072 sc1
    v_fma_f32 v74, v74, v45, v44
    v_mfma_f32_32x32x16_bf16 v[140:155], v[52:55], a[88:91], v[140:155]
    ds_read_b128 v[88:91], v5 offset:28672
    v_fma_f32 v75, v75, v45, v44
    v_mul_f32 v74, v74, v110
    v_mul_f32 v75, v75, v111
    v_exp_f32 v74, v74
    v_mfma_f32_32x32x16_bf16 v[140:155], v[56:59], a[92:95], v[140:155]
    ds_read_b128 v[48:51], v5 offset:29696
    v_exp_f32 v75, v75
    v_mul_f32 v118, v110, v118
    v_fma_f32 v74, v74, v46, v46
    v_mfma_f32_32x32x16_bf16 v[140:155], v[60:63], a[96:99], v[140:155]
    ds_read_b128 v[52:55], v5 offset:30720
    v_fma_f32 v75, v75, v46, v46
    buffer_load_dwordx4 v[212:215], v12, s[4:7], s58 offen offset:0 sc1
    v_rcp_f32 v74, v74
    s_waitcnt lgkmcnt(2)
    v_mfma_f32_32x32x16_bf16 v[140:155], v[64:67], a[100:103], v[140:155]
    ds_read_b128 v[56:59], v5 offset:31744
    v_rcp_f32 v75, v75
    s_add_u32 m0, s75, 32768
    v_mul_f32 v119, v111, v119
    v_mfma_f32_32x32x16_bf16 v[140:155], v[68:71], a[104:107], v[140:155]
    ds_read_b128 v[60:63], v4 offset:24576
    v_mul_f32 v118, v118, v74
    v_mul_f32 v119, v119, v75
    buffer_load_dwordx4 v6, s[4:7], s38 offen sc1 lds
    v_mfma_f32_32x32x16_bf16 v[140:155], v[84:87], a[108:111], v[140:155]
    ds_read_b128 v[64:67], v4 offset:25600
    v_cvt_pk_bf16_f32 v81, v118, v119
    v_mul_f32 v72, v112, v112
    v_mul_f32 v73, v113, v113
    buffer_load_dwordx4 v[216:219], v16, s[4:7], s59 offen offset:0 sc1
    v_fma_f32 v72, v72, v45, v44
    v_mfma_f32_32x32x16_bf16 v[140:155], v[88:91], a[112:115], v[140:155]
    ds_read_b128 v[68:71], v4 offset:26624
    v_fma_f32 v73, v73, v45, v44
    v_mul_f32 v72, v72, v112
    v_mul_f32 v73, v73, v113
    s_waitcnt lgkmcnt(2)
    v_mfma_f32_32x32x16_bf16 v[140:155], v[48:51], a[116:119], v[140:155]
    ds_read_b128 v[84:87], v4 offset:27648
    v_exp_f32 v72, v72
    s_add_u32 m0, s75, 36864
    v_exp_f32 v73, v73
    v_mfma_f32_32x32x16_bf16 v[140:155], v[52:55], a[120:123], v[140:155]
    ds_read_b128 v[88:91], v4 offset:28672
    v_mul_f32 v120, v112, v120
    buffer_load_dwordx4 v6, s[4:7], s39 offen sc1 lds
    v_fma_f32 v72, v72, v46, v46
    buffer_load_dwordx4 v[220:223], v16, s[4:7], s59 offen offset:1024 sc1
    v_fma_f32 v73, v73, v46, v46
    v_mfma_f32_32x32x16_bf16 v[140:155], v[56:59], a[124:127], v[140:155]
    ds_read_b128 v[48:51], v4 offset:29696
    v_rcp_f32 v72, v72
    v_rcp_f32 v73, v73
    v_mfma_f32_32x32x16_bf16 v[140:155], v[60:63], a[128:131], v[140:155]
    ds_read_b128 v[52:55], v4 offset:30720
    v_mul_f32 v121, v113, v121
    v_mul_f32 v120, v120, v72
    v_mul_f32 v121, v121, v73
    s_waitcnt lgkmcnt(2)
    v_mfma_f32_32x32x16_bf16 v[140:155], v[64:67], a[132:135], v[140:155]
    ds_read_b128 v[56:59], v4 offset:31744
    s_add_u32 m0, s75, 40960
    v_cvt_pk_bf16_f32 v82, v120, v121
    v_mul_f32 v74, v114, v114
    buffer_load_dwordx4 v[224:227], v16, s[4:7], s59 offen offset:2048 sc1
    v_mul_f32 v75, v115, v115
    buffer_load_dwordx4 v6, s[4:7], s40 offen sc1 lds
    v_mfma_f32_32x32x16_bf16 v[140:155], v[68:71], a[136:139], v[140:155]
    ds_read_b128 v[60:63], v2 offset:3072
    v_fma_f32 v74, v74, v45, v44
    v_fma_f32 v75, v75, v45, v44
    v_mul_f32 v74, v74, v114
    v_mul_f32 v75, v75, v115
    v_mfma_f32_32x32x16_bf16 v[140:155], v[84:87], a[140:143], v[140:155]
    ds_read_b128 v[64:67], v4 offset:32768
    v_exp_f32 v74, v74
    v_exp_f32 v75, v75
    v_mfma_f32_32x32x16_bf16 v[140:155], v[88:91], a[144:147], v[140:155]
    ds_read_b128 v[68:71], v4 offset:33792
    v_mul_f32 v122, v114, v122
    buffer_load_dwordx4 v[228:231], v16, s[4:7], s59 offen offset:3072 sc1
    v_fma_f32 v74, v74, v46, v46
    s_add_u32 m0, s75, 45056
    v_fma_f32 v75, v75, v46, v46
    s_waitcnt lgkmcnt(2)
    v_mfma_f32_32x32x16_bf16 v[140:155], v[48:51], a[148:151], v[140:155]
    ds_read_b128 v[84:87], v4 offset:34816
    v_rcp_f32 v74, v74
    buffer_load_dwordx4 v6, s[4:7], s41 offen sc1 lds
    v_rcp_f32 v75, v75
    v_mfma_f32_32x32x16_bf16 v[140:155], v[52:55], a[152:155], v[140:155]
    ds_read_b128 v[88:91], v4 offset:35840
    v_mul_f32 v123, v115, v123
    v_mul_f32 v122, v122, v74
    v_mul_f32 v123, v123, v75
    v_cvt_pk_bf16_f32 v83, v122, v123
    v_mfma_f32_32x32x16_bf16 v[140:155], v[56:59], a[156:159], v[140:155]
    ds_read_b128 v[48:51], v4 offset:36864
    buffer_store_dwordx4 v[80:83], v7, s[8:11], s50 offen sc1
    buffer_load_dwordx4 v[232:235], v12, s[4:7], s59 offen offset:0 sc1
    v_mul_f32 v72, v124, v124
    v_mfma_f32_32x32x16_bf16 v[140:155], v[60:63], v[40:43], v[140:155]
    ds_read_b128 v[52:55], v4 offset:37888
    v_mul_f32 v73, v125, v125
    v_add_u32 v6, s47, v3
    v_fma_f32 v72, v72, v45, v44
    v_fma_f32 v73, v73, v45, v44
    s_waitcnt vmcnt(9)
    s_barrier
    s_waitcnt lgkmcnt(2)
    v_mfma_f32_32x32x16_bf16 v[92:107], v[64:67], a[0:3], 0
    ds_read_b128 v[56:59], v4 offset:38912
    v_mul_f32 v72, v72, v124
    s_add_u32 m0, s75, 49152
    v_mul_f32 v73, v73, v125
    v_exp_f32 v72, v72
    v_mfma_f32_32x32x16_bf16 v[92:107], v[68:71], a[4:7], v[92:107]
    ds_read_b128 v[60:63], v4 offset:39936
    buffer_load_dwordx4 v6, s[4:7], s32 offen sc1 lds
    v_exp_f32 v73, v73
    buffer_load_dwordx4 v[236:239], v16, s[4:7], s60 offen offset:0 sc1
    v_mul_f32 v132, v124, v132
    v_mfma_f32_32x32x16_bf16 v[92:107], v[84:87], a[8:11], v[92:107]
    ds_read_b128 v[64:67], v4 offset:40960
    v_fma_f32 v72, v72, v46, v46
    v_fma_f32 v73, v73, v46, v46
    v_rcp_f32 v72, v72
    v_mfma_f32_32x32x16_bf16 v[92:107], v[88:91], a[12:15], v[92:107]
    ds_read_b128 v[68:71], v4 offset:41984
    v_rcp_f32 v73, v73
    v_mul_f32 v133, v125, v133
    s_add_u32 m0, s75, 53248
    s_waitcnt lgkmcnt(2)
    v_mfma_f32_32x32x16_bf16 v[92:107], v[48:51], a[16:19], v[92:107]
    ds_read_b128 v[84:87], v4 offset:43008
    v_mul_f32 v132, v132, v72
    v_mul_f32 v133, v133, v73
    buffer_load_dwordx4 v[240:243], v16, s[4:7], s60 offen offset:1024 sc1
    v_cvt_pk_bf16_f32 v76, v132, v133
    buffer_load_dwordx4 v6, s[4:7], s33 offen sc1 lds
    v_mfma_f32_32x32x16_bf16 v[92:107], v[52:55], a[20:23], v[92:107]
    ds_read_b128 v[88:91], v4 offset:44032
    v_mul_f32 v74, v126, v126
    v_mul_f32 v75, v127, v127
    v_fma_f32 v74, v74, v45, v44
    v_fma_f32 v75, v75, v45, v44
    v_mfma_f32_32x32x16_bf16 v[92:107], v[56:59], a[24:27], v[92:107]
    ds_read_b128 v[48:51], v4 offset:45056
    v_mul_f32 v74, v74, v126
    v_mul_f32 v75, v75, v127
    v_exp_f32 v74, v74
    v_mfma_f32_32x32x16_bf16 v[92:107], v[60:63], a[28:31], v[92:107]
    ds_read_b128 v[52:55], v4 offset:46080
    v_exp_f32 v75, v75
    s_add_u32 m0, s75, 57344
    buffer_load_dwordx4 v[244:247], v16, s[4:7], s60 offen offset:2048 sc1
    v_mul_f32 v134, v126, v134
    s_waitcnt lgkmcnt(2)
    v_mfma_f32_32x32x16_bf16 v[92:107], v[64:67], a[32:35], v[92:107]
    ds_read_b128 v[56:59], v4 offset:47104
    v_fma_f32 v74, v74, v46, v46
    buffer_load_dwordx4 v6, s[4:7], s34 offen sc1 lds
    v_fma_f32 v75, v75, v46, v46
    v_rcp_f32 v74, v74
    v_mfma_f32_32x32x16_bf16 v[92:107], v[68:71], a[36:39], v[92:107]
    ds_read_b128 v[60:63], v4 offset:48128
    v_rcp_f32 v75, v75
    v_mul_f32 v135, v127, v135
    v_mul_f32 v134, v134, v74
    v_mfma_f32_32x32x16_bf16 v[92:107], v[84:87], a[40:43], v[92:107]
    ds_read_b128 v[64:67], v4 offset:49152
    buffer_load_dwordx4 v[248:251], v16, s[4:7], s60 offen offset:3072 sc1
    v_mul_f32 v135, v135, v75
    v_cvt_pk_bf16_f32 v77, v134, v135
    v_mfma_f32_32x32x16_bf16 v[92:107], v[88:91], a[44:47], v[92:107]
    ds_read_b128 v[68:71], v4 offset:50176
    s_add_u32 m0, s75, 61440
    v_mul_f32 v72, v128, v128
    v_mul_f32 v73, v129, v129
    v_fma_f32 v72, v72, v45, v44
    buffer_load_dwordx4 v6, s[4:7], s35 offen sc1 lds
    s_waitcnt lgkmcnt(2)
    v_mfma_f32_32x32x16_bf16 v[92:107], v[48:51], a[48:51], v[92:107]
    ds_read_b128 v[84:87], v4 offset:51200
    v_fma_f32 v73, v73, v45, v44
    v_mul_f32 v72, v72, v128
    v_mul_f32 v73, v73, v129
    v_exp_f32 v72, v72
    v_mfma_f32_32x32x16_bf16 v[92:107], v[52:55], a[52:55], v[92:107]
    ds_read_b128 v[88:91], v4 offset:52224
    v_exp_f32 v73, v73
    buffer_load_dwordx4 v[252:255], v12, s[4:7], s60 offen offset:0 sc1
    v_mfma_f32_32x32x16_bf16 v[92:107], v[56:59], a[56:59], v[92:107]
    ds_read_b128 v[48:51], v4 offset:53248
    v_mul_f32 v136, v128, v136
    v_fma_f32 v72, v72, v46, v46
    v_fma_f32 v73, v73, v46, v46
    s_add_u32 m0, s75, 65536
    v_rcp_f32 v72, v72
    v_mfma_f32_32x32x16_bf16 v[92:107], v[60:63], a[60:63], v[92:107]
    ds_read_b128 v[52:55], v4 offset:54272
    v_rcp_f32 v73, v73
    buffer_load_dwordx4 v6, s[4:7], s36 offen sc1 lds
    s_waitcnt lgkmcnt(2)
    v_mfma_f32_32x32x16_bf16 v[92:107], v[64:67], a[64:67], v[92:107]
    ds_read_b128 v[56:59], v4 offset:55296
    v_mul_f32 v137, v129, v137
    v_mul_f32 v136, v136, v72
    buffer_load_dwordx4 a[160:163], v16, s[4:7], s61 offen offset:0 sc1
    v_mul_f32 v137, v137, v73
    v_cvt_pk_bf16_f32 v78, v136, v137
    v_mfma_f32_32x32x16_bf16 v[92:107], v[68:71], a[68:71], v[92:107]
    ds_read_b128 v[60:63], v4 offset:56320
    v_mul_f32 v74, v130, v130
    v_mul_f32 v75, v131, v131
    v_fma_f32 v74, v74, v45, v44
    v_fma_f32 v75, v75, v45, v44
    v_mfma_f32_32x32x16_bf16 v[92:107], v[84:87], a[72:75], v[92:107]
    ds_read_b128 v[64:67], v4 offset:57344
    s_add_u32 m0, s75, 69632
    v_mul_f32 v74, v74, v130
    v_mul_f32 v75, v75, v131
    v_exp_f32 v74, v74
    v_mfma_f32_32x32x16_bf16 v[92:107], v[88:91], a[76:79], v[92:107]
    ds_read_b128 v[68:71], v4 offset:58368
    buffer_load_dwordx4 v6, s[4:7], s37 offen sc1 lds
    buffer_load_dwordx4 a[164:167], v16, s[4:7], s61 offen offset:1024 sc1
    v_exp_f32 v75, v75
    s_waitcnt vmcnt(9)
    s_barrier
    s_waitcnt lgkmcnt(2)
    v_mfma_f32_32x32x16_bf16 v[92:107], v[48:51], a[80:83], v[92:107]
    ds_read_b128 v[84:87], v4 offset:59392
    v_mul_f32 v138, v130, v138
    v_fma_f32 v74, v74, v46, v46
    v_fma_f32 v75, v75, v46, v46
    v_rcp_f32 v74, v74
    v_mfma_f32_32x32x16_bf16 v[92:107], v[52:55], a[84:87], v[92:107]
    ds_read_b128 v[88:91], v4 offset:60416
    v_rcp_f32 v75, v75
    s_add_u32 m0, s75, 0
    v_mul_f32 v139, v131, v139
    v_mfma_f32_32x32x16_bf16 v[92:107], v[56:59], a[88:91], v[92:107]
    ds_read_b128 v[48:51], v4 offset:61440
    v_mul_f32 v138, v138, v74
    buffer_load_dwordx4 a[168:171], v16, s[4:7], s61 offen offset:2048 sc1
    buffer_load_dwordx4 v6, s[4:7], s38 offen sc1 lds
    v_mul_f32 v139, v139, v75
    v_cvt_pk_bf16_f32 v79, v138, v139
    v_mfma_f32_32x32x16_bf16 v[92:107], v[60:63], a[92:95], v[92:107]
    ds_read_b128 v[52:55], v4 offset:62464
    buffer_store_dwordx4 v[76:79], v7, s[8:11], s51 offen sc1
    v_mul_f32 v72, v140, v140
    s_waitcnt lgkmcnt(2)
    v_mfma_f32_32x32x16_bf16 v[92:107], v[64:67], a[96:99], v[92:107]
    ds_read_b128 v[56:59], v4 offset:63488
    v_mul_f32 v73, v141, v141
    v_fma_f32 v72, v72, v45, v44
    v_fma_f32 v73, v73, v45, v44
    v_mul_f32 v72, v72, v140
    v_mfma_f32_32x32x16_bf16 v[92:107], v[68:71], a[100:103], v[92:107]
    ds_read_b128 v[60:63], v4 offset:64512
    s_add_u32 m0, s75, 4096
    buffer_load_dwordx4 a[172:175], v16, s[4:7], s61 offen offset:3072 sc1
    v_mul_f32 v73, v73, v141
    v_exp_f32 v72, v72
    v_mfma_f32_32x32x16_bf16 v[92:107], v[84:87], a[104:107], v[92:107]
    ds_read_b128 v[64:67], v5 offset:0
    buffer_load_dwordx4 v6, s[4:7], s39 offen sc1 lds
    v_exp_f32 v73, v73
    v_mfma_f32_32x32x16_bf16 v[92:107], v[88:91], a[108:111], v[92:107]
    ds_read_b128 v[68:71], v5 offset:1024
    v_mul_f32 v148, v140, v148
    v_fma_f32 v72, v72, v46, v46
    v_fma_f32 v73, v73, v46, v46
    s_waitcnt lgkmcnt(2)
    v_mfma_f32_32x32x16_bf16 v[92:107], v[48:51], a[112:115], v[92:107]
    ds_read_b128 v[84:87], v5 offset:2048
    v_rcp_f32 v72, v72
    buffer_load_dwordx4 a[176:179], v12, s[4:7], s61 offen offset:0 sc1
    v_rcp_f32 v73, v73
    s_add_u32 m0, s75, 8192
    v_mfma_f32_32x32x16_bf16 v[92:107], v[52:55], a[116:119], v[92:107]
    ds_read_b128 v[88:91], v5 offset:3072
    v_mul_f32 v149, v141, v149
    buffer_load_dwordx4 v6, s[4:7], s40 offen sc1 lds
    v_mul_f32 v148, v148, v72
    v_mfma_f32_32x32x16_bf16 v[92:107], v[56:59], a[120:123], v[92:107]
    ds_read_b128 v[48:51], v5 offset:4096
    v_mul_f32 v149, v149, v73
    v_cvt_pk_bf16_f32 v80, v148, v149
    v_mul_f32 v74, v142, v142
    v_mul_f32 v75, v143, v143
    v_mfma_f32_32x32x16_bf16 v[92:107], v[60:63], a[124:127], v[92:107]
    ds_read_b128 v[52:55], v5 offset:5120
    buffer_load_dwordx4 a[180:183], v16, s[4:7], s62 offen offset:0 sc1
    v_fma_f32 v74, v74, v45, v44
    v_fma_f32 v75, v75, v45, v44
    s_waitcnt lgkmcnt(2)
    v_mfma_f32_32x32x16_bf16 v[92:107], v[64:67], a[128:131], v[92:107]
    ds_read_b128 v[56:59], v5 offset:6144
    v_mul_f32 v74, v74, v142
    v_mul_f32 v75, v75, v143
    s_add_u32 m0, s75, 12288
    v_exp_f32 v74, v74
    v_mfma_f32_32x32x16_bf16 v[92:107], v[68:71], a[132:135], v[92:107]
    ds_read_b128 v[60:63], v5 offset:7168
    v_exp_f32 v75, v75
    buffer_load_dwordx4 v6, s[4:7], s41 offen sc1 lds
    v_mfma_f32_32x32x16_bf16 v[92:107], v[84:87], a[136:139], v[92:107]
    ds_read_b128 v[64:67], v2 offset:4096
    v_mul_f32 v150, v142, v150
    v_fma_f32 v74, v74, v46, v46
    buffer_load_dwordx4 a[184:187], v16, s[4:7], s62 offen offset:1024 sc1
    v_fma_f32 v75, v75, v46, v46
    v_mfma_f32_32x32x16_bf16 v[92:107], v[88:91], a[140:143], v[92:107]
    ds_read_b128 v[68:71], v5 offset:8192
    v_rcp_f32 v74, v74
    v_rcp_f32 v75, v75
    s_waitcnt lgkmcnt(2)
    v_mfma_f32_32x32x16_bf16 v[92:107], v[48:51], a[144:147], v[92:107]
    ds_read_b128 v[84:87], v5 offset:9216
    v_add_u32 v6, s48, v3
    v_mul_f32 v151, v143, v151
    v_mul_f32 v150, v150, v74
    v_mul_f32 v151, v151, v75
    v_mfma_f32_32x32x16_bf16 v[92:107], v[52:55], a[148:151], v[92:107]
    ds_read_b128 v[88:91], v5 offset:10240
    s_add_u32 m0, s75, 16384
    v_cvt_pk_bf16_f32 v81, v150, v151
    buffer_load_dwordx4 a[188:191], v16, s[4:7], s62 offen offset:2048 sc1
    v_mul_f32 v72, v144, v144
    v_mul_f32 v73, v145, v145
    v_mfma_f32_32x32x16_bf16 v[92:107], v[56:59], a[152:155], v[92:107]
    ds_read_b128 v[48:51], v5 offset:11264
    buffer_load_dwordx4 v6, s[4:7], s32 offen sc1 lds
    v_fma_f32 v72, v72, v45, v44
    v_fma_f32 v73, v73, v45, v44
    v_mul_f32 v72, v72, v144
    v_mfma_f32_32x32x16_bf16 v[92:107], v[60:63], a[156:159], v[92:107]
    ds_read_b128 v[52:55], v5 offset:12288
    v_mul_f32 v73, v73, v145
    v_exp_f32 v72, v72
    s_waitcnt lgkmcnt(2)
    v_mfma_f32_32x32x16_bf16 v[92:107], v[64:67], v[40:43], v[92:107]
    ds_read_b128 v[56:59], v5 offset:13312
    v_exp_f32 v73, v73
    buffer_load_dwordx4 a[192:195], v16, s[4:7], s62 offen offset:3072 sc1
    s_add_u32 m0, s75, 20480
    v_mul_f32 v152, v144, v152
    s_waitcnt vmcnt(11)
    s_waitcnt vmcnt(10)
    s_barrier
    s_cmp_lg_u32 s20, 0
    s_cbranch_scc1 L_sig_19
    s_mov_b64 exec, 1
    buffer_atomic_add v18, off, s[4:7], s74 offset:256 sc1
    s_mov_b64 exec, -1
L_sig_19:
    v_mfma_f32_32x32x16_bf16 v[108:123], v[68:71], a[0:3], 0
    ds_read_b128 v[60:63], v5 offset:14336
    v_fma_f32 v72, v72, v46, v46
    v_fma_f32 v73, v73, v46, v46
    buffer_load_dwordx4 v6, s[4:7], s33 offen sc1 lds
    v_rcp_f32 v72, v72
    v_mfma_f32_32x32x16_bf16 v[108:123], v[84:87], a[4:7], v[108:123]
    ds_read_b128 v[64:67], v5 offset:15360
    v_rcp_f32 v73, v73
    v_mul_f32 v153, v145, v153
    v_mul_f32 v152, v152, v72
    v_mfma_f32_32x32x16_bf16 v[108:123], v[88:91], a[8:11], v[108:123]
    ds_read_b128 v[68:71], v5 offset:16384
    buffer_load_dwordx4 a[196:199], v12, s[4:7], s62 offen offset:0 sc1
    v_mul_f32 v153, v153, v73
    s_waitcnt lgkmcnt(2)
    v_mfma_f32_32x32x16_bf16 v[108:123], v[48:51], a[12:15], v[108:123]
    ds_read_b128 v[84:87], v5 offset:17408
    v_cvt_pk_bf16_f32 v82, v152, v153
    v_mul_f32 v74, v146, v146
    s_add_u32 m0, s75, 24576
    v_mul_f32 v75, v147, v147
    v_mfma_f32_32x32x16_bf16 v[108:123], v[52:55], a[16:19], v[108:123]
    ds_read_b128 v[88:91], v5 offset:18432
    v_fma_f32 v74, v74, v45, v44
    buffer_load_dwordx4 v6, s[4:7], s34 offen sc1 lds
    v_fma_f32 v75, v75, v45, v44
    v_mul_f32 v74, v74, v146
    v_mfma_f32_32x32x16_bf16 v[108:123], v[56:59], a[20:23], v[108:123]
    ds_read_b128 v[48:51], v5 offset:19456
    v_mul_f32 v75, v75, v147
    buffer_load_dwordx4 a[200:203], v16, s[4:7], s63 offen offset:0 sc1
    v_exp_f32 v74, v74
    v_exp_f32 v75, v75
    v_mfma_f32_32x32x16_bf16 v[108:123], v[60:63], a[24:27], v[108:123]
    ds_read_b128 v[52:55], v5 offset:20480
    v_mul_f32 v154, v146, v154
    v_fma_f32 v74, v74, v46, v46
    s_add_u32 m0, s75, 28672
    s_waitcnt lgkmcnt(2)
    v_mfma_f32_32x32x16_bf16 v[108:123], v[64:67], a[28:31], v[108:123]
    ds_read_b128 v[56:59], v5 offset:21504
    v_fma_f32 v75, v75, v46, v46
    v_rcp_f32 v74, v74
    buffer_load_dwordx4 v6, s[4:7], s35 offen sc1 lds
    v_mfma_f32_32x32x16_bf16 v[108:123], v[68:71], a[32:35], v[108:123]
    ds_read_b128 v[60:63], v5 offset:22528
    v_rcp_f32 v75, v75
    buffer_load_dwordx4 a[204:207], v16, s[4:7], s63 offen offset:1024 sc1
    v_mul_f32 v155, v147, v155
    v_mfma_f32_32x32x16_bf16 v[108:123], v[84:87], a[36:39], v[108:123]
    ds_read_b128 v[64:67], v5 offset:23552
    v_mul_f32 v154, v154, v74
    v_mul_f32 v155, v155, v75
    v_cvt_pk_bf16_f32 v83, v154, v155
    s_add_u32 m0, s75, 32768
    v_mfma_f32_32x32x16_bf16 v[108:123], v[88:91], a[40:43], v[108:123]
    ds_read_b128 v[68:71], v5 offset:24576
    buffer_store_dwordx4 v[80:83], v7, s[8:11], s52 offen sc1
    v_mul_f32 v72, v92, v92
    s_waitcnt lgkmcnt(2)
    v_mfma_f32_32x32x16_bf16 v[108:123], v[48:51], a[44:47], v[108:123]
    ds_read_b128 v[84:87], v5 offset:25600
    buffer_load_dwordx4 a[208:211], v16, s[4:7], s63 offen offset:2048 sc1
    v_mul_f32 v73, v93, v93
    buffer_load_dwordx4 v6, s[4:7], s36 offen sc1 lds
    v_fma_f32 v72, v72, v45, v44
    v_fma_f32 v73, v73, v45, v44
    v_mfma_f32_32x32x16_bf16 v[108:123], v[52:55], a[48:51], v[108:123]
    ds_read_b128 v[88:91], v5 offset:26624
    v_mul_f32 v72, v72, v92
    v_mul_f32 v73, v73, v93
    v_exp_f32 v72, v72
    v_mfma_f32_32x32x16_bf16 v[108:123], v[56:59], a[52:55], v[108:123]
    ds_read_b128 v[48:51], v5 offset:27648
    v_exp_f32 v73, v73
    s_add_u32 m0, s75, 36864
    v_mul_f32 v100, v92, v100
    v_mfma_f32_32x32x16_bf16 v[108:123], v[60:63], a[56:59], v[108:123]
    ds_read_b128 v[52:55], v5 offset:28672
    buffer_load_dwordx4 a[212:215], v16, s[4:7], s63 offen offset:3072 sc1
    v_fma_f32 v72, v72, v46, v46
    v_fma_f32 v73, v73, v46, v46
    buffer_load_dwordx4 v6, s[4:7], s37 offen sc1 lds
    s_waitcnt lgkmcnt(2)
    v_mfma_f32_32x32x16_bf16 v[108:123], v[64:67], a[60:63], v[108:123]
    ds_read_b128 v[56:59], v5 offset:29696
    v_rcp_f32 v72, v72
    v_rcp_f32 v73, v73
    v_mfma_f32_32x32x16_bf16 v[108:123], v[68:71], a[64:67], v[108:123]
    ds_read_b128 v[60:63], v5 offset:30720
    v_mul_f32 v101, v93, v101
    v_mul_f32 v100, v100, v72
    v_mul_f32 v101, v101, v73
    v_cvt_pk_bf16_f32 v76, v100, v101
    v_mfma_f32_32x32x16_bf16 v[108:123], v[84:87], a[68:71], v[108:123]
    ds_read_b128 v[64:67], v5 offset:31744
    buffer_load_dwordx4 a[216:219], v12, s[4:7], s63 offen offset:0 sc1
    s_add_u32 m0, s75, 40960
    v_mul_f32 v74, v94, v94
    v_mfma_f32_32x32x16_bf16 v[108:123], v[88:91], a[72:75], v[108:123]
    ds_read_b128 v[68:71], v4 offset:24576
    v_mul_f32 v75, v95, v95
    v_fma_f32 v74, v74, v45, v44
    buffer_load_dwordx4 v6, s[4:7], s38 offen sc1 lds
    v_fma_f32 v75, v75, v45, v44
    s_waitcnt lgkmcnt(2)
    v_mfma_f32_32x32x16_bf16 v[108:123], v[48:51], a[76:79], v[108:123]
    ds_read_b128 v[84:87], v4 offset:25600
    v_mul_f32 v74, v74, v94
    v_mul_f32 v75, v75, v95
    v_exp_f32 v74, v74
    s_waitcnt vmcnt(14)
    s_barrier
    v_mfma_f32_32x32x16_bf16 v[108:123], v[52:55], a[80:83], v[108:123]
    ds_read_b128 v[88:91], v4 offset:26624
    buffer_load_dwordx4 a[220:223], v16, s[4:7], s64 offen offset:0 sc1
    v_exp_f32 v75, v75
    v_mfma_f32_32x32x16_bf16 v[108:123], v[56:59], a[84:87], v[108:123]
    ds_read_b128 v[48:51], v4 offset:27648
    v_mul_f32 v102, v94, v102
    s_add_u32 m0, s75, 45056
    v_fma_f32 v74, v74, v46, v46
    v_fma_f32 v75, v75, v46, v46
    v_mfma_f32_32x32x16_bf16 v[108:123], v[60:63], a[88:91], v[108:123]
    ds_read_b128 v[52:55], v4 offset:28672
    v_rcp_f32 v74, v74
    buffer_load_dwordx4 v6, s[4:7], s39 offen sc1 lds
    v_rcp_f32 v75, v75
    s_waitcnt lgkmcnt(2)
    v_mfma_f32_32x32x16_bf16 v[108:123], v[64:67], a[92:95], v[108:123]
    ds_read_b128 v[56:59], v4 offset:29696
    buffer_load_dwordx4 a[224:227], v16, s[4:7], s64 offen offset:1024 sc1
    v_mul_f32 v103, v95, v103
    v_mul_f32 v102, v102, v74
    v_mul_f32 v103, v103, v75
    v_mfma_f32_32x32x16_bf16 v[108:123], v[68:71], a[96:99], v[108:123]
    ds_read_b128 v[60:63], v4 offset:30720
    v_cvt_pk_bf16_f32 v77, v102, v103
    v_mul_f32 v72, v96, v96
    v_mul_f32 v73, v97, v97
    v_fma_f32 v72, v72, v45, v44
    v_mfma_f32_32x32x16_bf16 v[108:123], v[84:87], a[100:103], v[108:123]
    ds_read_b128 v[64:67], v4 offset:31744
    v_fma_f32 v73, v73, v45, v44
    v_mul_f32 v72, v72, v96
    s_add_u32 m0, s75, 49152
    v_mul_f32 v73, v73, v97
    v_mfma_f32_32x32x16_bf16 v[108:123], v[88:91], a[104:107], v[108:123]
    ds_read_b128 v[68:71], v4 offset:32768
    buffer_load_dwordx4 a[228:231], v16, s[4:7], s64 offen offset:2048 sc1
    v_exp_f32 v72, v72
    buffer_load_dwordx4 v6, s[4:7], s40 offen sc1 lds
    s_waitcnt lgkmcnt(2)
    v_mfma_f32_32x32x16_bf16 v[108:123], v[48:51], a[108:111], v[108:123]
    ds_read_b128 v[84:87], v4 offset:33792
    v_exp_f32 v73, v73
    v_mul_f32 v104, v96, v104
    v_fma_f32 v72, v72, v46, v46
    v_mfma_f32_32x32x16_bf16 v[108:123], v[52:55], a[112:115], v[108:123]
    ds_read_b128 v[88:91], v4 offset:34816
    v_fma_f32 v73, v73, v46, v46
    v_rcp_f32 v72, v72
    s_add_u32 m0, s75, 53248
    v_mfma_f32_32x32x16_bf16 v[108:123], v[56:59], a[116:119], v[108:123]
    ds_read_b128 v[48:51], v4 offset:35840
    buffer_load_dwordx4 a[232:235], v16, s[4:7], s64 offen offset:3072 sc1
    v_rcp_f32 v73, v73
    buffer_load_dword v19, off, s[4:7], s74 offset:256 sc1
    v_mfma_f32_32x32x16_bf16 v[108:123], v[60:63], a[120:123], v[108:123]
    ds_read_b128 v[52:55], v4 offset:36864
    v_mul_f32 v105, v97, v105
    buffer_load_dwordx4 v6, s[4:7], s41 offen sc1 lds
    v_mul_f32 v104, v104, v72
    v_mul_f32 v105, v105, v73
    s_waitcnt lgkmcnt(2)
    v_mfma_f32_32x32x16_bf16 v[108:123], v[64:67], a[124:127], v[108:123]
    ds_read_b128 v[56:59], v4 offset:37888
    v_cvt_pk_bf16_f32 v78, v104, v105
    v_mul_f32 v74, v98, v98
    v_mul_f32 v75, v99, v99
    v_fma_f32 v74, v74, v45, v44
    v_mfma_f32_32x32x16_bf16 v[108:123], v[68:71], a[128:131], v[108:123]
    ds_read_b128 v[60:63], v4 offset:38912
    buffer_load_dwordx4 a[236:239], v12, s[4:7], s64 offen offset:0 sc1
    v_fma_f32 v75, v75, v45, v44
    v_mul_f32 v74, v74, v98
    v_mfma_f32_32x32x16_bf16 v[108:123], v[84:87], a[132:135], v[108:123]
    ds_read_b128 v[64:67], v4 offset:39936
    v_mul_f32 v75, v75, v99
    v_exp_f32 v74, v74
    v_exp_f32 v75, v75
    v_mfma_f32_32x32x16_bf16 v[108:123], v[88:91], a[136:139], v[108:123]
    ds_read_b128 v[68:71], v2 offset:5120
    v_mul_f32 v106, v98, v106
    v_fma_f32 v74, v74, v46, v46
    v_fma_f32 v75, v75, v46, v46
    s_waitcnt lgkmcnt(2)
    v_mfma_f32_32x32x16_bf16 v[108:123], v[48:51], a[140:143], v[108:123]
    ds_read_b128 v[84:87], v4 offset:40960
    buffer_load_dwordx4 a[240:243], v16, s[4:7], s65 offen offset:0 sc1
    v_rcp_f32 v74, v74
    s_waitcnt vmcnt(12)
    s_barrier
    v_mfma_f32_32x32x16_bf16 v[108:123], v[52:55], a[144:147], v[108:123]
    ds_read_b128 v[88:91], v4 offset:41984
    v_rcp_f32 v75, v75
    v_mul_f32 v107, v99, v107
    v_mul_f32 v106, v106, v74
    v_mfma_f32_32x32x16_bf16 v[108:123], v[56:59], a[148:151], v[108:123]
    ds_read_b128 v[48:51], v4 offset:43008
    v_mul_f32 v107, v107, v75
    v_cvt_pk_bf16_f32 v79, v106, v107
    v_mfma_f32_32x32x16_bf16 v[108:123], v[60:63], a[152:155], v[108:123]
    ds_read_b128 v[52:55], v4 offset:44032
    buffer_load_dwordx4 a[244:247], v16, s[4:7], s65 offen offset:1024 sc1
    buffer_store_dwordx4 v[76:79], v7, s[8:11], s53 offen sc1
    s_waitcnt lgkmcnt(2)
    v_mfma_f32_32x32x16_bf16 v[108:123], v[64:67], a[156:159], v[108:123]
    ds_read_b128 v[56:59], v4 offset:45056
    buffer_load_dwordx4 a[248:251], v16, s[4:7], s65 offen offset:2048 sc1
    v_mfma_f32_32x32x16_bf16 v[108:123], v[68:71], v[40:43], v[108:123]
    ds_read_b128 v[60:63], v4 offset:46080
    buffer_load_dwordx4 a[252:255], v16, s[4:7], s65 offen offset:3072 sc1
    v_mfma_f32_32x32x16_bf16 v[124:139], v[84:87], a[0:3], 0
    ds_read_b128 v[64:67], v4 offset:47104
    s_waitcnt vmcnt(7)
    v_readfirstlane_b32 s24, v19
    s_cmp_ge_u32 s24, 16
    s_cbranch_scc0 L_slow_20
L_ok_21:
    v_mfma_f32_32x32x16_bf16 v[124:139], v[88:91], a[4:7], v[124:139]
    ds_read_b128 v[68:71], v4 offset:48128
    buffer_load_dwordx4 a[0:3], v8, s[8:11], s56 offen sc1
    s_waitcnt lgkmcnt(2)
    v_mfma_f32_32x32x16_bf16 v[124:139], v[48:51], a[8:11], v[124:139]
    ds_read_b128 v[84:87], v4 offset:49152
    v_mul_f32 v72, v108, v108
    v_mul_f32 v73, v109, v109
    v_fma_f32 v72, v72, v45, v44
    v_fma_f32 v73, v73, v45, v44
    v_mfma_f32_32x32x16_bf16 v[124:139], v[52:55], a[12:15], v[124:139]
    ds_read_b128 v[88:91], v4 offset:50176
    buffer_load_dwordx4 a[4:7], v9, s[8:11], s56 offen sc1
    v_mul_f32 v72, v72, v108
    v_mfma_f32_32x32x16_bf16 v[124:139], v[56:59], a[16:19], v[124:139]
    ds_read_b128 v[48:51], v4 offset:51200
    v_mul_f32 v73, v73, v109
    v_exp_f32 v72, v72
    v_mfma_f32_32x32x16_bf16 v[124:139], v[60:63], a[20:23], v[124:139]
    ds_read_b128 v[52:55], v4 offset:52224
    buffer_load_dwordx4 a[8:11], v10, s[8:11], s56 offen sc1
    s_waitcnt lgkmcnt(2)
    v_mfma_f32_32x32x16_bf16 v[124:139], v[64:67], a[24:27], v[124:139]
    ds_read_b128 v[56:59], v4 offset:53248
    v_exp_f32 v73, v73
    v_mul_f32 v116, v108, v116
    v_fma_f32 v72, v72, v46, v46
    v_mfma_f32_32x32x16_bf16 v[124:139], v[68:71], a[28:31], v[124:139]
    ds_read_b128 v[60:63], v4 offset:54272
    buffer_load_dwordx4 a[12:15], v11, s[8:11], s56 offen sc1
    v_fma_f32 v73, v73, v46, v46
    v_mfma_f32_32x32x16_bf16 v[124:139], v[84:87], a[32:35], v[124:139]
    ds_read_b128 v[64:67], v4 offset:55296
    v_rcp_f32 v72, v72
    v_rcp_f32 v73, v73
    v_mfma_f32_32x32x16_bf16 v[124:139], v[88:91], a[36:39], v[124:139]
    ds_read_b128 v[68:71], v4 offset:56320
    buffer_load_dwordx4 a[16:19], v8, s[8:11], s57 offen sc1
    v_mul_f32 v117, v109, v117
    s_waitcnt lgkmcnt(2)
    v_mfma_f32_32x32x16_bf16 v[124:139], v[48:51], a[40:43], v[124:139]
    ds_read_b128 v[84:87], v4 offset:57344
    v_mul_f32 v116, v116, v72
    v_mul_f32 v117, v117, v73
    v_cvt_pk_bf16_f32 v80, v116, v117
    v_mul_f32 v74, v110, v110
    v_mfma_f32_32x32x16_bf16 v[124:139], v[52:55], a[44:47], v[124:139]
    ds_read_b128 v[88:91], v4 offset:58368
    buffer_load_dwordx4 a[20:23], v9, s[8:11], s57 offen sc1
    v_mul_f32 v75, v111, v111
    v_mfma_f32_32x32x16_bf16 v[124:139], v[56:59], a[48:51], v[124:139]
    ds_read_b128 v[48:51], v4 offset:59392
    v_fma_f32 v74, v74, v45, v44
    v_fma_f32 v75, v75, v45, v44
    v_mul_f32 v74, v74, v110
    v_mul_f32 v75, v75, v111
    v_mfma_f32_32x32x16_bf16 v[124:139], v[60:63], a[52:55], v[124:139]
    ds_read_b128 v[52:55], v4 offset:60416
    buffer_load_dwordx4 a[24:27], v10, s[8:11], s57 offen sc1
    s_waitcnt lgkmcnt(2)
    v_mfma_f32_32x32x16_bf16 v[124:139], v[64:67], a[56:59], v[124:139]
    ds_read_b128 v[56:59], v4 offset:61440
    v_exp_f32 v74, v74
    s_waitcnt vmcnt(13)
    s_waitcnt vmcnt(9)
    s_barrier
    s_cmp_lg_u32 s20, 0
    s_cbranch_scc1 L_sig_22
    s_mov_b64 exec, 1
    buffer_atomic_add v18, off, s[4:7], s74 offset:768 sc1
    s_mov_b64 exec, -1
L_sig_22:
    v_mfma_f32_32x32x16_bf16 v[124:139], v[68:71], a[60:63], v[124:139]
    ds_read_b128 v[60:63], v4 offset:62464
    v_exp_f32 v75, v75
    v_mul_f32 v118, v110, v118
    v_fma_f32 v74, v74, v46, v46
    v_mfma_f32_32x32x16_bf16 v[124:139], v[84:87], a[64:67], v[124:139]
    ds_read_b128 v[64:67], v4 offset:63488
    buffer_load_dwordx4 a[28:31], v11, s[8:11], s57 offen sc1
    v_fma_f32 v75, v75, v46, v46
    v_mfma_f32_32x32x16_bf16 v[124:139], v[88:91], a[68:71], v[124:139]
    ds_read_b128 v[68:71], v4 offset:64512
    v_rcp_f32 v74, v74
    s_waitcnt lgkmcnt(2)
    v_mfma_f32_32x32x16_bf16 v[124:139], v[48:51], a[72:75], v[124:139]
    ds_read_b128 v[84:87], v5 offset:0
    buffer_load_dwordx4 a[32:35], v8, s[8:11], s58 offen sc1
    v_mfma_f32_32x32x16_bf16 v[124:139], v[52:55], a[76:79], v[124:139]
    ds_read_b128 v[88:91], v5 offset:1024
    v_rcp_f32 v75, v75
    v_mul_f32 v119, v111, v119
    v_mul_f32 v118, v118, v74
    v_mfma_f32_32x32x16_bf16 v[124:139], v[56:59], a[80:83], v[124:139]
    ds_read_b128 v[48:51], v5 offset:2048
    buffer_load_dwordx4 a[36:39], v9, s[8:11], s58 offen sc1
    v_mul_f32 v119, v119, v75
    v_mfma_f32_32x32x16_bf16 v[124:139], v[60:63], a[84:87], v[124:139]
    ds_read_b128 v[52:55], v5 offset:3072
    v_cvt_pk_bf16_f32 v81, v118, v119
    v_mul_f32 v72, v112, v112
    v_mul_f32 v73, v113, v113
    s_waitcnt lgkmcnt(2)
    v_mfma_f32_32x32x16_bf16 v[124:139], v[64:67], a[88:91], v[124:139]
    ds_read_b128 v[56:59], v5 offset:4096
    buffer_load_dwordx4 a[40:43], v10, s[8:11], s58 offen sc1
    v_fma_f32 v72, v72, v45, v44
    v_mfma_f32_32x32x16_bf16 v[124:139], v[68:71], a[92:95], v[124:139]
    ds_read_b128 v[60:63], v5 offset:5120
    v_fma_f32 v73, v73, v45, v44
    v_mul_f32 v72, v72, v112
    v_mul_f32 v73, v73, v113
    v_mfma_f32_32x32x16_bf16 v[124:139], v[84:87], a[96:99], v[124:139]
    ds_read_b128 v[64:67], v5 offset:6144
    v_exp_f32 v72, v72
    v_exp_f32 v73, v73
    v_mfma_f32_32x32x16_bf16 v[124:139], v[88:91], a[100:103], v[124:139]
    ds_read_b128 v[68:71], v5 offset:7168
    buffer_load_dwordx4 a[44:47], v11, s[8:11], s58 offen sc1
    v_mul_f32 v120, v112, v120
    s_waitcnt lgkmcnt(2)
    v_mfma_f32_32x32x16_bf16 v[124:139], v[48:51], a[104:107], v[124:139]
    ds_read_b128 v[84:87], v5 offset:8192
    buffer_load_dwordx4 a[48:51], v8, s[8:11], s59 offen sc1
    v_fma_f32 v72, v72, v46, v46
    v_mfma_f32_32x32x16_bf16 v[124:139], v[52:55], a[108:111], v[124:139]
    ds_read_b128 v[88:91], v5 offset:9216
    v_fma_f32 v73, v73, v46, v46
    v_rcp_f32 v72, v72
    v_mfma_f32_32x32x16_bf16 v[124:139], v[56:59], a[112:115], v[124:139]
    ds_read_b128 v[48:51], v5 offset:10240
    v_rcp_f32 v73, v73
    v_mul_f32 v121, v113, v121
    v_mul_f32 v120, v120, v72
    v_mfma_f32_32x32x16_bf16 v[124:139], v[60:63], a[116:119], v[124:139]
    ds_read_b128 v[52:55], v5 offset:11264
    buffer_load_dwordx4 a[52:55], v9, s[8:11], s59 offen sc1
    v_mul_f32 v121, v121, v73
    s_waitcnt lgkmcnt(2)
    v_mfma_f32_32x32x16_bf16 v[124:139], v[64:67], a[120:123], v[124:139]
    ds_read_b128 v[56:59], v5 offset:12288
    v_cvt_pk_bf16_f32 v82, v120, v121
    buffer_load_dwordx4 a[56:59], v10, s[8:11], s59 offen sc1
    v_mfma_f32_32x32x16_bf16 v[124:139], v[68:71], a[124:127], v[124:139]
    ds_read_b128 v[60:63], v5 offset:13312
    v_mul_f32 v74, v114, v114
    v_mul_f32 v75, v115, v115
    v_fma_f32 v74, v74, v45, v44
    v_fma_f32 v75, v75, v45, v44
    v_mfma_f32_32x32x16_bf16 v[124:139], v[84:87], a[128:131], v[124:139]
    ds_read_b128 v[64:67], v5 offset:14336
    buffer_load_dwordx4 a[60:63], v11, s[8:11], s59 offen sc1
    v_mul_f32 v74, v74, v114
    v_mfma_f32_32x32x16_bf16 v[124:139], v[88:91], a[132:135], v[124:139]
    ds_read_b128 v[68:71], v5 offset:15360
    v_mul_f32 v75, v75, v115
    v_exp_f32 v74, v74
    s_waitcnt lgkmcnt(2)
    v_mfma_f32_32x32x16_bf16 v[124:139], v[48:51], a[136:139], v[124:139]
    ds_read_b128 v[84:87], v2 offset:6144
    v_exp_f32 v75, v75
    v_mul_f32 v122, v114, v122
    v_fma_f32 v74, v74, v46, v46
    v_mfma_f32_32x32x16_bf16 v[124:139], v[52:55], a[140:143], v[124:139]
    buffer_load_dwordx4 a[76:79], v12, s[4:7], s65 offen offset:0 sc1
    v_fma_f32 v75, v75, v46, v46
    v_mfma_f32_32x32x16_bf16 v[124:139], v[56:59], a[144:147], v[124:139]
    v_rcp_f32 v74, v74
    buffer_load_dwordx4 a[80:83], v16, s[4:7], s66 offen offset:0 sc1
    v_mfma_f32_32x32x16_bf16 v[124:139], v[60:63], a[148:151], v[124:139]
    v_rcp_f32 v75, v75
    v_mul_f32 v123, v115, v123
    v_mul_f32 v122, v122, v74
    s_waitcnt lgkmcnt(0)
    v_mfma_f32_32x32x16_bf16 v[124:139], v[64:67], a[152:155], v[124:139]
    buffer_load_dwordx4 a[84:87], v16, s[4:7], s66 offen offset:1024 sc1
    v_mul_f32 v123, v123, v75
    v_cvt_pk_bf16_f32 v83, v122, v123
    v_mfma_f32_32x32x16_bf16 v[124:139], v[68:71], a[156:159], v[124:139]
    buffer_store_dwordx4 v[80:83], v7, s[8:11], s54 offen sc1
    buffer_load_dwordx4 a[88:91], v16, s[4:7], s66 offen offset:2048 sc1
    v_mfma_f32_32x32x16_bf16 v[124:139], v[84:87], v[40:43], v[124:139]
    buffer_load_dwordx4 a[92:95], v16, s[4:7], s66 offen offset:3072 sc1
    buffer_load_dwordx4 a[96:99], v12, s[4:7], s66 offen offset:0 sc1
    s_nop 9
    v_pk_mul_f32 v[72:73], v[124:125], v[124:125]
    v_pk_fma_f32 v[72:73], v[72:73], v[44:45], v[44:45] op_sel:[0,1,0] op_sel_hi:[1,1,0]
    v_pk_mul_f32 v[72:73], v[72:73], v[124:125]
    v_exp_f32 v72, v72
    v_exp_f32 v73, v73
    v_pk_mul_f32 v[132:133], v[124:125], v[132:133]
    v_pk_fma_f32 v[72:73], v[72:73], v[46:47], v[46:47] op_sel_hi:[1,0,0]
    v_rcp_f32 v72, v72
    v_rcp_f32 v73, v73
    s_nop 0
    v_pk_mul_f32 v[132:133], v[132:133], v[72:73]
    v_cvt_pk_bf16_f32 v76, v132, v133
    v_pk_mul_f32 v[74:75], v[126:127], v[126:127]
    v_pk_fma_f32 v[74:75], v[74:75], v[44:45], v[44:45] op_sel:[0,1,0] op_sel_hi:[1,1,0]
    v_pk_mul_f32 v[74:75], v[74:75], v[126:127]
    v_exp_f32 v74, v74
    v_exp_f32 v75, v75
    v_pk_mul_f32 v[134:135], v[126:127], v[134:135]
    v_pk_fma_f32 v[74:75], v[74:75], v[46:47], v[46:47] op_sel_hi:[1,0,0]
    v_rcp_f32 v74, v74
    v_rcp_f32 v75, v75
    s_nop 0
    v_pk_mul_f32 v[134:135], v[134:135], v[74:75]
    v_cvt_pk_bf16_f32 v77, v134, v135
    v_pk_mul_f32 v[72:73], v[128:129], v[128:129]
    v_pk_fma_f32 v[72:73], v[72:73], v[44:45], v[44:45] op_sel:[0,1,0] op_sel_hi:[1,1,0]
    v_pk_mul_f32 v[72:73], v[72:73], v[128:129]
    v_exp_f32 v72, v72
    v_exp_f32 v73, v73
    v_pk_mul_f32 v[136:137], v[128:129], v[136:137]
    v_pk_fma_f32 v[72:73], v[72:73], v[46:47], v[46:47] op_sel_hi:[1,0,0]
    v_rcp_f32 v72, v72
    v_rcp_f32 v73, v73
    s_nop 0
    v_pk_mul_f32 v[136:137], v[136:137], v[72:73]
    v_cvt_pk_bf16_f32 v78, v136, v137
    v_pk_mul_f32 v[74:75], v[130:131], v[130:131]
    v_pk_fma_f32 v[74:75], v[74:75], v[44:45], v[44:45] op_sel:[0,1,0] op_sel_hi:[1,1,0]
    v_pk_mul_f32 v[74:75], v[74:75], v[130:131]
    v_exp_f32 v74, v74
    v_exp_f32 v75, v75
    v_pk_mul_f32 v[138:139], v[130:131], v[138:139]
    v_pk_fma_f32 v[74:75], v[74:75], v[46:47], v[46:47] op_sel_hi:[1,0,0]
    v_rcp_f32 v74, v74
    v_rcp_f32 v75, v75
    s_nop 0
    v_pk_mul_f32 v[138:139], v[138:139], v[74:75]
    v_cvt_pk_bf16_f32 v79, v138, v139
    buffer_store_dwordx4 v[76:79], v7, s[8:11], s55 offen sc1
    s_waitcnt vmcnt(22)
    v_mfma_f32_16x16x32_bf16 v[92:95], v[156:159], a[4:7], 0
    v_lshlrev_b32 v72, 16, v30
    v_and_b32 v73, 0xffff0000, v30
    v_mfma_f32_16x16x32_bf16 v[96:99], v[160:163], a[4:7], 0
    v_lshlrev_b32 v74, 16, v31
    v_and_b32 v75, 0xffff0000, v31
    v_mfma_f32_16x16x32_bf16 v[100:103], v[164:167], a[4:7], 0
    buffer_load_dword v19, off, s[4:7], s74 offset:768 sc1
    v_lshlrev_b32 v76, 16, v32
    v_and_b32 v77, 0xffff0000, v32
    v_mfma_f32_16x16x32_bf16 v[104:107], v[168:171], a[4:7], 0
    v_lshlrev_b32 v78, 16, v33
    v_and_b32 v79, 0xffff0000, v33
    v_mfma_f32_16x16x32_bf16 v[108:111], v[172:175], a[4:7], 0
    v_lshlrev_b32 v80, 16, v34
    v_and_b32 v81, 0xffff0000, v34
    s_waitcnt vmcnt(22)
    v_mfma_f32_16x16x32_bf16 v[112:115], v[156:159], a[8:11], 0
    buffer_load_dwordx4 a[64:67], v8, s[8:11], s60 offen sc1
    v_mfma_f32_16x16x32_bf16 v[116:119], v[160:163], a[8:11], 0
    v_lshlrev_b32 v82, 16, v35
    v_and_b32 v83, 0xffff0000, v35
    v_mfma_f32_16x16x32_bf16 v[120:123], v[164:167], a[8:11], 0
    v_lshlrev_b32 v84, 16, v36
    v_and_b32 v85, 0xffff0000, v36
    v_mfma_f32_16x16x32_bf16 v[124:127], v[168:171], a[8:11], 0
    v_lshlrev_b32 v86, 16, v37
    v_and_b32 v87, 0xffff0000, v37
    v_mfma_f32_16x16x32_bf16 v[128:131], v[172:175], a[8:11], 0
    v_lshlrev_b32 v88, 16, v38
    v_and_b32 v89, 0xffff0000, v38
    s_waitcnt vmcnt(22)
    v_mfma_f32_16x16x32_bf16 v[132:135], v[156:159], a[12:15], 0
    v_lshlrev_b32 v90, 16, v39
    v_and_b32 v91, 0xffff0000, v39
    v_mfma_f32_16x16x32_bf16 v[136:139], v[160:163], a[12:15], 0
    buffer_load_dwordx4 a[68:71], v9, s[8:11], s60 offen sc1
    v_mfma_f32_16x16x32_bf16 v[140:143], v[164:167], a[12:15], 0
    buffer_load_dwordx4 a[72:75], v10, s[8:11], s60 offen sc1
    v_mfma_f32_16x16x32_bf16 v[144:147], v[168:171], a[12:15], 0
    v_mfma_f32_16x16x32_bf16 v[148:151], v[172:175], a[12:15], 0
    buffer_load_dwordx4 v[48:51], v11, s[8:11], s60 offen sc1
    v_mfma_f32_16x16x32_bf16 v[72:75], v[156:159], a[0:3], v[72:75]
    v_mfma_f32_16x16x32_bf16 v[76:79], v[160:163], a[0:3], v[76:79]
    v_mfma_f32_16x16x32_bf16 v[80:83], v[164:167], a[0:3], v[80:83]
    v_mfma_f32_16x16x32_bf16 v[84:87], v[168:171], a[0:3], v[84:87]
    v_mfma_f32_16x16x32_bf16 v[88:91], v[172:175], a[0:3], v[88:91]
    s_waitcnt vmcnt(24)
    v_mfma_f32_16x16x32_bf16 v[72:75], v[176:179], a[16:19], v[72:75]
    buffer_load_dwordx4 v[52:55], v8, s[8:11], s61 offen sc1
    v_mfma_f32_16x16x32_bf16 v[76:79], v[180:183], a[16:19], v[76:79]
    v_mfma_f32_16x16x32_bf16 v[80:83], v[184:187], a[16:19], v[80:83]
    v_mfma_f32_16x16x32_bf16 v[84:87], v[188:191], a[16:19], v[84:87]
    v_mfma_f32_16x16x32_bf16 v[88:91], v[192:195], a[16:19], v[88:91]
    buffer_load_dwordx4 v[56:59], v9, s[8:11], s61 offen sc1
    s_waitcnt vmcnt(25)
    v_mfma_f32_16x16x32_bf16 v[92:95], v[176:179], a[20:23], v[92:95]
    v_mfma_f32_16x16x32_bf16 v[96:99], v[180:183], a[20:23], v[96:99]
    v_mfma_f32_16x16x32_bf16 v[100:103], v[184:187], a[20:23], v[100:103]
    v_mfma_f32_16x16x32_bf16 v[104:107], v[188:191], a[20:23], v[104:107]
    v_mfma_f32_16x16x32_bf16 v[108:111], v[192:195], a[20:23], v[108:111]
    buffer_load_dwordx4 v[60:63], v10, s[8:11], s61 offen sc1
    s_waitcnt vmcnt(25)
    v_mfma_f32_16x16x32_bf16 v[112:115], v[176:179], a[24:27], v[112:115]
    buffer_load_dwordx4 a[100:103], v16, s[4:7], s67 offen offset:0 sc1
    v_mfma_f32_16x16x32_bf16 v[116:119], v[180:183], a[24:27], v[116:119]
    v_mfma_f32_16x16x32_bf16 v[120:123], v[184:187], a[24:27], v[120:123]
    v_mfma_f32_16x16x32_bf16 v[124:127], v[188:191], a[24:27], v[124:127]
    v_mfma_f32_16x16x32_bf16 v[128:131], v[192:195], a[24:27], v[128:131]
    buffer_load_dwordx4 v[64:67], v11, s[8:11], s61 offen sc1
    s_waitcnt vmcnt(26)
    v_mfma_f32_16x16x32_bf16 v[132:135], v[176:179], a[28:31], v[132:135]
    buffer_load_dwordx4 a[104:107], v16, s[4:7], s67 offen offset:1024 sc1
    v_mfma_f32_16x16x32_bf16 v[136:139], v[180:183], a[28:31], v[136:139]
    v_mfma_f32_16x16x32_bf16 v[140:143], v[184:187], a[28:31], v[140:143]
    v_mfma_f32_16x16x32_bf16 v[144:147], v[188:191], a[28:31], v[144:147]
    v_mfma_f32_16x16x32_bf16 v[148:151], v[192:195], a[28:31], v[148:151]
    s_waitcnt vmcnt(26)
    v_mfma_f32_16x16x32_bf16 v[72:75], v[196:199], a[32:35], v[72:75]
    v_mfma_f32_16x16x32_bf16 v[76:79], v[200:203], a[32:35], v[76:79]
    buffer_load_dwordx4 a[108:111], v16, s[4:7], s67 offen offset:2048 sc1
    v_mfma_f32_16x16x32_bf16 v[80:83], v[204:207], a[32:35], v[80:83]
    v_mfma_f32_16x16x32_bf16 v[84:87], v[208:211], a[32:35], v[84:87]
    v_mfma_f32_16x16x32_bf16 v[88:91], v[212:215], a[32:35], v[88:91]
    s_waitcnt vmcnt(26)
    v_mfma_f32_16x16x32_bf16 v[92:95], v[196:199], a[36:39], v[92:95]
    v_mfma_f32_16x16x32_bf16 v[96:99], v[200:203], a[36:39], v[96:99]
    buffer_load_dwordx4 a[112:115], v16, s[4:7], s67 offen offset:3072 sc1
    v_mfma_f32_16x16x32_bf16 v[100:103], v[204:207], a[36:39], v[100:103]
    v_mfma_f32_16x16x32_bf16 v[104:107], v[208:211], a[36:39], v[104:107]
    v_mfma_f32_16x16x32_bf16 v[108:111], v[212:215], a[36:39], v[108:111]
    s_waitcnt vmcnt(26)
    v_mfma_f32_16x16x32_bf16 v[112:115], v[196:199], a[40:43], v[112:115]
    v_mfma_f32_16x16x32_bf16 v[116:119], v[200:203], a[40:43], v[116:119]
    v_mfma_f32_16x16x32_bf16 v[120:123], v[204:207], a[40:43], v[120:123]
    buffer_load_dwordx4 a[116:119], v12, s[4:7], s67 offen offset:0 sc1
    v_mfma_f32_16x16x32_bf16 v[124:127], v[208:211], a[40:43], v[124:127]
    v_mfma_f32_16x16x32_bf16 v[128:131], v[212:215], a[40:43], v[128:131]
    s_waitcnt vmcnt(26)
    v_mfma_f32_16x16x32_bf16 v[132:135], v[196:199], a[44:47], v[132:135]
    v_mfma_f32_16x16x32_bf16 v[136:139], v[200:203], a[44:47], v[136:139]
    s_waitcnt vmcnt(14)
    s_barrier
    s_cmp_lg_u32 s20, 0
    s_cbranch_scc1 L_sig_23
    s_mov_b64 exec, 1
    buffer_atomic_add v18, off, s[4:7], s74 offset:512 sc1
    s_mov_b64 exec, -1
L_sig_23:
    v_mfma_f32_16x16x32_bf16 v[140:143], v[204:207], a[44:47], v[140:143]
    v_mfma_f32_16x16x32_bf16 v[144:147], v[208:211], a[44:47], v[144:147]
    s_waitcnt vmcnt(13)
    v_readfirstlane_b32 s24, v19
    s_cmp_ge_u32 s24, 16
    s_cbranch_scc0 L_slow_24
L_ok_25:
    v_mfma_f32_16x16x32_bf16 v[148:151], v[212:215], a[44:47], v[148:151]
    buffer_load_dwordx4 a[4:7], v8, s[8:11], s62 offen sc1
    v_mfma_f32_16x16x32_bf16 v[72:75], v[216:219], a[48:51], v[72:75]
    buffer_load_dwordx4 a[8:11], v9, s[8:11], s62 offen sc1
    v_mfma_f32_16x16x32_bf16 v[76:79], v[220:223], a[48:51], v[76:79]
    v_mfma_f32_16x16x32_bf16 v[80:83], v[224:227], a[48:51], v[80:83]
    buffer_load_dwordx4 a[12:15], v10, s[8:11], s62 offen sc1
    v_mfma_f32_16x16x32_bf16 v[84:87], v[228:231], a[48:51], v[84:87]
    v_mfma_f32_16x16x32_bf16 v[88:91], v[232:235], a[48:51], v[88:91]
    buffer_load_dwordx4 a[0:3], v11, s[8:11], s62 offen sc1
    v_mfma_f32_16x16x32_bf16 v[92:95], v[216:219], a[52:55], v[92:95]
    buffer_load_dwordx4 a[16:19], v8, s[8:11], s63 offen sc1
    v_mfma_f32_16x16x32_bf16 v[96:99], v[220:223], a[52:55], v[96:99]
    v_mfma_f32_16x16x32_bf16 v[100:103], v[224:227], a[52:55], v[100:103]
    buffer_load_dwordx4 a[20:23], v9, s[8:11], s63 offen sc1
    v_mfma_f32_16x16x32_bf16 v[104:107], v[228:231], a[52:55], v[104:107]
    v_mfma_f32_16x16x32_bf16 v[108:111], v[232:235], a[52:55], v[108:111]
    buffer_load_dwordx4 a[24:27], v10, s[8:11], s63 offen sc1
    v_mfma_f32_16x16x32_bf16 v[112:115], v[216:219], a[56:59], v[112:115]
    v_mfma_f32_16x16x32_bf16 v[116:119], v[220:223], a[56:59], v[116:119]
    v_mfma_f32_16x16x32_bf16 v[120:123], v[224:227], a[56:59], v[120:123]
    v_mfma_f32_16x16x32_bf16 v[124:127], v[228:231], a[56:59], v[124:127]
    v_mfma_f32_16x16x32_bf16 v[128:131], v[232:235], a[56:59], v[128:131]
    buffer_load_dwordx4 a[28:31], v11, s[8:11], s63 offen sc1
    v_mfma_f32_16x16x32_bf16 v[132:135], v[216:219], a[60:63], v[132:135]
    v_mfma_f32_16x16x32_bf16 v[136:139], v[220:223], a[60:63], v[136:139]
    v_mfma_f32_16x16x32_bf16 v[140:143], v[224:227], a[60:63], v[140:143]
    v_mfma_f32_16x16x32_bf16 v[144:147], v[228:231], a[60:63], v[144:147]
    v_mfma_f32_16x16x32_bf16 v[148:151], v[232:235], a[60:63], v[148:151]
    s_waitcnt vmcnt(20)
    v_mfma_f32_16x16x32_bf16 v[72:75], v[236:239], a[64:67], v[72:75]
    buffer_load_dwordx4 a[32:35], v8, s[8:11], s64 offen sc1
    v_mfma_f32_16x16x32_bf16 v[76:79], v[240:243], a[64:67], v[76:79]
    v_mfma_f32_16x16x32_bf16 v[80:83], v[244:247], a[64:67], v[80:83]
    v_mfma_f32_16x16x32_bf16 v[84:87], v[248:251], a[64:67], v[84:87]
    v_mfma_f32_16x16x32_bf16 v[88:91], v[252:255], a[64:67], v[88:91]
    buffer_load_dwordx4 a[36:39], v9, s[8:11], s64 offen sc1
    s_waitcnt vmcnt(21)
    v_mfma_f32_16x16x32_bf16 v[92:95], v[236:239], a[68:71], v[92:95]
    v_mfma_f32_16x16x32_bf16 v[96:99], v[240:243], a[68:71], v[96:99]
    v_mfma_f32_16x16x32_bf16 v[100:103], v[244:247], a[68:71], v[100:103]
    v_mfma_f32_16x16x32_bf16 v[104:107], v[248:251], a[68:71], v[104:107]
    v_mfma_f32_16x16x32_bf16 v[108:111], v[252:255], a[68:71], v[108:111]
    buffer_load_dwordx4 a[40:43], v10, s[8:11], s64 offen sc1
    s_waitcnt vmcnt(21)
    v_mfma_f32_16x16x32_bf16 v[112:115], v[236:239], a[72:75], v[112:115]
    v_mfma_f32_16x16x32_bf16 v[116:119], v[240:243], a[72:75], v[116:119]
    v_mfma_f32_16x16x32_bf16 v[120:123], v[244:247], a[72:75], v[120:123]
    v_mfma_f32_16x16x32_bf16 v[124:127], v[248:251], a[72:75], v[124:127]
    v_mfma_f32_16x16x32_bf16 v[128:131], v[252:255], a[72:75], v[128:131]
    buffer_load_dwordx4 a[44:47], v11, s[8:11], s64 offen sc1
    s_waitcnt vmcnt(21)
    v_mfma_f32_16x16x32_bf16 v[132:135], v[236:239], v[48:51], v[132:135]
    v_mfma_f32_16x16x32_bf16 v[136:139], v[240:243], v[48:51], v[136:139]
    v_mfma_f32_16x16x32_bf16 v[140:143], v[244:247], v[48:51], v[140:143]
    v_mfma_f32_16x16x32_bf16 v[144:147], v[248:251], v[48:51], v[144:147]
    v_mfma_f32_16x16x32_bf16 v[148:151], v[252:255], v[48:51], v[148:151]
    s_waitcnt vmcnt(20)
    v_mfma_f32_16x16x32_bf16 v[72:75], a[160:163], v[52:55], v[72:75]
    buffer_load_dwordx4 a[48:51], v8, s[8:11], s65 offen sc1
    v_mfma_f32_16x16x32_bf16 v[76:79], a[164:167], v[52:55], v[76:79]
    v_mfma_f32_16x16x32_bf16 v[80:83], a[168:171], v[52:55], v[80:83]
    v_mfma_f32_16x16x32_bf16 v[84:87], a[172:175], v[52:55], v[84:87]
    v_mfma_f32_16x16x32_bf16 v[88:91], a[176:179], v[52:55], v[88:91]
    buffer_load_dwordx4 a[52:55], v9, s[8:11], s65 offen sc1
    s_waitcnt vmcnt(21)
    v_mfma_f32_16x16x32_bf16 v[92:95], a[160:163], v[56:59], v[92:95]
    v_mfma_f32_16x16x32_bf16 v[96:99], a[164:167], v[56:59], v[96:99]
    v_mfma_f32_16x16x32_bf16 v[100:103], a[168:171], v[56:59], v[100:103]
    v_mfma_f32_16x16x32_bf16 v[104:107], a[172:175], v[56:59], v[104:107]
    v_mfma_f32_16x16x32_bf16 v[108:111], a[176:179], v[56:59], v[108:111]
    buffer_load_dwordx4 a[56:59], v10, s[8:11], s65 offen sc1
    s_waitcnt vmcnt(21)
    v_mfma_f32_16x16x32_bf16 v[112:115], a[160:163], v[60:63], v[112:115]
    v_mfma_f32_16x16x32_bf16 v[116:119], a[164:167], v[60:63], v[116:119]
    v_mfma_f32_16x16x32_bf16 v[120:123], a[168:171], v[60:63], v[120:123]
    v_mfma_f32_16x16x32_bf16 v[124:127], a[172:175], v[60:63], v[124:127]
    v_mfma_f32_16x16x32_bf16 v[128:131], a[176:179], v[60:63], v[128:131]
    buffer_load_dwordx4 a[60:63], v11, s[8:11], s65 offen sc1
    s_waitcnt vmcnt(20)
    v_mfma_f32_16x16x32_bf16 v[132:135], a[160:163], v[64:67], v[132:135]
    buffer_load_dword v19, off, s[4:7], s74 offset:512 sc1
    v_mfma_f32_16x16x32_bf16 v[136:139], a[164:167], v[64:67], v[136:139]
    buffer_load_dwordx4 a[120:123], v16, s[4:7], s68 offen offset:0 sc1
    v_mfma_f32_16x16x32_bf16 v[140:143], a[168:171], v[64:67], v[140:143]
    v_mfma_f32_16x16x32_bf16 v[144:147], a[172:175], v[64:67], v[144:147]
    v_mfma_f32_16x16x32_bf16 v[148:151], a[176:179], v[64:67], v[148:151]
    s_waitcnt vmcnt(17)
    v_mfma_f32_16x16x32_bf16 v[72:75], a[180:183], a[4:7], v[72:75]
    buffer_load_dwordx4 a[124:127], v16, s[4:7], s68 offen offset:1024 sc1
    v_mfma_f32_16x16x32_bf16 v[76:79], a[184:187], a[4:7], v[76:79]
    v_mfma_f32_16x16x32_bf16 v[80:83], a[188:191], a[4:7], v[80:83]
    v_mfma_f32_16x16x32_bf16 v[84:87], a[192:195], a[4:7], v[84:87]
    v_mfma_f32_16x16x32_bf16 v[88:91], a[196:199], a[4:7], v[88:91]
    buffer_load_dwordx4 a[128:131], v16, s[4:7], s68 offen offset:2048 sc1
    s_waitcnt vmcnt(18)
    v_mfma_f32_16x16x32_bf16 v[92:95], a[180:183], a[8:11], v[92:95]
    v_mfma_f32_16x16x32_bf16 v[96:99], a[184:187], a[8:11], v[96:99]
    v_mfma_f32_16x16x32_bf16 v[100:103], a[188:191], a[8:11], v[100:103]
    v_mfma_f32_16x16x32_bf16 v[104:107], a[192:195], a[8:11], v[104:107]
    buffer_load_dwordx4 a[132:135], v16, s[4:7], s68 offen offset:3072 sc1
    v_mfma_f32_16x16x32_bf16 v[108:111], a[196:199], a[8:11], v[108:111]
    s_waitcnt vmcnt(18)
    v_mfma_f32_16x16x32_bf16 v[112:115], a[180:183], a[12:15], v[112:115]
    v_mfma_f32_16x16x32_bf16 v[116:119], a[184:187], a[12:15], v[116:119]
    v_mfma_f32_16x16x32_bf16 v[120:123], a[188:191], a[12:15], v[120:123]
    buffer_load_dwordx4 a[136:139], v12, s[4:7], s68 offen offset:0 sc1
    v_mfma_f32_16x16x32_bf16 v[124:127], a[192:195], a[12:15], v[124:127]
    v_mfma_f32_16x16x32_bf16 v[128:131], a[196:199], a[12:15], v[128:131]
    s_waitcnt vmcnt(18)
    v_mfma_f32_16x16x32_bf16 v[132:135], a[180:183], a[0:3], v[132:135]
    v_mfma_f32_16x16x32_bf16 v[136:139], a[184:187], a[0:3], v[136:139]
    buffer_load_dwordx4 a[140:143], v16, s[4:7], s69 offen offset:0 sc1
    v_mfma_f32_16x16x32_bf16 v[140:143], a[188:191], a[0:3], v[140:143]
    v_mfma_f32_16x16x32_bf16 v[144:147], a[192:195], a[0:3], v[144:147]
    v_mfma_f32_16x16x32_bf16 v[148:151], a[196:199], a[0:3], v[148:151]
    s_waitcnt vmcnt(18)
    v_mfma_f32_16x16x32_bf16 v[72:75], a[200:203], a[16:19], v[72:75]
    v_mfma_f32_16x16x32_bf16 v[76:79], a[204:207], a[16:19], v[76:79]
    buffer_load_dwordx4 a[144:147], v16, s[4:7], s69 offen offset:1024 sc1
    v_mfma_f32_16x16x32_bf16 v[80:83], a[208:211], a[16:19], v[80:83]
    v_mfma_f32_16x16x32_bf16 v[84:87], a[212:215], a[16:19], v[84:87]
    v_mfma_f32_16x16x32_bf16 v[88:91], a[216:219], a[16:19], v[88:91]
    s_waitcnt vmcnt(18)
    v_mfma_f32_16x16x32_bf16 v[92:95], a[200:203], a[20:23], v[92:95]
    buffer_load_dwordx4 a[148:151], v16, s[4:7], s69 offen offset:2048 sc1
    v_mfma_f32_16x16x32_bf16 v[96:99], a[204:207], a[20:23], v[96:99]
    v_mfma_f32_16x16x32_bf16 v[100:103], a[208:211], a[20:23], v[100:103]
    v_mfma_f32_16x16x32_bf16 v[104:107], a[212:215], a[20:23], v[104:107]
    v_mfma_f32_16x16x32_bf16 v[108:111], a[216:219], a[20:23], v[108:111]
    buffer_load_dwordx4 a[152:155], v16, s[4:7], s69 offen offset:3072 sc1
    s_waitcnt vmcnt(19)
    v_mfma_f32_16x16x32_bf16 v[112:115], a[200:203], a[24:27], v[112:115]
    v_mfma_f32_16x16x32_bf16 v[116:119], a[204:207], a[24:27], v[116:119]
    v_mfma_f32_16x16x32_bf16 v[120:123], a[208:211], a[24:27], v[120:123]
    v_mfma_f32_16x16x32_bf16 v[124:127], a[212:215], a[24:27], v[124:127]
    buffer_load_dwordx4 a[156:159], v12, s[4:7], s69 offen offset:0 sc1
    v_mfma_f32_16x16x32_bf16 v[128:131], a[216:219], a[24:27], v[128:131]
    s_waitcnt vmcnt(19)
    v_mfma_f32_16x16x32_bf16 v[132:135], a[200:203], a[28:31], v[132:135]
    v_mfma_f32_16x16x32_bf16 v[136:139], a[204:207], a[28:31], v[136:139]
    v_mfma_f32_16x16x32_bf16 v[140:143], a[208:211], a[28:31], v[140:143]
    v_mfma_f32_16x16x32_bf16 v[144:147], a[212:215], a[28:31], v[144:147]
    s_waitcnt vmcnt(10)
    v_readfirstlane_b32 s24, v19
    s_cmp_ge_u32 s24, 16
    s_cbranch_scc0 L_slow_26
L_ok_27:
    v_mfma_f32_16x16x32_bf16 v[148:151], a[216:219], a[28:31], v[148:151]
    buffer_load_dwordx4 a[64:67], v8, s[8:11], s66 offen sc1
    v_mfma_f32_16x16x32_bf16 v[72:75], a[220:223], a[32:35], v[72:75]
    buffer_load_dwordx4 a[68:71], v9, s[8:11], s66 offen sc1
    v_mfma_f32_16x16x32_bf16 v[76:79], a[224:227], a[32:35], v[76:79]
    v_mfma_f32_16x16x32_bf16 v[80:83], a[228:231], a[32:35], v[80:83]
    buffer_load_dwordx4 a[72:75], v10, s[8:11], s66 offen sc1
    v_mfma_f32_16x16x32_bf16 v[84:87], a[232:235], a[32:35], v[84:87]
    v_mfma_f32_16x16x32_bf16 v[88:91], a[236:239], a[32:35], v[88:91]
    buffer_load_dwordx4 v[48:51], v11, s[8:11], s66 offen sc1
    v_mfma_f32_16x16x32_bf16 v[92:95], a[220:223], a[36:39], v[92:95]
    buffer_load_dwordx4 v[52:55], v8, s[8:11], s67 offen sc1
    v_mfma_f32_16x16x32_bf16 v[96:99], a[224:227], a[36:39], v[96:99]
    v_mfma_f32_16x16x32_bf16 v[100:103], a[228:231], a[36:39], v[100:103]
    buffer_load_dwordx4 v[56:59], v9, s[8:11], s67 offen sc1
    v_mfma_f32_16x16x32_bf16 v[104:107], a[232:235], a[36:39], v[104:107]
    v_mfma_f32_16x16x32_bf16 v[108:111], a[236:239], a[36:39], v[108:111]
    buffer_load_dwordx4 v[60:63], v10, s[8:11], s67 offen sc1
    v_mfma_f32_16x16x32_bf16 v[112:115], a[220:223], a[40:43], v[112:115]
    s_add_u32 s25, s20, 1
    s_and_b32 s25, s25, 3
    v_mfma_f32_16x16x32_bf16 v[116:119], a[224:227], a[40:43], v[116:119]
    buffer_load_dwordx4 v[64:67], v11, s[8:11], s67 offen sc1
    v_mfma_f32_16x16x32_bf16 v[120:123], a[228:231], a[40:43], v[120:123]
    s_mul_i32 s25, s25, 15360
    s_add_u32 s25, s25, 90112
    v_mfma_f32_16x16x32_bf16 v[124:127], a[232:235], a[40:43], v[124:127]
    v_add_u32 v69, s25, v2
    v_mfma_f32_16x16x32_bf16 v[128:131], a[236:239], a[40:43], v[128:131]
    buffer_load_dwordx4 a[4:7], v8, s[8:11], s68 offen sc1
    v_mfma_f32_16x16x32_bf16 v[132:135], a[220:223], a[44:47], v[132:135]
    s_add_u32 s25, s20, 2
    s_and_b32 s25, s25, 3
    v_mfma_f32_16x16x32_bf16 v[136:139], a[224:227], a[44:47], v[136:139]
    buffer_load_dwordx4 a[8:11], v9, s[8:11], s68 offen sc1
    v_mfma_f32_16x16x32_bf16 v[140:143], a[228:231], a[44:47], v[140:143]
    s_mul_i32 s25, s25, 15360
    s_add_u32 s25, s25, 95232
    v_mfma_f32_16x16x32_bf16 v[144:147], a[232:235], a[44:47], v[144:147]
    buffer_load_dwordx4 a[12:15], v10, s[8:11], s68 offen sc1
    v_mfma_f32_16x16x32_bf16 v[148:151], a[236:239], a[44:47], v[148:151]
    v_add_u32 v70, s25, v2
    v_mfma_f32_16x16x32_bf16 v[72:75], a[240:243], a[48:51], v[72:75]
    buffer_load_dwordx4 a[0:3], v11, s[8:11], s68 offen sc1
    v_mfma_f32_16x16x32_bf16 v[76:79], a[244:247], a[48:51], v[76:79]
    s_add_u32 s25, s20, 3
    s_and_b32 s25, s25, 3
    v_mfma_f32_16x16x32_bf16 v[80:83], a[248:251], a[48:51], v[80:83]
    s_mul_i32 s25, s25, 15360
    s_add_u32 s25, s25, 100352
    v_mfma_f32_16x16x32_bf16 v[84:87], a[252:255], a[48:51], v[84:87]
    buffer_load_dwordx4 a[16:19], v8, s[8:11], s69 offen sc1
    v_mfma_f32_16x16x32_bf16 v[88:91], a[76:79], a[48:51], v[88:91]
    v_add_u32 v71, s25, v2
    v_mfma_f32_16x16x32_bf16 v[92:95], a[240:243], a[52:55], v[92:95]
    buffer_load_dwordx4 a[20:23], v9, s[8:11], s69 offen sc1
    v_mfma_f32_16x16x32_bf16 v[96:99], a[244:247], a[52:55], v[96:99]
    s_mul_i32 s25, s20, 15360
    s_add_u32 s25, s25, 90112
    v_mfma_f32_16x16x32_bf16 v[100:103], a[248:251], a[52:55], v[100:103]
    v_mfma_f32_16x16x32_bf16 v[104:107], a[252:255], a[52:55], v[104:107]
    v_add_u32 v68, s25, v2
    v_mfma_f32_16x16x32_bf16 v[108:111], a[76:79], a[52:55], v[108:111]
    buffer_load_dwordx4 a[24:27], v10, s[8:11], s69 offen sc1
    v_mfma_f32_16x16x32_bf16 v[112:115], a[240:243], a[56:59], v[112:115]
    v_mfma_f32_16x16x32_bf16 v[116:119], a[244:247], a[56:59], v[116:119]
    v_mfma_f32_16x16x32_bf16 v[120:123], a[248:251], a[56:59], v[120:123]
    v_mfma_f32_16x16x32_bf16 v[124:127], a[252:255], a[56:59], v[124:127]
    v_mfma_f32_16x16x32_bf16 v[128:131], a[76:79], a[56:59], v[128:131]
    buffer_load_dwordx4 a[28:31], v11, s[8:11], s69 offen sc1
    v_mfma_f32_16x16x32_bf16 v[132:135], a[240:243], a[60:63], v[132:135]
    v_mfma_f32_16x16x32_bf16 v[136:139], a[244:247], a[60:63], v[136:139]
    v_mfma_f32_16x16x32_bf16 v[140:143], a[248:251], a[60:63], v[140:143]
    v_mfma_f32_16x16x32_bf16 v[144:147], a[252:255], a[60:63], v[144:147]
    v_mfma_f32_16x16x32_bf16 v[148:151], a[76:79], a[60:63], v[148:151]
    s_waitcnt vmcnt(15)
    v_mfma_f32_16x16x32_bf16 v[72:75], a[80:83], a[64:67], v[72:75]
    buffer_load_dword v19, off, s[4:7], s74 offset:1024 sc1
    v_mfma_f32_16x16x32_bf16 v[76:79], a[84:87], a[64:67], v[76:79]
    v_mfma_f32_16x16x32_bf16 v[80:83], a[88:91], a[64:67], v[80:83]
    v_mfma_f32_16x16x32_bf16 v[84:87], a[92:95], a[64:67], v[84:87]
    v_mfma_f32_16x16x32_bf16 v[88:91], a[96:99], a[64:67], v[88:91]
    s_waitcnt vmcnt(15)
    v_mfma_f32_16x16x32_bf16 v[92:95], a[80:83], a[68:71], v[92:95]
    v_mfma_f32_16x16x32_bf16 v[96:99], a[84:87], a[68:71], v[96:99]
    v_mfma_f32_16x16x32_bf16 v[100:103], a[88:91], a[68:71], v[100:103]
    v_mfma_f32_16x16x32_bf16 v[104:107], a[92:95], a[68:71], v[104:107]
    v_mfma_f32_16x16x32_bf16 v[108:111], a[96:99], a[68:71], v[108:111]
    s_waitcnt vmcnt(14)
    v_mfma_f32_16x16x32_bf16 v[112:115], a[80:83], a[72:75], v[112:115]
    v_mfma_f32_16x16x32_bf16 v[116:119], a[84:87], a[72:75], v[116:119]
    v_mfma_f32_16x16x32_bf16 v[120:123], a[88:91], a[72:75], v[120:123]
    v_mfma_f32_16x16x32_bf16 v[124:127], a[92:95], a[72:75], v[124:127]
    v_mfma_f32_16x16x32_bf16 v[128:131], a[96:99], a[72:75], v[128:131]
    s_waitcnt vmcnt(13)
    v_mfma_f32_16x16x32_bf16 v[132:135], a[80:83], v[48:51], v[132:135]
    v_mfma_f32_16x16x32_bf16 v[136:139], a[84:87], v[48:51], v[136:139]
    v_mfma_f32_16x16x32_bf16 v[140:143], a[88:91], v[48:51], v[140:143]
    v_mfma_f32_16x16x32_bf16 v[144:147], a[92:95], v[48:51], v[144:147]
    v_mfma_f32_16x16x32_bf16 v[148:151], a[96:99], v[48:51], v[148:151]
    s_waitcnt vmcnt(12)
    v_mfma_f32_16x16x32_bf16 v[72:75], a[100:103], v[52:55], v[72:75]
    v_mfma_f32_16x16x32_bf16 v[76:79], a[104:107], v[52:55], v[76:79]
    v_mfma_f32_16x16x32_bf16 v[80:83], a[108:111], v[52:55], v[80:83]
    v_mfma_f32_16x16x32_bf16 v[84:87], a[112:115], v[52:55], v[84:87]
    v_mfma_f32_16x16x32_bf16 v[88:91], a[116:119], v[52:55], v[88:91]
    s_waitcnt vmcnt(11)
    v_mfma_f32_16x16x32_bf16 v[92:95], a[100:103], v[56:59], v[92:95]
    v_mfma_f32_16x16x32_bf16 v[96:99], a[104:107], v[56:59], v[96:99]
    v_mfma_f32_16x16x32_bf16 v[100:103], a[108:111], v[56:59], v[100:103]
    v_mfma_f32_16x16x32_bf16 v[104:107], a[112:115], v[56:59], v[104:107]
    v_mfma_f32_16x16x32_bf16 v[108:111], a[116:119], v[56:59], v[108:111]
    s_waitcnt vmcnt(10)
    v_mfma_f32_16x16x32_bf16 v[112:115], a[100:103], v[60:63], v[112:115]
    v_mfma_f32_16x16x32_bf16 v[116:119], a[104:107], v[60:63], v[116:119]
    v_mfma_f32_16x16x32_bf16 v[120:123], a[108:111], v[60:63], v[120:123]
    v_mfma_f32_16x16x32_bf16 v[124:127], a[112:115], v[60:63], v[124:127]
    v_mfma_f32_16x16x32_bf16 v[128:131], a[116:119], v[60:63], v[128:131]
    s_waitcnt vmcnt(9)
    v_mfma_f32_16x16x32_bf16 v[132:135], a[100:103], v[64:67], v[132:135]
    v_mfma_f32_16x16x32_bf16 v[136:139], a[104:107], v[64:67], v[136:139]
    v_mfma_f32_16x16x32_bf16 v[140:143], a[108:111], v[64:67], v[140:143]
    v_mfma_f32_16x16x32_bf16 v[144:147], a[112:115], v[64:67], v[144:147]
    v_mfma_f32_16x16x32_bf16 v[148:151], a[116:119], v[64:67], v[148:151]
    s_waitcnt vmcnt(7)
    v_mfma_f32_16x16x32_bf16 v[92:95], a[120:123], a[8:11], v[92:95]
    v_mfma_f32_16x16x32_bf16 v[96:99], a[124:127], a[8:11], v[96:99]
    v_mfma_f32_16x16x32_bf16 v[100:103], a[128:131], a[8:11], v[100:103]
    v_mfma_f32_16x16x32_bf16 v[104:107], a[132:135], a[8:11], v[104:107]
    v_mfma_f32_16x16x32_bf16 v[108:111], a[136:139], a[8:11], v[108:111]
    s_waitcnt vmcnt(3)
    v_mfma_f32_16x16x32_bf16 v[92:95], a[140:143], a[20:23], v[92:95]
    v_mfma_f32_16x16x32_bf16 v[96:99], a[144:147], a[20:23], v[96:99]
    v_mfma_f32_16x16x32_bf16 v[100:103], a[148:151], a[20:23], v[100:103]
    v_mfma_f32_16x16x32_bf16 v[104:107], a[152:155], a[20:23], v[104:107]
    v_mfma_f32_16x16x32_bf16 v[108:111], a[156:159], a[20:23], v[108:111]
    v_mfma_f32_16x16x32_bf16 v[112:115], a[120:123], a[12:15], v[112:115]
    v_mfma_f32_16x16x32_bf16 v[116:119], a[124:127], a[12:15], v[116:119]
    v_mfma_f32_16x16x32_bf16 v[120:123], a[128:131], a[12:15], v[120:123]
    v_mfma_f32_16x16x32_bf16 v[124:127], a[132:135], a[12:15], v[124:127]
    ds_write_b128 v69, v[92:95] offset:0
    v_mfma_f32_16x16x32_bf16 v[128:131], a[136:139], a[12:15], v[128:131]
    ds_write_b128 v69, v[96:99] offset:1024
    s_waitcnt vmcnt(2)
    v_mfma_f32_16x16x32_bf16 v[112:115], a[140:143], a[24:27], v[112:115]
    v_mfma_f32_16x16x32_bf16 v[116:119], a[144:147], a[24:27], v[116:119]
    ds_write_b128 v69, v[100:103] offset:2048
    v_mfma_f32_16x16x32_bf16 v[120:123], a[148:151], a[24:27], v[120:123]
    v_mfma_f32_16x16x32_bf16 v[124:127], a[152:155], a[24:27], v[124:127]
    ds_write_b128 v69, v[104:107] offset:3072
    v_mfma_f32_16x16x32_bf16 v[128:131], a[156:159], a[24:27], v[128:131]
    v_mfma_f32_16x16x32_bf16 v[132:135], a[120:123], a[0:3], v[132:135]
    ds_write_b128 v69, v[108:111] offset:4096
    v_mfma_f32_16x16x32_bf16 v[136:139], a[124:127], a[0:3], v[136:139]
    v_mfma_f32_16x16x32_bf16 v[140:143], a[128:131], a[0:3], v[140:143]
    v_mfma_f32_16x16x32_bf16 v[144:147], a[132:135], a[0:3], v[144:147]
    ds_write_b128 v70, v[112:115] offset:0
    v_mfma_f32_16x16x32_bf16 v[148:151], a[136:139], a[0:3], v[148:151]
    ds_write_b128 v70, v[116:119] offset:1024
    s_waitcnt vmcnt(1)
    v_mfma_f32_16x16x32_bf16 v[132:135], a[140:143], a[28:31], v[132:135]
    v_mfma_f32_16x16x32_bf16 v[136:139], a[144:147], a[28:31], v[136:139]
    ds_write_b128 v70, v[120:123] offset:2048
    v_mfma_f32_16x16x32_bf16 v[140:143], a[148:151], a[28:31], v[140:143]
    v_mfma_f32_16x16x32_bf16 v[144:147], a[152:155], a[28:31], v[144:147]
    ds_write_b128 v70, v[124:127] offset:3072
    v_mfma_f32_16x16x32_bf16 v[148:151], a[156:159], a[28:31], v[148:151]
    v_mfma_f32_16x16x32_bf16 v[72:75], a[120:123], a[4:7], v[72:75]
    ds_write_b128 v70, v[128:131] offset:4096
    v_mfma_f32_16x16x32_bf16 v[76:79], a[124:127], a[4:7], v[76:79]
    v_mfma_f32_16x16x32_bf16 v[80:83], a[128:131], a[4:7], v[80:83]
    v_mfma_f32_16x16x32_bf16 v[84:87], a[132:135], a[4:7], v[84:87]
    ds_write_b128 v71, v[132:135] offset:0
    v_mfma_f32_16x16x32_bf16 v[88:91], a[136:139], a[4:7], v[88:91]
    ds_write_b128 v71, v[136:139] offset:1024
    v_mfma_f32_16x16x32_bf16 v[72:75], a[140:143], a[16:19], v[72:75]
    v_mfma_f32_16x16x32_bf16 v[76:79], a[144:147], a[16:19], v[76:79]
    ds_write_b128 v71, v[140:143] offset:2048
    v_mfma_f32_16x16x32_bf16 v[80:83], a[148:151], a[16:19], v[80:83]
    v_mfma_f32_16x16x32_bf16 v[84:87], a[152:155], a[16:19], v[84:87]
    ds_write_b128 v71, v[144:147] offset:3072
    v_mfma_f32_16x16x32_bf16 v[88:91], a[156:159], a[16:19], v[88:91]
    ds_write_b128 v71, v[148:151] offset:4096
    s_waitcnt lgkmcnt(0)
    s_barrier
    ds_read_b128 v[92:95], v68 offset:0
    ds_read_b128 v[96:99], v68 offset:1024
    ds_read_b128 v[100:103], v68 offset:2048
    ds_read_b128 v[104:107], v68 offset:3072
    ds_read_b128 v[108:111], v68 offset:4096
    ds_read_b128 v[112:115], v68 offset:5120
    ds_read_b128 v[116:119], v68 offset:6144
    ds_read_b128 v[120:123], v68 offset:7168
    ds_read_b128 v[124:127], v68 offset:8192
    ds_read_b128 v[128:131], v68 offset:9216
    ds_read_b128 v[132:135], v68 offset:10240
    ds_read_b128 v[136:139], v68 offset:11264
    ds_read_b128 v[140:143], v68 offset:12288
    ds_read_b128 v[144:147], v68 offset:13312
    ds_read_b128 v[148:151], v68 offset:14336
    s_waitcnt lgkmcnt(14)
    v_pk_add_f32 v[72:73], v[72:73], v[92:93]
    v_pk_add_f32 v[74:75], v[74:75], v[94:95]
    s_waitcnt lgkmcnt(13)
    v_pk_add_f32 v[76:77], v[76:77], v[96:97]
    v_pk_add_f32 v[78:79], v[78:79], v[98:99]
    s_waitcnt lgkmcnt(12)
    v_pk_add_f32 v[80:81], v[80:81], v[100:101]
    v_pk_add_f32 v[82:83], v[82:83], v[102:103]
    s_waitcnt lgkmcnt(11)
    v_pk_add_f32 v[84:85], v[84:85], v[104:105]
    v_pk_add_f32 v[86:87], v[86:87], v[106:107]
    s_waitcnt lgkmcnt(10)
    v_pk_add_f32 v[88:89], v[88:89], v[108:109]
    v_pk_add_f32 v[90:91], v[90:91], v[110:111]
    s_waitcnt lgkmcnt(9)
    v_pk_add_f32 v[72:73], v[72:73], v[112:113]
    v_pk_add_f32 v[74:75], v[74:75], v[114:115]
    s_waitcnt lgkmcnt(8)
    v_pk_add_f32 v[76:77], v[76:77], v[116:117]
    v_pk_add_f32 v[78:79], v[78:79], v[118:119]
    s_waitcnt lgkmcnt(7)
    v_pk_add_f32 v[80:81], v[80:81], v[120:121]
    v_pk_add_f32 v[82:83], v[82:83], v[122:123]
    s_waitcnt lgkmcnt(6)
    v_pk_add_f32 v[84:85], v[84:85], v[124:125]
    v_pk_add_f32 v[86:87], v[86:87], v[126:127]
    s_waitcnt lgkmcnt(5)
    v_pk_add_f32 v[88:89], v[88:89], v[128:129]
    v_pk_add_f32 v[90:91], v[90:91], v[130:131]
    s_waitcnt lgkmcnt(4)
    v_pk_add_f32 v[72:73], v[72:73], v[132:133]
    v_pk_add_f32 v[74:75], v[74:75], v[134:135]
    s_waitcnt lgkmcnt(3)
    v_pk_add_f32 v[76:77], v[76:77], v[136:137]
    v_pk_add_f32 v[78:79], v[78:79], v[138:139]
    s_waitcnt lgkmcnt(2)
    v_pk_add_f32 v[80:81], v[80:81], v[140:141]
    v_pk_add_f32 v[82:83], v[82:83], v[142:143]
    s_waitcnt lgkmcnt(1)
    v_pk_add_f32 v[84:85], v[84:85], v[144:145]
    v_pk_add_f32 v[86:87], v[86:87], v[146:147]
    s_waitcnt lgkmcnt(0)
    v_pk_add_f32 v[88:89], v[88:89], v[148:149]
    v_pk_add_f32 v[90:91], v[90:91], v[150:151]
    v_pk_add_f32 v[92:93], v[72:73], v[74:75]
    v_pk_mul_f32 v[94:95], v[72:73], v[72:73]
    v_pk_fma_f32 v[94:95], v[74:75], v[74:75], v[94:95]
    v_pk_add_f32 v[92:93], v[92:93], v[76:77]
    v_pk_fma_f32 v[94:95], v[76:77], v[76:77], v[94:95]
    v_pk_add_f32 v[92:93], v[92:93], v[78:79]
    v_pk_fma_f32 v[94:95], v[78:79], v[78:79], v[94:95]
    v_pk_add_f32 v[92:93], v[92:93], v[80:81]
    v_pk_fma_f32 v[94:95], v[80:81], v[80:81], v[94:95]
    v_pk_add_f32 v[92:93], v[92:93], v[82:83]
    v_pk_fma_f32 v[94:95], v[82:83], v[82:83], v[94:95]
    v_pk_add_f32 v[92:93], v[92:93], v[84:85]
    v_pk_fma_f32 v[94:95], v[84:85], v[84:85], v[94:95]
    v_pk_add_f32 v[92:93], v[92:93], v[86:87]
    v_pk_fma_f32 v[94:95], v[86:87], v[86:87], v[94:95]
    v_pk_add_f32 v[92:93], v[92:93], v[88:89]
    v_pk_fma_f32 v[94:95], v[88:89], v[88:89], v[94:95]
    v_pk_add_f32 v[92:93], v[92:93], v[90:91]
    v_pk_fma_f32 v[94:95], v[90:91], v[90:91], v[94:95]
    v_add_f32 v96, v92, v93
    v_add_f32 v97, v94, v95
    v_mov_b32 v92, v96
    v_mov_b32 v93, v97
    s_nop 0
    v_permlane16_swap_b32 v96, v92
    v_permlane16_swap_b32 v97, v93
    v_add_f32 v96, v96, v92
    v_add_f32 v97, v97, v93
    v_mov_b32 v92, v96
    v_mov_b32 v93, v97
    s_nop 0
    v_permlane32_swap_b32 v96, v92
    v_permlane32_swap_b32 v97, v93
    v_add_f32 v96, v96, v92
    v_add_f32 v97, v97, v93
    s_mov_b32 s24, 18874368
    s_mov_b64 exec, 0xffff
    buffer_store_dwordx2 v[96:97], v14, s[4:7], s24 offen sc1
    s_mov_b64 exec, -1
    s_movk_i32 s79, 30000
L_xch_28:
    buffer_load_dwordx2 v[92:93], v15, s[4:7], 0 offen sc1
    buffer_load_dwordx2 v[94:95], v15, s[4:7], 0 offen offset:128 sc1
    s_waitcnt vmcnt(0)
    v_max_u32 v96, v93, v95
    v_cmp_eq_u32 vcc, -1, v96
    s_and_b64 vcc, exec, vcc
    s_cbranch_vccz L_xok_29
    s_sub_u32 s79, s79, 1
    s_cbranch_scc0 L_xch_28
L_xok_29:
    v_add_f32 v92, v92, v94
    v_add_f32 v93, v93, v95
    v_mov_b32 v94, v92
    v_mov_b32 v95, v93
    s_nop 0
    v_permlane16_swap_b32 v92, v94
    v_permlane16_swap_b32 v93, v95
    v_add_f32 v92, v92, v94
    v_add_f32 v93, v93, v95
    v_mov_b32 v94, v92
    v_mov_b32 v95, v93
    s_nop 0
    v_permlane32_swap_b32 v92, v94
    v_permlane32_swap_b32 v93, v95
    v_add_f32 v92, v92, v94
    v_add_f32 v93, v93, v95
    v_mul_f32 v92, s76, v92
    v_mul_f32 v94, v92, v92
    v_fma_f32 v93, v93, s76, -v94
    v_max_f32 v93, 0, v93
    v_cvt_pk_bf16_f32 v92, v92, v92
    v_lshlrev_b32 v92, 16, v92
    v_cvt_pk_bf16_f32 v93, v93, v93
    v_lshlrev_b32 v93, 16, v93
    v_add_f32 v93, 0x3727c5ac, v93
    v_cvt_pk_bf16_f32 v93, v93, v93
    v_lshlrev_b32 v93, 16, v93
    v_sqrt_f32 v93, v93
    s_nop 0
    v_cvt_pk_bf16_f32 v93, v93, v93
    v_lshlrev_b32 v93, 16, v93
    v_rcp_f32 v45, v93
    v_mov_b32 v44, v92
    s_add_u32 s8, s8, 16777216
    s_addc_u32 s9, s9, 0
    s_add_u32 s74, s74, 1024
    v_mul_f32 v46, v44, v45
    v_lshlrev_b32 v92, 16, v20
    v_and_b32 v93, 0xffff0000, v20
    v_pk_fma_f32 v[94:95], v[72:73], v[44:45], v[46:47] op_sel:[0,1,0] op_sel_hi:[1,1,0] neg_lo:[0,0,1] neg_hi:[0,0,1]
    v_pk_fma_f32 v[72:73], v[94:95], v[92:93], v[72:73]
    v_cvt_pk_bf16_f32 v30, v72, v73
    v_lshlrev_b32 v92, 16, v21
    v_and_b32 v93, 0xffff0000, v21
    v_pk_fma_f32 v[94:95], v[74:75], v[44:45], v[46:47] op_sel:[0,1,0] op_sel_hi:[1,1,0] neg_lo:[0,0,1] neg_hi:[0,0,1]
    v_pk_fma_f32 v[74:75], v[94:95], v[92:93], v[74:75]
    v_cvt_pk_bf16_f32 v31, v74, v75
    v_lshlrev_b32 v92, 16, v22
    v_and_b32 v93, 0xffff0000, v22
    v_pk_fma_f32 v[94:95], v[76:77], v[44:45], v[46:47] op_sel:[0,1,0] op_sel_hi:[1,1,0] neg_lo:[0,0,1] neg_hi:[0,0,1]
    v_pk_fma_f32 v[76:77], v[94:95], v[92:93], v[76:77]
    v_cvt_pk_bf16_f32 v32, v76, v77
    v_lshlrev_b32 v92, 16, v23
    v_and_b32 v93, 0xffff0000, v23
    v_pk_fma_f32 v[94:95], v[78:79], v[44:45], v[46:47] op_sel:[0,1,0] op_sel_hi:[1,1,0] neg_lo:[0,0,1] neg_hi:[0,0,1]
    v_pk_fma_f32 v[78:79], v[94:95], v[92:93], v[78:79]
    v_cvt_pk_bf16_f32 v33, v78, v79
    s_nop 1
    v_permlane16_swap_b32 v30, v32
    v_permlane16_swap_b32 v31, v33
    buffer_store_dwordx4 v[30:33], v13, s[8:11], s72 offen offset:0 sc1
    v_lshlrev_b32 v92, 16, v24
    v_and_b32 v93, 0xffff0000, v24
    v_pk_fma_f32 v[94:95], v[80:81], v[44:45], v[46:47] op_sel:[0,1,0] op_sel_hi:[1,1,0] neg_lo:[0,0,1] neg_hi:[0,0,1]
    v_pk_fma_f32 v[80:81], v[94:95], v[92:93], v[80:81]
    v_cvt_pk_bf16_f32 v34, v80, v81
    v_lshlrev_b32 v92, 16, v25
    v_and_b32 v93, 0xffff0000, v25
    v_pk_fma_f32 v[94:95], v[82:83], v[44:45], v[46:47] op_sel:[0,1,0] op_sel_hi:[1,1,0] neg_lo:[0,0,1] neg_hi:[0,0,1]
    v_pk_fma_f32 v[82:83], v[94:95], v[92:93], v[82:83]
    v_cvt_pk_bf16_f32 v35, v82, v83
    v_lshlrev_b32 v92, 16, v26
    v_and_b32 v93, 0xffff0000, v26
    v_pk_fma_f32 v[94:95], v[84:85], v[44:45], v[46:47] op_sel:[0,1,0] op_sel_hi:[1,1,0] neg_lo:[0,0,1] neg_hi:[0,0,1]
    v_pk_fma_f32 v[84:85], v[94:95], v[92:93], v[84:85]
    v_cvt_pk_bf16_f32 v36, v84, v85
    v_lshlrev_b32 v92, 16, v27
    v_and_b32 v93, 0xffff0000, v27
    v_pk_fma_f32 v[94:95], v[86:87], v[44:45], v[46:47] op_sel:[0,1,0] op_sel_hi:[1,1,0] neg_lo:[0,0,1] neg_hi:[0,0,1]
    v_pk_fma_f32 v[86:87], v[94:95], v[92:93], v[86:87]
    v_cvt_pk_bf16_f32 v37, v86, v87
    s_nop 1
    v_permlane16_swap_b32 v34, v36
    v_permlane16_swap_b32 v35, v37
    buffer_store_dwordx4 v[34:37], v13, s[8:11], s72 offen offset:2048 sc1
    v_lshlrev_b32 v92, 16, v28
    v_and_b32 v93, 0xffff0000, v28
    v_pk_fma_f32 v[94:95], v[88:89], v[44:45], v[46:47] op_sel:[0,1,0] op_sel_hi:[1,1,0] neg_lo:[0,0,1] neg_hi:[0,0,1]
    v_pk_fma_f32 v[88:89], v[94:95], v[92:93], v[88:89]
    v_cvt_pk_bf16_f32 v38, v88, v89
    v_lshlrev_b32 v92, 16, v29
    v_and_b32 v93, 0xffff0000, v29
    v_pk_fma_f32 v[94:95], v[90:91], v[44:45], v[46:47] op_sel:[0,1,0] op_sel_hi:[1,1,0] neg_lo:[0,0,1] neg_hi:[0,0,1]
    v_pk_fma_f32 v[90:91], v[94:95], v[92:93], v[90:91]
    v_cvt_pk_bf16_f32 v39, v90, v91
    s_add_u32 s24, s72, 4096
    s_nop 1
    v_permlane16_swap_b32 v38, v40
    v_permlane16_swap_b32 v39, v41
    s_mov_b32 exec_lo, 0xffff
    s_mov_b32 exec_hi, 0xffff
    buffer_store_dwordx4 v[38:41], v13, s[8:11], s24 offen sc1
    s_mov_b64 exec, -1
    v_pk_add_f32 v[92:93], v[72:73], v[74:75]
    v_pk_mul_f32 v[94:95], v[72:73], v[72:73]
    v_pk_fma_f32 v[94:95], v[74:75], v[74:75], v[94:95]
    v_pk_add_f32 v[92:93], v[92:93], v[76:77]
    v_pk_fma_f32 v[94:95], v[76:77], v[76:77], v[94:95]
    v_pk_add_f32 v[92:93], v[92:93], v[78:79]
    v_pk_fma_f32 v[94:95], v[78:79], v[78:79], v[94:95]
    v_pk_add_f32 v[92:93], v[92:93], v[80:81]
    v_pk_fma_f32 v[94:95], v[80:81], v[80:81], v[94:95]
    v_pk_add_f32 v[92:93], v[92:93], v[82:83]
    v_pk_fma_f32 v[94:95], v[82:83], v[82:83], v[94:95]
    v_pk_add_f32 v[92:93], v[92:93], v[84:85]
    v_pk_fma_f32 v[94:95], v[84:85], v[84:85], v[94:95]
    v_pk_add_f32 v[92:93], v[92:93], v[86:87]
    v_pk_fma_f32 v[94:95], v[86:87], v[86:87], v[94:95]
    v_pk_add_f32 v[92:93], v[92:93], v[88:89]
    v_pk_fma_f32 v[94:95], v[88:89], v[88:89], v[94:95]
    v_pk_add_f32 v[92:93], v[92:93], v[90:91]
    v_pk_fma_f32 v[94:95], v[90:91], v[90:91], v[94:95]
    v_add_f32 v96, v92, v93
    v_add_f32 v97, v94, v95
    v_mov_b32 v92, v96
    v_mov_b32 v93, v97
    s_nop 0
    v_permlane16_swap_b32 v96, v92
    v_permlane16_swap_b32 v97, v93
    v_add_f32 v96, v96, v92
    v_add_f32 v97, v97, v93
    v_mov_b32 v92, v96
    v_mov_b32 v93, v97
    s_nop 0
    v_permlane32_swap_b32 v96, v92
    v_permlane32_swap_b32 v97, v93
    v_add_f32 v96, v96, v92
    v_add_f32 v97, v97, v93
    s_mov_b32 s24, 3145728
    s_mov_b64 exec, 0xffff
    buffer_store_dwordx2 v[96:97], v14, s[8:11], s24 offen sc1
    s_mov_b64 exec, -1
    s_waitcnt vmcnt(0)
    s_barrier
    s_cmp_lg_u32 s20, 0
    s_cbranch_scc1 L_sig_30
    s_mov_b64 exec, 1
    buffer_atomic_add v18, off, s[4:7], s74 offset:0 sc1
    s_mov_b64 exec, -1
L_sig_30:
    s_cmp_eq_u32 s20, 0
    s_cbranch_scc1 L_nosh_31
    s_cmp_eq_u32 s20, 2
    s_cselect_b32 s25, s33, s32
    s_cmp_eq_u32 s20, 3
    s_cselect_b32 s25, s34, s25
    s_lshl_b32 s26, s20, 12
    s_add_u32 m0, s26, 86016
    s_add_u32 s25, s25, s44
    buffer_load_dwordx4 v2, s[4:7], s25 offen offset:0 sc1 lds
    buffer_load_dwordx4 v2, s[4:7], s25 offen offset:1024 sc1 lds
    buffer_load_dwordx4 v2, s[4:7], s25 offen offset:2048 sc1 lds
    buffer_load_dwordx4 v2, s[4:7], s25 offen offset:3072 sc1 lds
    s_cmp_eq_u32 s20, 2
    s_cselect_b32 s25, s36, s35
    s_cmp_eq_u32 s20, 3
    s_cselect_b32 s25, s37, s25
    s_lshl_b32 s26, s20, 12
    s_add_u32 m0, s26, 98304
    s_add_u32 s25, s25, s44
    buffer_load_dwordx4 v2, s[4:7], s25 offen offset:0 sc1 lds
    buffer_load_dwordx4 v2, s[4:7], s25 offen offset:1024 sc1 lds
    buffer_load_dwordx4 v2, s[4:7], s25 offen offset:2048 sc1 lds
    buffer_load_dwordx4 v2, s[4:7], s25 offen offset:3072 sc1 lds
    s_cmp_eq_u32 s20, 2
    s_cselect_b32 s25, s39, s38
    s_cmp_eq_u32 s20, 3
    s_cselect_b32 s25, s40, s25
    s_lshl_b32 s26, s20, 12
    s_add_u32 m0, s26, 110592
    s_add_u32 s25, s25, s44
    buffer_load_dwordx4 v2, s[4:7], s25 offen offset:0 sc1 lds
    buffer_load_dwordx4 v2, s[4:7], s25 offen offset:1024 sc1 lds
    buffer_load_dwordx4 v2, s[4:7], s25 offen offset:2048 sc1 lds
    buffer_load_dwordx4 v2, s[4:7], s25 offen offset:3072 sc1 lds
    s_cmp_lg_u32 s20, 1
    s_cbranch_scc1 L_nosh_31
    s_mov_b32 s25, s41
    s_lshl_b32 s26, s20, 12
    s_add_u32 m0, s26, 122880
    s_add_u32 s25, s25, s44
    buffer_load_dwordx4 v2, s[4:7], s25 offen offset:0 sc1 lds
    buffer_load_dwordx4 v2, s[4:7], s25 offen offset:1024 sc1 lds
    buffer_load_dwordx4 v2, s[4:7], s25 offen offset:2048 sc1 lds
    buffer_load_dwordx4 v2, s[4:7], s25 offen offset:3072 sc1 lds
L_nosh_31:
    s_cmp_lg_u32 s20, 0
    s_cbranch_scc1 L_got_32
    s_movk_i32 s79, 30000
L_spin_33:
    buffer_load_dword v19, off, s[4:7], s74 offset:0 sc1
    s_waitcnt vmcnt(0)
    v_readfirstlane_b32 s24, v19
    s_cmp_ge_u32 s24, 16
    s_cbranch_scc1 L_got_32
    s_sub_u32 s79, s79, 1
    s_cbranch_scc0 L_spin_33
    s_branch L_got_32
L_got_32:
    s_barrier
    buffer_load_dwordx4 a[0:3], v47, s[8:11], s32 offen offset:0 sc1
    buffer_load_dwordx4 a[4:7], v47, s[8:11], s32 offen offset:1024 sc1
    buffer_load_dwordx4 a[8:11], v47, s[8:11], s32 offen offset:2048 sc1
    buffer_load_dwordx4 a[12:15], v47, s[8:11], s32 offen offset:3072 sc1
    buffer_load_dwordx4 a[16:19], v47, s[8:11], s33 offen offset:0 sc1
    buffer_load_dwordx4 a[20:23], v47, s[8:11], s33 offen offset:1024 sc1
    buffer_load_dwordx4 a[24:27], v47, s[8:11], s33 offen offset:2048 sc1
    buffer_load_dwordx4 a[28:31], v47, s[8:11], s33 offen offset:3072 sc1
    v_and_b32 v80, 15, v1
    v_lshlrev_b32 v80, 3, v80
    v_lshrrev_b32 v81, 5, v1
    v_lshl_add_u32 v80, v81, 9, v80
    v_bfe_u32 v81, v1, 4, 1
    v_lshl_add_u32 v80, v81, 10, v80
    buffer_load_dwordx2 v[72:73], v80, s[8:11], s70 offen offset:0 sc1
    buffer_load_dwordx2 v[74:75], v80, s[8:11], s70 offen offset:128 sc1
    buffer_load_dwordx2 v[76:77], v80, s[8:11], s70 offen offset:256 sc1
    buffer_load_dwordx2 v[78:79], v80, s[8:11], s70 offen offset:384 sc1
    s_waitcnt vmcnt(11)
    s_barrier
    ds_read_b128 v[48:51], v2 offset:8192
    ds_read_b128 v[52:55], v2 offset:12288
    ds_read_b128 v[56:59], v4 offset:24576
    ds_read_b128 v[60:63], v2 offset:9216
    ds_read_b128 v[64:67], v2 offset:13312
    ds_read_b128 v[68:71], v4 offset:25600
    s_waitcnt lgkmcnt(2)
    v_mfma_f32_32x32x16_bf16 v[92:107], v[48:51], a[0:3], 0
    ds_read_b128 v[84:87], v2 offset:10240
    buffer_load_dwordx4 a[32:35], v47, s[8:11], s34 offen offset:0 sc1
    v_mfma_f32_32x32x16_bf16 v[108:123], v[52:55], a[0:3], 0
    ds_read_b128 v[88:91], v2 offset:14336
    v_mfma_f32_32x32x16_bf16 v[124:139], v[56:59], a[0:3], 0
    ds_read_b128 v[48:51], v4 offset:26624
    buffer_load_dwordx4 a[36:39], v47, s[8:11], s34 offen offset:1024 sc1
    v_permlane16_swap_b32 v30, v32
    s_waitcnt vmcnt(12)
    v_mfma_f32_32x32x16_bf16 v[92:107], v[60:63], a[4:7], v[92:107]
    ds_read_b128 v[52:55], v2 offset:11264
    v_permlane16_swap_b32 v31, v33
    s_waitcnt lgkmcnt(2)
    v_mfma_f32_32x32x16_bf16 v[108:123], v[64:67], a[4:7], v[108:123]
    ds_read_b128 v[56:59], v2 offset:15360
    v_add_u32 v6, s45, v3
    s_add_u32 m0, s75, 40960
    v_permlane16_swap_b32 v34, v36
    v_mfma_f32_32x32x16_bf16 v[124:139], v[68:71], a[4:7], v[124:139]
    ds_read_b128 v[60:63], v4 offset:27648
    buffer_load_dwordx4 a[40:43], v47, s[8:11], s34 offen offset:2048 sc1
    v_permlane16_swap_b32 v35, v37
    s_waitcnt vmcnt(12)
    v_mfma_f32_32x32x16_bf16 v[92:107], v[84:87], a[8:11], v[92:107]
    ds_read_b128 v[64:67], v2 offset:16384
    buffer_load_dwordx4 v6, s[4:7], s32 offen sc1 lds
    v_mfma_f32_32x32x16_bf16 v[108:123], v[88:91], a[8:11], v[108:123]
    ds_read_b128 v[68:71], v2 offset:20480
    buffer_load_dwordx4 a[44:47], v47, s[8:11], s34 offen offset:3072 sc1
    v_permlane16_swap_b32 v38, v40
    s_waitcnt lgkmcnt(2)
    v_mfma_f32_32x32x16_bf16 v[124:139], v[48:51], a[8:11], v[124:139]
    ds_read_b128 v[84:87], v4 offset:28672
    s_add_u32 m0, s75, 45056
    s_nop 0
    buffer_load_dwordx4 v6, s[4:7], s33 offen sc1 lds
    v_permlane16_swap_b32 v39, v41
    s_waitcnt vmcnt(14)
    v_mfma_f32_32x32x16_bf16 v[92:107], v[52:55], a[12:15], v[92:107]
    ds_read_b128 v[88:91], v2 offset:17408
    v_mfma_f32_32x32x16_bf16 v[108:123], v[56:59], a[12:15], v[108:123]
    ds_read_b128 v[48:51], v2 offset:21504
    buffer_load_dwordx4 a[48:51], v47, s[8:11], s35 offen offset:0 sc1
    v_mfma_f32_32x32x16_bf16 v[124:139], v[60:63], a[12:15], v[124:139]
    ds_read_b128 v[52:55], v4 offset:29696
    s_add_u32 m0, s75, 49152
    s_waitcnt lgkmcnt(2)
    s_waitcnt vmcnt(14)
    v_mfma_f32_32x32x16_bf16 v[92:107], v[64:67], a[16:19], v[92:107]
    ds_read_b128 v[56:59], v2 offset:18432
    buffer_load_dwordx4 a[52:55], v47, s[8:11], s35 offen offset:1024 sc1
    v_mfma_f32_32x32x16_bf16 v[108:123], v[68:71], a[16:19], v[108:123]
    ds_read_b128 v[60:63], v2 offset:22528
    buffer_load_dwordx4 v6, s[4:7], s34 offen sc1 lds
    v_mfma_f32_32x32x16_bf16 v[124:139], v[84:87], a[16:19], v[124:139]
    ds_read_b128 v[64:67], v4 offset:30720
    s_add_u32 m0, s75, 53248
    s_waitcnt vmcnt(15)
    v_mfma_f32_32x32x16_bf16 v[92:107], v[88:91], a[20:23], v[92:107]
    ds_read_b128 v[68:71], v2 offset:19456
    buffer_load_dwordx4 a[56:59], v47, s[8:11], s35 offen offset:2048 sc1
    s_waitcnt lgkmcnt(2)
    v_mfma_f32_32x32x16_bf16 v[108:123], v[48:51], a[20:23], v[108:123]
    ds_read_b128 v[84:87], v2 offset:23552
    buffer_load_dwordx4 v6, s[4:7], s35 offen sc1 lds
    v_mfma_f32_32x32x16_bf16 v[124:139], v[52:55], a[20:23], v[124:139]
    ds_read_b128 v[88:91], v4 offset:31744
    buffer_load_dwordx4 a[60:63], v47, s[8:11], s35 offen offset:3072 sc1
    s_waitcnt vmcnt(17)
    v_mfma_f32_32x32x16_bf16 v[92:107], v[56:59], a[24:27], v[92:107]
    ds_read_b128 v[48:51], v2 offset:24576
    s_add_u32 m0, s75, 57344
    v_mfma_f32_32x32x16_bf16 v[108:123], v[60:63], a[24:27], v[108:123]
    ds_read_b128 v[52:55], v2 offset:28672
    buffer_load_dwordx4 v6, s[4:7], s36 offen sc1 lds
    s_waitcnt lgkmcnt(2)
    v_mfma_f32_32x32x16_bf16 v[124:139], v[64:67], a[24:27], v[124:139]
    ds_read_b128 v[56:59], v4 offset:32768
    s_waitcnt vmcnt(13)
    v_add_f32 v72, v72, v74
    v_add_f32 v73, v73, v75
    v_add_f32 v76, v76, v78
    v_mfma_f32_32x32x16_bf16 v[92:107], v[68:71], a[28:31], v[92:107]
    ds_read_b128 v[60:63], v2 offset:25600
    buffer_load_dwordx4 a[64:67], v47, s[8:11], s36 offen offset:0 sc1
    v_add_f32 v77, v77, v79
    s_add_u32 m0, s75, 61440
    v_mfma_f32_32x32x16_bf16 v[108:123], v[84:87], a[28:31], v[108:123]
    ds_read_b128 v[64:67], v2 offset:29696
    v_add_f32 v72, v72, v76
    v_add_f32 v73, v73, v77
    v_mov_b32 v74, v72
    v_mfma_f32_32x32x16_bf16 v[124:139], v[88:91], a[28:31], v[124:139]
    ds_read_b128 v[68:71], v4 offset:33792
    buffer_load_dwordx4 a[68:71], v47, s[8:11], s36 offen offset:1024 sc1
    v_mov_b32 v75, v73
    s_waitcnt lgkmcnt(2)
    s_waitcnt vmcnt(14)
    v_mfma_f32_32x32x16_bf16 v[92:107], v[48:51], a[32:35], v[92:107]
    ds_read_b128 v[84:87], v2 offset:26624
    buffer_load_dwordx4 v6, s[4:7], s37 offen sc1 lds
    s_nop 0
    v_mfma_f32_32x32x16_bf16 v[108:123], v[52:55], a[32:35], v[108:123]
    ds_read_b128 v[88:91], v2 offset:30720
    s_add_u32 m0, s75, 65536
    v_permlane32_swap_b32 v72, v74
    v_mfma_f32_32x32x16_bf16 v[124:139], v[56:59], a[32:35], v[124:139]
    ds_read_b128 v[48:51], v4 offset:34816
    buffer_load_dwordx4 a[72:75], v47, s[8:11], s36 offen offset:2048 sc1
    s_waitcnt vmcnt(15)
    v_mfma_f32_32x32x16_bf16 v[92:107], v[60:63], a[36:39], v[92:107]
    ds_read_b128 v[52:55], v2 offset:27648
    buffer_load_dwordx4 v6, s[4:7], s38 offen sc1 lds
    v_permlane32_swap_b32 v73, v75
    s_waitcnt lgkmcnt(2)
    v_mfma_f32_32x32x16_bf16 v[108:123], v[64:67], a[36:39], v[108:123]
    ds_read_b128 v[56:59], v2 offset:31744
    buffer_load_dwordx4 a[76:79], v47, s[8:11], s36 offen offset:3072 sc1
    v_add_f32 v72, v72, v74
    v_mfma_f32_32x32x16_bf16 v[124:139], v[68:71], a[36:39], v[124:139]
    ds_read_b128 v[60:63], v4 offset:35840
    s_add_u32 m0, s75, 69632
    s_nop 0
    buffer_load_dwordx4 v6, s[4:7], s39 offen sc1 lds
    s_waitcnt vmcnt(17)
    v_mfma_f32_32x32x16_bf16 v[92:107], v[84:87], a[40:43], v[92:107]
    ds_read_b128 v[64:67], v2 offset:32768
    v_add_f32 v73, v73, v75
    v_mfma_f32_32x32x16_bf16 v[108:123], v[88:91], a[40:43], v[108:123]
    ds_read_b128 v[68:71], v2 offset:36864
    buffer_load_dwordx4 a[80:83], v47, s[8:11], s37 offen offset:0 sc1
    s_waitcnt lgkmcnt(2)
    v_mfma_f32_32x32x16_bf16 v[124:139], v[48:51], a[40:43], v[124:139]
    ds_read_b128 v[84:87], v4 offset:36864
    v_mul_f32 v72, s76, v72
    s_waitcnt vmcnt(16)
    v_mfma_f32_32x32x16_bf16 v[92:107], v[52:55], a[44:47], v[92:107]
    ds_read_b128 v[88:91], v2 offset:33792
    buffer_load_dwordx4 a[84:87], v47, s[8:11], s37 offen offset:1024 sc1
    v_mul_f32 v74, v72, v72
    v_mfma_f32_32x32x16_bf16 v[108:123], v[56:59], a[44:47], v[108:123]
    ds_read_b128 v[48:51], v2 offset:37888
    v_mfma_f32_32x32x16_bf16 v[124:139], v[60:63], a[44:47], v[124:139]
    ds_read_b128 v[52:55], v4 offset:37888
    v_fma_f32 v73, v73, s76, -v74
    s_waitcnt lgkmcnt(2)
    s_waitcnt vmcnt(15)
    v_mfma_f32_32x32x16_bf16 v[92:107], v[64:67], a[48:51], v[92:107]
    ds_read_b128 v[56:59], v2 offset:34816
    buffer_load_dwordx4 a[88:91], v47, s[8:11], s37 offen offset:2048 sc1
    v_max_f32 v73, 0, v73
    v_mfma_f32_32x32x16_bf16 v[108:123], v[68:71], a[48:51], v[108:123]
    ds_read_b128 v[60:63], v2 offset:38912
    v_mfma_f32_32x32x16_bf16 v[124:139], v[84:87], a[48:51], v[124:139]
    ds_read_b128 v[64:67], v4 offset:38912
    buffer_load_dwordx4 a[92:95], v47, s[8:11], s37 offen offset:3072 sc1
    v_cvt_pk_bf16_f32 v72, v72, v72
    s_waitcnt vmcnt(16)
    v_mfma_f32_32x32x16_bf16 v[92:107], v[88:91], a[52:55], v[92:107]
    ds_read_b128 v[68:71], v2 offset:35840
    v_lshlrev_b32 v72, 16, v72
    s_waitcnt lgkmcnt(2)
    v_mfma_f32_32x32x16_bf16 v[108:123], v[48:51], a[52:55], v[108:123]
    ds_read_b128 v[84:87], v2 offset:39936
    v_mfma_f32_32x32x16_bf16 v[124:139], v[52:55], a[52:55], v[124:139]
    ds_read_b128 v[88:91], v4 offset:39936
    v_cvt_pk_bf16_f32 v73, v73, v73
    s_waitcnt vmcnt(14)
    v_mfma_f32_32x32x16_bf16 v[92:107], v[56:59], a[56:59], v[92:107]
    ds_read_b128 v[48:51], v2 offset:40960
    buffer_load_dwordx4 a[96:99], v47, s[8:11], s38 offen offset:0 sc1
    v_mfma_f32_32x32x16_bf16 v[108:123], v[60:63], a[56:59], v[108:123]
    ds_read_b128 v[52:55], v2 offset:45056
    v_lshlrev_b32 v73, 16, v73
    s_waitcnt lgkmcnt(2)
    v_mfma_f32_32x32x16_bf16 v[124:139], v[64:67], a[56:59], v[124:139]
    ds_read_b128 v[56:59], v4 offset:40960
    buffer_load_dwordx4 a[100:103], v47, s[8:11], s38 offen offset:1024 sc1
    v_add_f32 v73, 0x3727c5ac, v73
    s_waitcnt vmcnt(14)
    v_mfma_f32_32x32x16_bf16 v[92:107], v[68:71], a[60:63], v[92:107]
    ds_read_b128 v[60:63], v2 offset:41984
    v_mfma_f32_32x32x16_bf16 v[108:123], v[84:87], a[60:63], v[108:123]
    ds_read_b128 v[64:67], v2 offset:46080
    v_cvt_pk_bf16_f32 v73, v73, v73
    v_mfma_f32_32x32x16_bf16 v[124:139], v[88:91], a[60:63], v[124:139]
    ds_read_b128 v[68:71], v4 offset:41984
    buffer_load_dwordx4 a[104:107], v47, s[8:11], s38 offen offset:2048 sc1
    s_barrier
    s_waitcnt lgkmcnt(2)
    s_waitcnt vmcnt(13)
    v_mfma_f32_32x32x16_bf16 v[92:107], v[48:51], a[64:67], v[92:107]
    ds_read_b128 v[84:87], v2 offset:43008
    s_add_u32 m0, s75, 0
    s_nop 0
    buffer_load_dwordx4 v6, s[4:7], s40 offen sc1 lds
    v_lshlrev_b32 v73, 16, v73
    v_mfma_f32_32x32x16_bf16 v[108:123], v[52:55], a[64:67], v[108:123]
    ds_read_b128 v[88:91], v2 offset:47104
    buffer_load_dwordx4 a[108:111], v47, s[8:11], s38 offen offset:3072 sc1
    v_mfma_f32_32x32x16_bf16 v[124:139], v[56:59], a[64:67], v[124:139]
    ds_read_b128 v[48:51], v4 offset:43008
    v_sqrt_f32 v73, v73
    s_add_u32 m0, s75, 4096
    s_waitcnt vmcnt(14)
    v_mfma_f32_32x32x16_bf16 v[92:107], v[60:63], a[68:71], v[92:107]
    ds_read_b128 v[52:55], v2 offset:44032
    buffer_load_dwordx4 v6, s[4:7], s41 offen sc1 lds
    s_waitcnt lgkmcnt(2)
    v_mfma_f32_32x32x16_bf16 v[108:123], v[64:67], a[68:71], v[108:123]
    ds_read_b128 v[56:59], v2 offset:48128
    buffer_load_dwordx4 a[112:115], v47, s[8:11], s39 offen offset:0 sc1
    s_nop 0
    v_mfma_f32_32x32x16_bf16 v[124:139], v[68:71], a[68:71], v[124:139]
    ds_read_b128 v[60:63], v4 offset:44032
    v_cvt_pk_bf16_f32 v73, v73, v73
    s_waitcnt vmcnt(14)
    v_mfma_f32_32x32x16_bf16 v[92:107], v[84:87], a[72:75], v[92:107]
    ds_read_b128 v[64:67], v2 offset:49152
    buffer_load_dwordx4 a[116:119], v47, s[8:11], s39 offen offset:1024 sc1
    v_add_u32 v6, s46, v3
    v_mfma_f32_32x32x16_bf16 v[108:123], v[88:91], a[72:75], v[108:123]
    ds_read_b128 v[68:71], v2 offset:53248
    s_add_u32 m0, s75, 8192
    v_lshlrev_b32 v73, 16, v73
    s_waitcnt lgkmcnt(2)
    v_mfma_f32_32x32x16_bf16 v[124:139], v[48:51], a[72:75], v[124:139]
    ds_read_b128 v[84:87], v4 offset:45056
    buffer_load_dwordx4 v6, s[4:7], s32 offen sc1 lds
    s_waitcnt vmcnt(14)
    v_mfma_f32_32x32x16_bf16 v[92:107], v[52:55], a[76:79], v[92:107]
    ds_read_b128 v[88:91], v2 offset:50176
    buffer_load_dwordx4 a[120:123], v47, s[8:11], s39 offen offset:2048 sc1
    v_mfma_f32_32x32x16_bf16 v[108:123], v[56:59], a[76:79], v[108:123]
    ds_read_b128 v[48:51], v2 offset:54272
    v_rcp_f32 v74, v73
    s_add_u32 m0, s75, 12288
    v_mfma_f32_32x32x16_bf16 v[124:139], v[60:63], a[76:79], v[124:139]
    ds_read_b128 v[52:55], v4 offset:46080
    buffer_load_dwordx4 a[124:127], v47, s[8:11], s39 offen offset:3072 sc1
    s_waitcnt lgkmcnt(2)
    s_waitcnt vmcnt(14)
    v_mfma_f32_32x32x16_bf16 v[92:107], v[64:67], a[80:83], v[92:107]
    ds_read_b128 v[56:59], v2 offset:51200
    buffer_load_dwordx4 v6, s[4:7], s33 offen sc1 lds
    v_mul_f32 v46, v73, v73
    v_mfma_f32_32x32x16_bf16 v[108:123], v[68:71], a[80:83], v[108:123]
    ds_read_b128 v[60:63], v2 offset:55296
    v_xor_b32 v72, 0x80000000, v72
    v_mfma_f32_32x32x16_bf16 v[124:139], v[84:87], a[80:83], v[124:139]
    ds_read_b128 v[64:67], v4 offset:47104
    s_waitcnt vmcnt(14)
    v_mfma_f32_32x32x16_bf16 v[92:107], v[88:91], a[84:87], v[92:107]
    ds_read_b128 v[68:71], v2 offset:52224
    buffer_load_dwordx4 a[128:131], v47, s[8:11], s40 offen offset:0 sc1
    v_mul_f32 v44, 0xc0135761, v74
    s_waitcnt lgkmcnt(2)
    v_mfma_f32_32x32x16_bf16 v[108:123], v[48:51], a[84:87], v[108:123]
    ds_read_b128 v[84:87], v2 offset:56320
    v_mul_f32 v75, v74, v74
    v_mfma_f32_32x32x16_bf16 v[124:139], v[52:55], a[84:87], v[124:139]
    ds_read_b128 v[88:91], v4 offset:48128
    buffer_load_dwordx4 a[132:135], v47, s[8:11], s40 offen offset:1024 sc1
    s_waitcnt vmcnt(15)
    v_mfma_f32_32x32x16_bf16 v[92:107], v[56:59], a[88:91], v[92:107]
    ds_read_b128 v[48:51], v2 offset:57344
    v_lshrrev_b32 v76, 16, v72
    v_mfma_f32_32x32x16_bf16 v[108:123], v[60:63], a[88:91], v[108:123]
    ds_read_b128 v[52:55], v2 offset:61440
    v_mul_f32 v75, v75, v74
    s_waitcnt lgkmcnt(2)
    v_mfma_f32_32x32x16_bf16 v[124:139], v[64:67], a[88:91], v[124:139]
    ds_read_b128 v[56:59], v4 offset:49152
    buffer_load_dwordx4 a[136:139], v47, s[8:11], s40 offen offset:2048 sc1
    s_waitcnt vmcnt(15)
    v_mfma_f32_32x32x16_bf16 v[92:107], v[68:71], a[92:95], v[92:107]
    ds_read_b128 v[60:63], v2 offset:58368
    v_or_b32 v72, v72, v76
    v_mfma_f32_32x32x16_bf16 v[108:123], v[84:87], a[92:95], v[108:123]
    ds_read_b128 v[64:67], v2 offset:62464
    buffer_load_dwordx4 a[140:143], v47, s[8:11], s40 offen offset:3072 sc1
    v_mfma_f32_32x32x16_bf16 v[124:139], v[88:91], a[92:95], v[124:139]
    ds_read_b128 v[68:71], v4 offset:50176
    v_mul_f32 v45, 0xbdd2d3e8, v75
    s_waitcnt lgkmcnt(2)
    s_waitcnt vmcnt(15)
    v_mfma_f32_32x32x16_bf16 v[92:107], v[48:51], a[96:99], v[92:107]
    ds_read_b128 v[84:87], v2 offset:59392
    v_mov_b32 v40, v72
    v_mfma_f32_32x32x16_bf16 v[108:123], v[52:55], a[96:99], v[108:123]
    ds_read_b128 v[88:91], v2 offset:63488
    buffer_load_dwordx4 a[144:147], v47, s[8:11], s41 offen offset:0 sc1
    v_mfma_f32_32x32x16_bf16 v[124:139], v[56:59], a[96:99], v[124:139]
    ds_read_b128 v[48:51], v4 offset:51200
    v_mov_b32 v41, v76
    s_waitcnt vmcnt(15)
    v_mfma_f32_32x32x16_bf16 v[92:107], v[60:63], a[100:103], v[92:107]
    ds_read_b128 v[52:55], v2 offset:60416
    buffer_load_dwordx4 a[148:151], v47, s[8:11], s41 offen offset:1024 sc1
    v_mov_b32 v42, v72
    s_waitcnt lgkmcnt(2)
    v_mfma_f32_32x32x16_bf16 v[108:123], v[64:67], a[100:103], v[108:123]
    ds_read_b128 v[56:59], v2 offset:64512
    v_mfma_f32_32x32x16_bf16 v[124:139], v[68:71], a[100:103], v[124:139]
    ds_read_b128 v[60:63], v4 offset:52224
    v_mov_b32 v43, v76
    s_waitcnt vmcnt(15)
    v_mfma_f32_32x32x16_bf16 v[92:107], v[84:87], a[104:107], v[92:107]
    ds_read_b128 v[64:67], v4 offset:0
    buffer_load_dwordx4 a[152:155], v47, s[8:11], s41 offen offset:2048 sc1
    v_mfma_f32_32x32x16_bf16 v[108:123], v[88:91], a[104:107], v[108:123]
    ds_read_b128 v[68:71], v4 offset:4096
    s_waitcnt lgkmcnt(2)
    v_mfma_f32_32x32x16_bf16 v[124:139], v[48:51], a[104:107], v[124:139]
    ds_read_b128 v[84:87], v4 offset:53248
    buffer_load_dwordx4 a[156:159], v47, s[8:11], s41 offen offset:3072 sc1
    s_waitcnt vmcnt(15)
    v_mfma_f32_32x32x16_bf16 v[92:107], v[52:55], a[108:111], v[92:107]
    ds_read_b128 v[88:91], v4 offset:1024
    v_mfma_f32_32x32x16_bf16 v[108:123], v[56:59], a[108:111], v[108:123]
    ds_read_b128 v[48:51], v4 offset:5120
    v_mfma_f32_32x32x16_bf16 v[124:139], v[60:63], a[108:111], v[124:139]
    ds_read_b128 v[52:55], v4 offset:54272
    s_waitcnt lgkmcnt(2)
    s_waitcnt vmcnt(13)
    v_mfma_f32_32x32x16_bf16 v[92:107], v[64:67], a[112:115], v[92:107]
    ds_read_b128 v[56:59], v4 offset:2048
    v_mfma_f32_32x32x16_bf16 v[108:123], v[68:71], a[112:115], v[108:123]
    ds_read_b128 v[60:63], v4 offset:6144
    v_mfma_f32_32x32x16_bf16 v[124:139], v[84:87], a[112:115], v[124:139]
    ds_read_b128 v[64:67], v4 offset:55296
    s_waitcnt vmcnt(12)
    v_mfma_f32_32x32x16_bf16 v[92:107], v[88:91], a[116:119], v[92:107]
    ds_read_b128 v[68:71], v4 offset:3072
    s_waitcnt lgkmcnt(2)
    v_mfma_f32_32x32x16_bf16 v[108:123], v[48:51], a[116:119], v[108:123]
    ds_read_b128 v[84:87], v4 offset:7168
    v_mfma_f32_32x32x16_bf16 v[124:139], v[52:55], a[116:119], v[124:139]
    ds_read_b128 v[88:91], v4 offset:56320
    s_waitcnt vmcnt(10)
    v_mfma_f32_32x32x16_bf16 v[92:107], v[56:59], a[120:123], v[92:107]
    ds_read_b128 v[48:51], v4 offset:8192
    v_mfma_f32_32x32x16_bf16 v[108:123], v[60:63], a[120:123], v[108:123]
    ds_read_b128 v[52:55], v4 offset:9216
    s_waitcnt lgkmcnt(2)
    v_mfma_f32_32x32x16_bf16 v[124:139], v[64:67], a[120:123], v[124:139]
    ds_read_b128 v[56:59], v4 offset:10240
    s_waitcnt vmcnt(9)
    v_mfma_f32_32x32x16_bf16 v[92:107], v[68:71], a[124:127], v[92:107]
    ds_read_b128 v[60:63], v4 offset:11264
    v_mfma_f32_32x32x16_bf16 v[108:123], v[84:87], a[124:127], v[108:123]
    ds_read_b128 v[64:67], v4 offset:16384
    v_mfma_f32_32x32x16_bf16 v[124:139], v[88:91], a[124:127], v[124:139]
    ds_read_b128 v[68:71], v4 offset:17408
    s_barrier
    s_waitcnt lgkmcnt(2)
    s_waitcnt vmcnt(7)
    v_mfma_f32_32x32x16_bf16 v[92:107], v[48:51], a[128:131], v[92:107]
    ds_read_b128 v[84:87], v4 offset:18432
    s_add_u32 m0, s75, 16384
    s_nop 0
    buffer_load_dwordx4 v6, s[4:7], s34 offen sc1 lds
    s_waitcnt vmcnt(7)
    v_mfma_f32_32x32x16_bf16 v[92:107], v[52:55], a[132:135], v[92:107]
    ds_read_b128 v[88:91], v4 offset:19456
    s_waitcnt vmcnt(6)
    v_mfma_f32_32x32x16_bf16 v[92:107], v[56:59], a[136:139], v[92:107]
    ds_read_b128 v[48:51], v2 offset:0
    s_add_u32 m0, s75, 20480
    s_waitcnt vmcnt(5)
    v_mfma_f32_32x32x16_bf16 v[92:107], v[60:63], a[140:143], v[92:107]
    ds_read_b128 v[52:55], v4 offset:12288
    buffer_load_dwordx4 v6, s[4:7], s35 offen sc1 lds
    s_waitcnt lgkmcnt(2)
    s_waitcnt vmcnt(5)
    v_mfma_f32_32x32x16_bf16 v[92:107], v[64:67], a[144:147], v[92:107]
    ds_read_b128 v[56:59], v4 offset:13312
    s_waitcnt vmcnt(4)
    v_mfma_f32_32x32x16_bf16 v[92:107], v[68:71], a[148:151], v[92:107]
    ds_read_b128 v[60:63], v4 offset:14336
    s_waitcnt vmcnt(3)
    v_mfma_f32_32x32x16_bf16 v[92:107], v[84:87], a[152:155], v[92:107]
    ds_read_b128 v[64:67], v4 offset:15360
    s_add_u32 m0, s75, 24576
    s_nop 0
    buffer_load_dwordx4 v6, s[4:7], s36 offen sc1 lds
    s_waitcnt vmcnt(3)
    v_mfma_f32_32x32x16_bf16 v[92:107], v[88:91], a[156:159], v[92:107]
    ds_read_b128 v[68:71], v4 offset:20480
    s_waitcnt lgkmcnt(2)
    v_mfma_f32_32x32x16_bf16 v[92:107], v[48:51], v[40:43], v[92:107]
    ds_read_b128 v[84:87], v4 offset:21504
    v_mfma_f32_32x32x16_bf16 v[108:123], v[52:55], a[128:131], v[108:123]
    ds_read_b128 v[88:91], v4 offset:22528
    s_add_u32 m0, s75, 28672
    v_mfma_f32_32x32x16_bf16 v[108:123], v[56:59], a[132:135], v[108:123]
    ds_read_b128 v[48:51], v4 offset:23552
    buffer_load_dwordx4 v6, s[4:7], s37 offen sc1 lds
    v_mfma_f32_32x32x16_bf16 v[108:123], v[60:63], a[136:139], v[108:123]
    ds_read_b128 v[52:55], v2 offset:1024
    s_waitcnt lgkmcnt(2)
    v_mfma_f32_32x32x16_bf16 v[108:123], v[64:67], a[140:143], v[108:123]
    ds_read_b128 v[56:59], v4 offset:57344
    v_mul_f32 v72, v92, v92
    v_mul_f32 v73, v93, v93
    v_fma_f32 v72, v72, v45, v44
    v_fma_f32 v73, v73, v45, v44
    v_mfma_f32_32x32x16_bf16 v[108:123], v[68:71], a[144:147], v[108:123]
    ds_read_b128 v[60:63], v4 offset:58368
    v_mul_f32 v72, v72, v92
    v_mul_f32 v73, v73, v93
    v_exp_f32 v72, v72
    v_mfma_f32_32x32x16_bf16 v[108:123], v[84:87], a[148:151], v[108:123]
    ds_read_b128 v[64:67], v4 offset:59392
    v_exp_f32 v73, v73
    v_mul_f32 v100, v92, v100
    v_fma_f32 v72, v72, v46, v46
    v_mfma_f32_32x32x16_bf16 v[108:123], v[88:91], a[152:155], v[108:123]
    ds_read_b128 v[68:71], v4 offset:60416
    v_fma_f32 v73, v73, v46, v46
    v_rcp_f32 v72, v72
    s_waitcnt lgkmcnt(2)
    v_mfma_f32_32x32x16_bf16 v[108:123], v[48:51], a[156:159], v[108:123]
    ds_read_b128 v[84:87], v4 offset:61440
    v_rcp_f32 v73, v73
    v_mul_f32 v101, v93, v101
    v_mul_f32 v100, v100, v72
    v_mfma_f32_32x32x16_bf16 v[108:123], v[52:55], v[40:43], v[108:123]
    ds_read_b128 v[88:91], v4 offset:62464
    v_mul_f32 v101, v101, v73
    v_cvt_pk_bf16_f32 v76, v100, v101
    v_mul_f32 v74, v94, v94
    v_mul_f32 v75, v95, v95
    v_mfma_f32_32x32x16_bf16 v[124:139], v[56:59], a[128:131], v[124:139]
    ds_read_b128 v[48:51], v4 offset:63488
    v_fma_f32 v74, v74, v45, v44
    v_fma_f32 v75, v75, v45, v44
    v_mul_f32 v74, v74, v94
    v_mul_f32 v75, v75, v95
    v_mfma_f32_32x32x16_bf16 v[124:139], v[60:63], a[132:135], v[124:139]
    ds_read_b128 v[52:55], v4 offset:64512
    v_exp_f32 v74, v74
    s_waitcnt lgkmcnt(2)
    v_mfma_f32_32x32x16_bf16 v[124:139], v[64:67], a[136:139], v[124:139]
    ds_read_b128 v[56:59], v2 offset:2048
    v_exp_f32 v75, v75
    s_barrier
    v_mfma_f32_32x32x16_bf16 v[124:139], v[68:71], a[140:143], v[124:139]
    ds_read_b128 v[60:63], v5 offset:0
    v_mul_f32 v102, v94, v102
    v_fma_f32 v74, v74, v46, v46
    v_fma_f32 v75, v75, v46, v46
    v_mfma_f32_32x32x16_bf16 v[124:139], v[84:87], a[144:147], v[124:139]
    ds_read_b128 v[64:67], v5 offset:1024
    v_rcp_f32 v74, v74
    v_rcp_f32 v75, v75
    v_mfma_f32_32x32x16_bf16 v[124:139], v[88:91], a[148:151], v[124:139]
    ds_read_b128 v[68:71], v5 offset:2048
    v_mul_f32 v103, v95, v103
    v_mul_f32 v102, v102, v74
    v_mul_f32 v103, v103, v75
    s_waitcnt lgkmcnt(2)
    v_mfma_f32_32x32x16_bf16 v[124:139], v[48:51], a[152:155], v[124:139]
    ds_read_b128 v[84:87], v5 offset:3072
    v_cvt_pk_bf16_f32 v77, v102, v103
    v_mul_f32 v72, v96, v96
    v_mul_f32 v73, v97, v97
    v_fma_f32 v72, v72, v45, v44
    v_mfma_f32_32x32x16_bf16 v[124:139], v[52:55], a[156:159], v[124:139]
    ds_read_b128 v[88:91], v5 offset:4096
    v_fma_f32 v73, v73, v45, v44
    v_mul_f32 v72, v72, v96
    v_mul_f32 v73, v73, v97
    v_mfma_f32_32x32x16_bf16 v[124:139], v[56:59], v[40:43], v[124:139]
    ds_read_b128 v[48:51], v5 offset:5120
    v_exp_f32 v72, v72
    v_exp_f32 v73, v73
    v_mfma_f32_32x32x16_bf16 v[140:155], v[60:63], a[0:3], 0
    ds_read_b128 v[52:55], v5 offset:6144
    v_mul_f32 v104, v96, v104
    v_fma_f32 v72, v72, v46, v46
    v_fma_f32 v73, v73, v46, v46
    s_waitcnt lgkmcnt(2)
    v_mfma_f32_32x32x16_bf16 v[140:155], v[64:67], a[4:7], v[140:155]
    ds_read_b128 v[56:59], v5 offset:7168
    v_rcp_f32 v72, v72
    v_rcp_f32 v73, v73
    v_mfma_f32_32x32x16_bf16 v[140:155], v[68:71], a[8:11], v[140:155]
    ds_read_b128 v[60:63], v5 offset:8192
    v_mul_f32 v105, v97, v105
    v_mul_f32 v104, v104, v72
    v_mul_f32 v105, v105, v73
    v_cvt_pk_bf16_f32 v78, v104, v105
    v_mfma_f32_32x32x16_bf16 v[140:155], v[84:87], a[12:15], v[140:155]
    ds_read_b128 v[64:67], v5 offset:9216
    v_mul_f32 v74, v98, v98
    v_mul_f32 v75, v99, v99
    v_fma_f32 v74, v74, v45, v44
    v_fma_f32 v75, v75, v45, v44
    v_mfma_f32_32x32x16_bf16 v[140:155], v[88:91], a[16:19], v[140:155]
    ds_read_b128 v[68:71], v5 offset:10240
    v_mul_f32 v74, v74, v98
    v_mul_f32 v75, v75, v99
    s_waitcnt lgkmcnt(2)
    v_mfma_f32_32x32x16_bf16 v[140:155], v[48:51], a[20:23], v[140:155]
    ds_read_b128 v[84:87], v5 offset:11264
    v_exp_f32 v74, v74
    v_exp_f32 v75, v75
    v_mfma_f32_32x32x16_bf16 v[140:155], v[52:55], a[24:27], v[140:155]
    ds_read_b128 v[88:91], v5 offset:12288
    v_mul_f32 v106, v98, v106
    v_fma_f32 v74, v74, v46, v46
    v_fma_f32 v75, v75, v46, v46
    v_mfma_f32_32x32x16_bf16 v[140:155], v[56:59], a[28:31], v[140:155]
    ds_read_b128 v[48:51], v5 offset:13312
    v_rcp_f32 v74, v74
    v_rcp_f32 v75, v75
    v_mfma_f32_32x32x16_bf16 v[140:155], v[60:63], a[32:35], v[140:155]
    ds_read_b128 v[52:55], v5 offset:14336
    v_mul_f32 v107, v99, v107
    v_mul_f32 v106, v106, v74
    v_mul_f32 v107, v107, v75
    s_waitcnt lgkmcnt(2)
    v_mfma_f32_32x32x16_bf16 v[140:155], v[64:67], a[36:39], v[140:155]
    ds_read_b128 v[56:59], v5 offset:15360
    v_cvt_pk_bf16_f32 v79, v106, v107
    buffer_store_dwordx4 v[76:79], v7, s[8:11], s49 offen sc1
    v_mfma_f32_32x32x16_bf16 v[140:155], v[68:71], a[40:43], v[140:155]
    ds_read_b128 v[60:63], v5 offset:16384
    v_mul_f32 v72, v108, v108
    v_mul_f32 v73, v109, v109
    v_fma_f32 v72, v72, v45, v44
    v_fma_f32 v73, v73, v45, v44
    v_mfma_f32_32x32x16_bf16 v[140:155], v[84:87], a[44:47], v[140:155]
    ds_read_b128 v[64:67], v5 offset:17408
    v_mul_f32 v72, v72, v108
    v_mul_f32 v73, v73, v109
    v_exp_f32 v72, v72
    v_mfma_f32_32x32x16_bf16 v[140:155], v[88:91], a[48:51], v[140:155]
    ds_read_b128 v[68:71], v5 offset:18432
    v_exp_f32 v73, v73
    v_mul_f32 v116, v108, v116
    s_waitcnt lgkmcnt(2)
    v_mfma_f32_32x32x16_bf16 v[140:155], v[48:51], a[52:55], v[140:155]
    ds_read_b128 v[84:87], v5 offset:19456
    v_fma_f32 v72, v72, v46, v46
    v_fma_f32 v73, v73, v46, v46
    v_rcp_f32 v72, v72
    v_mfma_f32_32x32x16_bf16 v[140:155], v[52:55], a[56:59], v[140:155]
    ds_read_b128 v[88:91], v5 offset:20480
    v_rcp_f32 v73, v73
    v_mul_f32 v117, v109, v117
    v_mul_f32 v116, v116, v72
    v_mfma_f32_32x32x16_bf16 v[140:155], v[56:59], a[60:63], v[140:155]
    ds_read_b128 v[48:51], v5 offset:21504
    v_mul_f32 v117, v117, v73
    v_cvt_pk_bf16_f32 v80, v116, v117
    v_mul_f32 v74, v110, v110
    v_mul_f32 v75, v111, v111
    v_mfma_f32_32x32x16_bf16 v[140:155], v[60:63], a[64:67], v[140:155]
    ds_read_b128 v[52:55], v5 offset:22528
    v_fma_f32 v74, v74, v45, v44
    v_fma_f32 v75, v75, v45, v44
    v_mul_f32 v74, v74, v110
    s_waitcnt lgkmcnt(2)
    v_mfma_f32_32x32x16_bf16 v[140:155], v[64:67], a[68:71], v[140:155]
    ds_read_b128 v[56:59], v5 offset:23552
    v_mul_f32 v75, v75, v111
    v_exp_f32 v74, v74
    v_mfma_f32_32x32x16_bf16 v[140:155], v[68:71], a[72:75], v[140:155]
    ds_read_b128 v[60:63], v5 offset:24576
    v_exp_f32 v75, v75
    v_mul_f32 v118, v110, v118
    v_fma_f32 v74, v74, v46, v46
    v_mfma_f32_32x32x16_bf16 v[140:155], v[84:87], a[76:79], v[140:155]
    ds_read_b128 v[64:67], v5 offset:25600
    v_fma_f32 v75, v75, v46, v46
    s_barrier
    v_mfma_f32_32x32x16_bf16 v[140:155], v[88:91], a[80:83], v[140:155]
    ds_read_b128 v[68:71], v5 offset:26624
    v_rcp_f32 v74, v74
    s_add_u32 m0, s75, 32768
    s_waitcnt lgkmcnt(2)
    v_mfma_f32_32x32x16_bf16 v[140:155], v[48:51], a[84:87], v[140:155]
    ds_read_b128 v[84:87], v5 offset:27648
    v_rcp_f32 v75, v75
    v_mul_f32 v119, v111, v119
    v_mul_f32 v118, v118, v74
    v_mfma_f32_32x32x16_bf16 v[140:155], v[52:55], a[88:91], v[140:155]
    ds_read_b128 v[88:91], v5 offset:28672
    v_mul_f32 v119, v119, v75
    buffer_load_dwordx4 v6, s[4:7], s38 offen sc1 lds
    s_add_u32 m0, s75, 36864
    v_mfma_f32_32x32x16_bf16 v[140:155], v[56:59], a[92:95], v[140:155]
    ds_read_b128 v[48:51], v5 offset:29696
    v_cvt_pk_bf16_f32 v81, v118, v119
    v_mul_f32 v72, v112, v112
    v_mul_f32 v73, v113, v113
    v_fma_f32 v72, v72, v45, v44
    v_mfma_f32_32x32x16_bf16 v[140:155], v[60:63], a[96:99], v[140:155]
    ds_read_b128 v[52:55], v5 offset:30720
    v_fma_f32 v73, v73, v45, v44
    v_mul_f32 v72, v72, v112
    v_mul_f32 v73, v73, v113
    s_waitcnt lgkmcnt(2)
    v_mfma_f32_32x32x16_bf16 v[140:155], v[64:67], a[100:103], v[140:155]
    ds_read_b128 v[56:59], v5 offset:31744
    v_exp_f32 v72, v72
    v_exp_f32 v73, v73
    v_mfma_f32_32x32x16_bf16 v[140:155], v[68:71], a[104:107], v[140:155]
    ds_read_b128 v[60:63], v4 offset:24576
    v_mul_f32 v120, v112, v120
    buffer_load_dwordx4 v6, s[4:7], s39 offen sc1 lds
    s_add_u32 m0, s75, 40960
    v_mfma_f32_32x32x16_bf16 v[140:155], v[84:87], a[108:111], v[140:155]
    ds_read_b128 v[64:67], v4 offset:25600
    v_fma_f32 v72, v72, v46, v46
    v_fma_f32 v73, v73, v46, v46
    v_rcp_f32 v72, v72
    v_mfma_f32_32x32x16_bf16 v[140:155], v[88:91], a[112:115], v[140:155]
    ds_read_b128 v[68:71], v4 offset:26624
    v_rcp_f32 v73, v73
    v_mul_f32 v121, v113, v121
    s_waitcnt lgkmcnt(2)
    v_mfma_f32_32x32x16_bf16 v[140:155], v[48:51], a[116:119], v[140:155]
    ds_read_b128 v[84:87], v4 offset:27648
    v_mul_f32 v120, v120, v72
    v_mul_f32 v121, v121, v73
    v_cvt_pk_bf16_f32 v82, v120, v121
    v_mul_f32 v74, v114, v114
    v_mfma_f32_32x32x16_bf16 v[140:155], v[52:55], a[120:123], v[140:155]
    ds_read_b128 v[88:91], v4 offset:28672
    v_mul_f32 v75, v115, v115
    buffer_load_dwordx4 v6, s[4:7], s40 offen sc1 lds
    s_add_u32 m0, s75, 45056
    v_mfma_f32_32x32x16_bf16 v[140:155], v[56:59], a[124:127], v[140:155]
    ds_read_b128 v[48:51], v4 offset:29696
    v_fma_f32 v74, v74, v45, v44
    v_fma_f32 v75, v75, v45, v44
    v_mul_f32 v74, v74, v114
    v_mul_f32 v75, v75, v115
    v_mfma_f32_32x32x16_bf16 v[140:155], v[60:63], a[128:131], v[140:155]
    ds_read_b128 v[52:55], v4 offset:30720
    v_exp_f32 v74, v74
    s_waitcnt lgkmcnt(2)
    v_mfma_f32_32x32x16_bf16 v[140:155], v[64:67], a[132:135], v[140:155]
    ds_read_b128 v[56:59], v4 offset:31744
    v_exp_f32 v75, v75
    v_mul_f32 v122, v114, v122
    v_fma_f32 v74, v74, v46, v46
    v_mfma_f32_32x32x16_bf16 v[140:155], v[68:71], a[136:139], v[140:155]
    ds_read_b128 v[60:63], v2 offset:3072
    v_fma_f32 v75, v75, v46, v46
    v_rcp_f32 v74, v74
    v_mul_f32 v72, v124, v124
    v_mfma_f32_32x32x16_bf16 v[140:155], v[84:87], a[140:143], v[140:155]
    ds_read_b128 v[64:67], v4 offset:32768
    buffer_load_dwordx4 v6, s[4:7], s41 offen sc1 lds
    v_mul_f32 v73, v125, v125
    v_mfma_f32_32x32x16_bf16 v[140:155], v[88:91], a[144:147], v[140:155]
    ds_read_b128 v[68:71], v4 offset:33792
    v_rcp_f32 v75, v75
    v_mul_f32 v123, v115, v123
    s_waitcnt lgkmcnt(2)
    v_mfma_f32_32x32x16_bf16 v[140:155], v[48:51], a[148:151], v[140:155]
    ds_read_b128 v[84:87], v4 offset:34816
    v_mul_f32 v122, v122, v74
    v_mul_f32 v123, v123, v75
    v_cvt_pk_bf16_f32 v83, v122, v123
    v_add_u32 v6, s47, v3
    v_mfma_f32_32x32x16_bf16 v[140:155], v[52:55], a[152:155], v[140:155]
    ds_read_b128 v[88:91], v4 offset:35840
    buffer_store_dwordx4 v[80:83], v7, s[8:11], s50 offen sc1
    v_fma_f32 v72, v72, v45, v44
    s_add_u32 m0, s75, 49152
    v_mfma_f32_32x32x16_bf16 v[140:155], v[56:59], a[156:159], v[140:155]
    ds_read_b128 v[48:51], v4 offset:36864
    v_fma_f32 v73, v73, v45, v44
    v_mul_f32 v72, v72, v124
    v_mul_f32 v73, v73, v125
    v_mfma_f32_32x32x16_bf16 v[140:155], v[60:63], v[40:43], v[140:155]
    ds_read_b128 v[52:55], v4 offset:37888
    s_waitcnt vmcnt(4)
    s_barrier
    s_waitcnt lgkmcnt(2)
    v_mfma_f32_32x32x16_bf16 v[92:107], v[64:67], a[0:3], 0
    ds_read_b128 v[56:59], v4 offset:38912
    v_exp_f32 v72, v72
    v_exp_f32 v73, v73
    v_mfma_f32_32x32x16_bf16 v[92:107], v[68:71], a[4:7], v[92:107]
    ds_read_b128 v[60:63], v4 offset:39936
    buffer_load_dwordx4 v6, s[4:7], s32 offen sc1 lds
    v_mul_f32 v132, v124, v132
    s_add_u32 m0, s75, 53248
    v_mfma_f32_32x32x16_bf16 v[92:107], v[84:87], a[8:11], v[92:107]
    ds_read_b128 v[64:67], v4 offset:40960
    v_fma_f32 v72, v72, v46, v46
    v_fma_f32 v73, v73, v46, v46
    v_rcp_f32 v72, v72
    v_mfma_f32_32x32x16_bf16 v[92:107], v[88:91], a[12:15], v[92:107]
    ds_read_b128 v[68:71], v4 offset:41984
    v_rcp_f32 v73, v73
    v_mul_f32 v133, v125, v133
    s_waitcnt lgkmcnt(2)
    v_mfma_f32_32x32x16_bf16 v[92:107], v[48:51], a[16:19], v[92:107]
    ds_read_b128 v[84:87], v4 offset:43008
    v_mul_f32 v132, v132, v72
    v_mul_f32 v133, v133, v73
    v_cvt_pk_bf16_f32 v76, v132, v133
    buffer_load_dwordx4 v6, s[4:7], s33 offen sc1 lds
    v_mfma_f32_32x32x16_bf16 v[92:107], v[52:55], a[20:23], v[92:107]
    ds_read_b128 v[88:91], v4 offset:44032
    v_mul_f32 v74, v126, v126
    v_mul_f32 v75, v127, v127
    v_fma_f32 v74, v74, v45, v44
    v_fma_f32 v75, v75, v45, v44
    v_mfma_f32_32x32x16_bf16 v[92:107], v[56:59], a[24:27], v[92:107]
    ds_read_b128 v[48:51], v4 offset:45056
    v_mul_f32 v74, v74, v126
    v_mul_f32 v75, v75, v127
    v_exp_f32 v74, v74
    v_mfma_f32_32x32x16_bf16 v[92:107], v[60:63], a[28:31], v[92:107]
    ds_read_b128 v[52:55], v4 offset:46080
    v_exp_f32 v75, v75
    s_add_u32 m0, s75, 57344
    v_mul_f32 v134, v126, v134
    s_waitcnt lgkmcnt(2)
    v_mfma_f32_32x32x16_bf16 v[92:107], v[64:67], a[32:35], v[92:107]
    ds_read_b128 v[56:59], v4 offset:47104
    v_fma_f32 v74, v74, v46, v46
    buffer_load_dwordx4 v6, s[4:7], s34 offen sc1 lds
    v_fma_f32 v75, v75, v46, v46
    v_rcp_f32 v74, v74
    v_mfma_f32_32x32x16_bf16 v[92:107], v[68:71], a[36:39], v[92:107]
    ds_read_b128 v[60:63], v4 offset:48128
    v_rcp_f32 v75, v75
    v_mul_f32 v135, v127, v135
    v_mul_f32 v134, v134, v74
    v_mfma_f32_32x32x16_bf16 v[92:107], v[84:87], a[40:43], v[92:107]
    ds_read_b128 v[64:67], v4 offset:49152
    v_mul_f32 v135, v135, v75
    v_cvt_pk_bf16_f32 v77, v134, v135
    s_add_u32 m0, s75, 61440
    v_mul_f32 v72, v128, v128
    v_mfma_f32_32x32x16_bf16 v[92:107], v[88:91], a[44:47], v[92:107]
    ds_read_b128 v[68:71], v4 offset:50176
    v_mul_f32 v73, v129, v129
    v_fma_f32 v72, v72, v45, v44
    buffer_load_dwordx4 v6, s[4:7], s35 offen sc1 lds
    s_waitcnt lgkmcnt(2)
    v_mfma_f32_32x32x16_bf16 v[92:107], v[48:51], a[48:51], v[92:107]
    ds_read_b128 v[84:87], v4 offset:51200
    v_fma_f32 v73, v73, v45, v44
    v_mul_f32 v72, v72, v128
    v_mul_f32 v73, v73, v129
    v_exp_f32 v72, v72
    v_mfma_f32_32x32x16_bf16 v[92:107], v[52:55], a[52:55], v[92:107]
    ds_read_b128 v[88:91], v4 offset:52224
    v_exp_f32 v73, v73
    v_mul_f32 v136, v128, v136
    v_fma_f32 v72, v72, v46, v46
    v_mfma_f32_32x32x16_bf16 v[92:107], v[56:59], a[56:59], v[92:107]
    ds_read_b128 v[48:51], v4 offset:53248
    v_fma_f32 v73, v73, v46, v46
    s_add_u32 m0, s75, 65536
    v_rcp_f32 v72, v72
    v_mfma_f32_32x32x16_bf16 v[92:107], v[60:63], a[60:63], v[92:107]
    ds_read_b128 v[52:55], v4 offset:54272
    v_rcp_f32 v73, v73
    buffer_load_dwordx4 v6, s[4:7], s36 offen sc1 lds
    s_waitcnt lgkmcnt(2)
    v_mfma_f32_32x32x16_bf16 v[92:107], v[64:67], a[64:67], v[92:107]
    ds_read_b128 v[56:59], v4 offset:55296
    v_mul_f32 v137, v129, v137
    v_mul_f32 v136, v136, v72
    v_mul_f32 v137, v137, v73
    v_cvt_pk_bf16_f32 v78, v136, v137
    v_mfma_f32_32x32x16_bf16 v[92:107], v[68:71], a[68:71], v[92:107]
    ds_read_b128 v[60:63], v4 offset:56320
    v_mul_f32 v74, v130, v130
    v_mul_f32 v75, v131, v131
    v_fma_f32 v74, v74, v45, v44
    v_fma_f32 v75, v75, v45, v44
    v_mfma_f32_32x32x16_bf16 v[92:107], v[84:87], a[72:75], v[92:107]
    ds_read_b128 v[64:67], v4 offset:57344
    s_add_u32 m0, s75, 69632
    v_mul_f32 v74, v74, v130
    v_mul_f32 v75, v75, v131
    v_exp_f32 v74, v74
    v_mfma_f32_32x32x16_bf16 v[92:107], v[88:91], a[76:79], v[92:107]
    ds_read_b128 v[68:71], v4 offset:58368
    buffer_load_dwordx4 v6, s[4:7], s37 offen sc1 lds
    v_exp_f32 v75, v75
    s_waitcnt vmcnt(4)
    s_barrier
    s_waitcnt lgkmcnt(2)
    v_mfma_f32_32x32x16_bf16 v[92:107], v[48:51], a[80:83], v[92:107]
    ds_read_b128 v[84:87], v4 offset:59392
    v_mul_f32 v138, v130, v138
    v_fma_f32 v74, v74, v46, v46
    v_fma_f32 v75, v75, v46, v46
    v_rcp_f32 v74, v74
    v_mfma_f32_32x32x16_bf16 v[92:107], v[52:55], a[84:87], v[92:107]
    ds_read_b128 v[88:91], v4 offset:60416
    v_rcp_f32 v75, v75
    s_add_u32 m0, s75, 0
    v_mul_f32 v139, v131, v139
    v_mfma_f32_32x32x16_bf16 v[92:107], v[56:59], a[88:91], v[92:107]
    ds_read_b128 v[48:51], v4 offset:61440
    v_mul_f32 v138, v138, v74
    buffer_load_dwordx4 v6, s[4:7], s38 offen sc1 lds
    v_mul_f32 v139, v139, v75
    v_cvt_pk_bf16_f32 v79, v138, v139
    v_mfma_f32_32x32x16_bf16 v[92:107], v[60:63], a[92:95], v[92:107]
    ds_read_b128 v[52:55], v4 offset:62464
    buffer_store_dwordx4 v[76:79], v7, s[8:11], s51 offen sc1
    v_mul_f32 v72, v140, v140
    s_waitcnt lgkmcnt(2)
    v_mfma_f32_32x32x16_bf16 v[92:107], v[64:67], a[96:99], v[92:107]
    ds_read_b128 v[56:59], v4 offset:63488
    v_mul_f32 v73, v141, v141
    v_fma_f32 v72, v72, v45, v44
    v_fma_f32 v73, v73, v45, v44
    v_mul_f32 v72, v72, v140
    v_mfma_f32_32x32x16_bf16 v[92:107], v[68:71], a[100:103], v[92:107]
    ds_read_b128 v[60:63], v4 offset:64512
    s_add_u32 m0, s75, 4096
    v_mul_f32 v73, v73, v141
    v_exp_f32 v72, v72
    v_mfma_f32_32x32x16_bf16 v[92:107], v[84:87], a[104:107], v[92:107]
    ds_read_b128 v[64:67], v5 offset:0
    buffer_load_dwordx4 v6, s[4:7], s39 offen sc1 lds
    v_exp_f32 v73, v73
    v_mfma_f32_32x32x16_bf16 v[92:107], v[88:91], a[108:111], v[92:107]
    ds_read_b128 v[68:71], v5 offset:1024
    v_mul_f32 v148, v140, v148
    v_fma_f32 v72, v72, v46, v46
    v_fma_f32 v73, v73, v46, v46
    s_waitcnt lgkmcnt(2)
    v_mfma_f32_32x32x16_bf16 v[92:107], v[48:51], a[112:115], v[92:107]
    ds_read_b128 v[84:87], v5 offset:2048
    v_rcp_f32 v72, v72
    v_rcp_f32 v73, v73
    s_add_u32 m0, s75, 8192
    v_mfma_f32_32x32x16_bf16 v[92:107], v[52:55], a[116:119], v[92:107]
    ds_read_b128 v[88:91], v5 offset:3072
    v_mul_f32 v149, v141, v149
    buffer_load_dwordx4 v6, s[4:7], s40 offen sc1 lds
    v_mul_f32 v148, v148, v72
    v_mfma_f32_32x32x16_bf16 v[92:107], v[56:59], a[120:123], v[92:107]
    ds_read_b128 v[48:51], v5 offset:4096
    v_mul_f32 v149, v149, v73
    v_cvt_pk_bf16_f32 v80, v148, v149
    v_mul_f32 v74, v142, v142
    v_mul_f32 v75, v143, v143
    v_mfma_f32_32x32x16_bf16 v[92:107], v[60:63], a[124:127], v[92:107]
    ds_read_b128 v[52:55], v5 offset:5120
    v_fma_f32 v74, v74, v45, v44
    v_fma_f32 v75, v75, v45, v44
    v_mul_f32 v74, v74, v142
    s_waitcnt lgkmcnt(2)
    v_mfma_f32_32x32x16_bf16 v[92:107], v[64:67], a[128:131], v[92:107]
    ds_read_b128 v[56:59], v5 offset:6144
    v_mul_f32 v75, v75, v143
    s_add_u32 m0, s75, 12288
    v_exp_f32 v74, v74
    v_mfma_f32_32x32x16_bf16 v[92:107], v[68:71], a[132:135], v[92:107]
    ds_read_b128 v[60:63], v5 offset:7168
    v_exp_f32 v75, v75
    buffer_load_dwordx4 v6, s[4:7], s41 offen sc1 lds
    v_mfma_f32_32x32x16_bf16 v[92:107], v[84:87], a[136:139], v[92:107]
    ds_read_b128 v[64:67], v2 offset:4096
    v_mul_f32 v150, v142, v150
    v_fma_f32 v74, v74, v46, v46
    v_fma_f32 v75, v75, v46, v46
    v_add_u32 v6, s48, v3
    v_mfma_f32_32x32x16_bf16 v[92:107], v[88:91], a[140:143], v[92:107]
    ds_read_b128 v[68:71], v5 offset:8192
    v_rcp_f32 v74, v74
    v_rcp_f32 v75, v75
    s_waitcnt lgkmcnt(2)
    v_mfma_f32_32x32x16_bf16 v[92:107], v[48:51], a[144:147], v[92:107]
    ds_read_b128 v[84:87], v5 offset:9216
    v_mul_f32 v151, v143, v151
    v_mul_f32 v150, v150, v74
    v_mul_f32 v151, v151, v75
    s_add_u32 m0, s75, 16384
    v_mfma_f32_32x32x16_bf16 v[92:107], v[52:55], a[148:151], v[92:107]
    ds_read_b128 v[88:91], v5 offset:10240
    v_cvt_pk_bf16_f32 v81, v150, v151
    v_mul_f32 v72, v144, v144
    v_mul_f32 v73, v145, v145
    v_fma_f32 v72, v72, v45, v44
    v_mfma_f32_32x32x16_bf16 v[92:107], v[56:59], a[152:155], v[92:107]
    ds_read_b128 v[48:51], v5 offset:11264
    buffer_load_dwordx4 v6, s[4:7], s32 offen sc1 lds
    v_fma_f32 v73, v73, v45, v44
    v_mul_f32 v72, v72, v144
    v_mfma_f32_32x32x16_bf16 v[92:107], v[60:63], a[156:159], v[92:107]
    ds_read_b128 v[52:55], v5 offset:12288
    v_mul_f32 v73, v73, v145
    v_exp_f32 v72, v72
    s_waitcnt lgkmcnt(2)
    v_mfma_f32_32x32x16_bf16 v[92:107], v[64:67], v[40:43], v[92:107]
    ds_read_b128 v[56:59], v5 offset:13312
    v_exp_f32 v73, v73
    s_add_u32 m0, s75, 20480
    v_mul_f32 v152, v144, v152
    s_waitcnt vmcnt(5)
    s_waitcnt vmcnt(4)
    s_barrier
    s_cmp_lg_u32 s20, 0
    s_cbranch_scc1 L_sig_34
    s_mov_b64 exec, 1
    buffer_atomic_add v18, off, s[4:7], s74 offset:256 sc1
    s_mov_b64 exec, -1
L_sig_34:
    v_mfma_f32_32x32x16_bf16 v[108:123], v[68:71], a[0:3], 0
    ds_read_b128 v[60:63], v5 offset:14336
    v_fma_f32 v72, v72, v46, v46
    v_fma_f32 v73, v73, v46, v46
    buffer_load_dwordx4 v6, s[4:7], s33 offen sc1 lds
    v_rcp_f32 v72, v72
    v_mfma_f32_32x32x16_bf16 v[108:123], v[84:87], a[4:7], v[108:123]
    ds_read_b128 v[64:67], v5 offset:15360
    v_rcp_f32 v73, v73
    v_mul_f32 v153, v145, v153
    v_mul_f32 v152, v152, v72
    v_mfma_f32_32x32x16_bf16 v[108:123], v[88:91], a[8:11], v[108:123]
    ds_read_b128 v[68:71], v5 offset:16384
    v_mul_f32 v153, v153, v73
    v_cvt_pk_bf16_f32 v82, v152, v153
    v_mul_f32 v74, v146, v146
    s_waitcnt lgkmcnt(2)
    v_mfma_f32_32x32x16_bf16 v[108:123], v[48:51], a[12:15], v[108:123]
    ds_read_b128 v[84:87], v5 offset:17408
    s_add_u32 m0, s75, 24576
    v_mul_f32 v75, v147, v147
    v_fma_f32 v74, v74, v45, v44
    v_fma_f32 v75, v75, v45, v44
    v_mfma_f32_32x32x16_bf16 v[108:123], v[52:55], a[16:19], v[108:123]
    ds_read_b128 v[88:91], v5 offset:18432
    buffer_load_dwordx4 v6, s[4:7], s34 offen sc1 lds
    v_mul_f32 v74, v74, v146
    s_add_u32 m0, s75, 28672
    v_mfma_f32_32x32x16_bf16 v[108:123], v[56:59], a[20:23], v[108:123]
    ds_read_b128 v[48:51], v5 offset:19456
    v_mul_f32 v75, v75, v147
    v_exp_f32 v74, v74
    v_exp_f32 v75, v75
    v_mfma_f32_32x32x16_bf16 v[108:123], v[60:63], a[24:27], v[108:123]
    ds_read_b128 v[52:55], v5 offset:20480
    v_mul_f32 v154, v146, v154
    v_fma_f32 v74, v74, v46, v46
    v_fma_f32 v75, v75, v46, v46
    s_waitcnt lgkmcnt(2)
    v_mfma_f32_32x32x16_bf16 v[108:123], v[64:67], a[28:31], v[108:123]
    ds_read_b128 v[56:59], v5 offset:21504
    v_rcp_f32 v74, v74
    buffer_load_dwordx4 v6, s[4:7], s35 offen sc1 lds
    v_mfma_f32_32x32x16_bf16 v[108:123], v[68:71], a[32:35], v[108:123]
    ds_read_b128 v[60:63], v5 offset:22528
    v_rcp_f32 v75, v75
    v_mul_f32 v155, v147, v155
    v_mul_f32 v154, v154, v74
    v_mfma_f32_32x32x16_bf16 v[108:123], v[84:87], a[36:39], v[108:123]
    ds_read_b128 v[64:67], v5 offset:23552
    v_mul_f32 v155, v155, v75
    v_cvt_pk_bf16_f32 v83, v154, v155
    s_add_u32 m0, s75, 32768
    v_mul_f32 v72, v92, v92
    v_mfma_f32_32x32x16_bf16 v[108:123], v[88:91], a[40:43], v[108:123]
    ds_read_b128 v[68:71], v5 offset:24576
    buffer_store_dwordx4 v[80:83], v7, s[8:11], s52 offen sc1
    v_mul_f32 v73, v93, v93
    s_waitcnt lgkmcnt(2)
    v_mfma_f32_32x32x16_bf16 v[108:123], v[48:51], a[44:47], v[108:123]
    ds_read_b128 v[84:87], v5 offset:25600
    buffer_load_dwordx4 v6, s[4:7], s36 offen sc1 lds
    v_fma_f32 v72, v72, v45, v44
    v_fma_f32 v73, v73, v45, v44
    v_mfma_f32_32x32x16_bf16 v[108:123], v[52:55], a[48:51], v[108:123]
    ds_read_b128 v[88:91], v5 offset:26624
    v_mul_f32 v72, v72, v92
    v_mul_f32 v73, v73, v93
    v_exp_f32 v72, v72
    v_mfma_f32_32x32x16_bf16 v[108:123], v[56:59], a[52:55], v[108:123]
    ds_read_b128 v[48:51], v5 offset:27648
    v_exp_f32 v73, v73
    s_add_u32 m0, s75, 36864
    v_mul_f32 v100, v92, v100
    v_mfma_f32_32x32x16_bf16 v[108:123], v[60:63], a[56:59], v[108:123]
    ds_read_b128 v[52:55], v5 offset:28672
    v_fma_f32 v72, v72, v46, v46
    v_fma_f32 v73, v73, v46, v46
    buffer_load_dwordx4 v6, s[4:7], s37 offen sc1 lds
    s_waitcnt lgkmcnt(2)
    v_mfma_f32_32x32x16_bf16 v[108:123], v[64:67], a[60:63], v[108:123]
    ds_read_b128 v[56:59], v5 offset:29696
    v_rcp_f32 v72, v72
    v_rcp_f32 v73, v73
    v_mfma_f32_32x32x16_bf16 v[108:123], v[68:71], a[64:67], v[108:123]
    ds_read_b128 v[60:63], v5 offset:30720
    v_mul_f32 v101, v93, v101
    v_mul_f32 v100, v100, v72
    v_mul_f32 v101, v101, v73
    v_cvt_pk_bf16_f32 v76, v100, v101
    v_mfma_f32_32x32x16_bf16 v[108:123], v[84:87], a[68:71], v[108:123]
    ds_read_b128 v[64:67], v5 offset:31744
    s_add_u32 m0, s75, 40960
    v_mul_f32 v74, v94, v94
    v_mul_f32 v75, v95, v95
    v_fma_f32 v74, v74, v45, v44
    v_mfma_f32_32x32x16_bf16 v[108:123], v[88:91], a[72:75], v[108:123]
    ds_read_b128 v[68:71], v4 offset:24576
    buffer_load_dwordx4 v6, s[4:7], s38 offen sc1 lds
    v_fma_f32 v75, v75, v45, v44
    s_waitcnt lgkmcnt(2)
    v_mfma_f32_32x32x16_bf16 v[108:123], v[48:51], a[76:79], v[108:123]
    ds_read_b128 v[84:87], v4 offset:25600
    v_mul_f32 v74, v74, v94
    v_mul_f32 v75, v75, v95
    v_exp_f32 v74, v74
    s_waitcnt vmcnt(7)
    s_barrier
    v_mfma_f32_32x32x16_bf16 v[108:123], v[52:55], a[80:83], v[108:123]
    ds_read_b128 v[88:91], v4 offset:26624
    v_exp_f32 v75, v75
    v_mul_f32 v102, v94, v102
    s_add_u32 m0, s75, 45056
    v_mfma_f32_32x32x16_bf16 v[108:123], v[56:59], a[84:87], v[108:123]
    ds_read_b128 v[48:51], v4 offset:27648
    v_fma_f32 v74, v74, v46, v46
    v_fma_f32 v75, v75, v46, v46
    v_rcp_f32 v74, v74
    v_mfma_f32_32x32x16_bf16 v[108:123], v[60:63], a[88:91], v[108:123]
    ds_read_b128 v[52:55], v4 offset:28672
    buffer_load_dwordx4 v6, s[4:7], s39 offen sc1 lds
    v_rcp_f32 v75, v75
    s_waitcnt lgkmcnt(2)
    v_mfma_f32_32x32x16_bf16 v[108:123], v[64:67], a[92:95], v[108:123]
    ds_read_b128 v[56:59], v4 offset:29696
    v_mul_f32 v103, v95, v103
    v_mul_f32 v102, v102, v74
    v_mul_f32 v103, v103, v75
    v_cvt_pk_bf16_f32 v77, v102, v103
    v_mfma_f32_32x32x16_bf16 v[108:123], v[68:71], a[96:99], v[108:123]
    ds_read_b128 v[60:63], v4 offset:30720
    v_mul_f32 v72, v96, v96
    v_mul_f32 v73, v97, v97
    v_fma_f32 v72, v72, v45, v44
    v_fma_f32 v73, v73, v45, v44
    v_mfma_f32_32x32x16_bf16 v[108:123], v[84:87], a[100:103], v[108:123]
    ds_read_b128 v[64:67], v4 offset:31744
    v_mul_f32 v72, v72, v96
    s_add_u32 m0, s75, 49152
    v_mul_f32 v73, v73, v97
    v_mfma_f32_32x32x16_bf16 v[108:123], v[88:91], a[104:107], v[108:123]
    ds_read_b128 v[68:71], v4 offset:32768
    v_exp_f32 v72, v72
    buffer_load_dwordx4 v6, s[4:7], s40 offen sc1 lds
    s_waitcnt lgkmcnt(2)
    v_mfma_f32_32x32x16_bf16 v[108:123], v[48:51], a[108:111], v[108:123]
    ds_read_b128 v[84:87], v4 offset:33792
    v_exp_f32 v73, v73
    v_mul_f32 v104, v96, v104
    v_fma_f32 v72, v72, v46, v46
    v_mfma_f32_32x32x16_bf16 v[108:123], v[52:55], a[112:115], v[108:123]
    ds_read_b128 v[88:91], v4 offset:34816
    v_fma_f32 v73, v73, v46, v46
    v_rcp_f32 v72, v72
    s_add_u32 m0, s75, 53248
    v_mfma_f32_32x32x16_bf16 v[108:123], v[56:59], a[116:119], v[108:123]
    ds_read_b128 v[48:51], v4 offset:35840
    v_rcp_f32 v73, v73
    v_mul_f32 v105, v97, v105
    buffer_load_dword v19, off, s[4:7], s74 offset:256 sc1
    v_mfma_f32_32x32x16_bf16 v[108:123], v[60:63], a[120:123], v[108:123]
    ds_read_b128 v[52:55], v4 offset:36864
    buffer_load_dwordx4 v6, s[4:7], s41 offen sc1 lds
    v_mul_f32 v104, v104, v72
    v_mul_f32 v105, v105, v73
    s_waitcnt lgkmcnt(2)
    v_mfma_f32_32x32x16_bf16 v[108:123], v[64:67], a[124:127], v[108:123]
    ds_read_b128 v[56:59], v4 offset:37888
    v_cvt_pk_bf16_f32 v78, v104, v105
    v_mul_f32 v74, v98, v98
    v_mul_f32 v75, v99, v99
    v_fma_f32 v74, v74, v45, v44
    v_mfma_f32_32x32x16_bf16 v[108:123], v[68:71], a[128:131], v[108:123]
    ds_read_b128 v[60:63], v4 offset:38912
    v_fma_f32 v75, v75, v45, v44
    v_mul_f32 v74, v74, v98
    v_mul_f32 v75, v75, v99
    v_mfma_f32_32x32x16_bf16 v[108:123], v[84:87], a[132:135], v[108:123]
    ds_read_b128 v[64:67], v4 offset:39936
    v_exp_f32 v74, v74
    v_exp_f32 v75, v75
    v_mfma_f32_32x32x16_bf16 v[108:123], v[88:91], a[136:139], v[108:123]
    ds_read_b128 v[68:71], v2 offset:5120
    v_mul_f32 v106, v98, v106
    v_fma_f32 v74, v74, v46, v46
    v_fma_f32 v75, v75, v46, v46
    s_waitcnt lgkmcnt(2)
    v_mfma_f32_32x32x16_bf16 v[108:123], v[48:51], a[140:143], v[108:123]
    ds_read_b128 v[84:87], v4 offset:40960
    v_rcp_f32 v74, v74
    s_waitcnt vmcnt(5)
    s_barrier
    v_mfma_f32_32x32x16_bf16 v[108:123], v[52:55], a[144:147], v[108:123]
    ds_read_b128 v[88:91], v4 offset:41984
    v_rcp_f32 v75, v75
    v_mul_f32 v107, v99, v107
    v_mul_f32 v106, v106, v74
    v_mfma_f32_32x32x16_bf16 v[108:123], v[56:59], a[148:151], v[108:123]
    ds_read_b128 v[48:51], v4 offset:43008
    v_mul_f32 v107, v107, v75
    v_cvt_pk_bf16_f32 v79, v106, v107
    v_mfma_f32_32x32x16_bf16 v[108:123], v[60:63], a[152:155], v[108:123]
    ds_read_b128 v[52:55], v4 offset:44032
    buffer_store_dwordx4 v[76:79], v7, s[8:11], s53 offen sc1
    s_waitcnt lgkmcnt(2)
    v_mfma_f32_32x32x16_bf16 v[108:123], v[64:67], a[156:159], v[108:123]
    ds_read_b128 v[56:59], v4 offset:45056
    v_mfma_f32_32x32x16_bf16 v[108:123], v[68:71], v[40:43], v[108:123]
    ds_read_b128 v[60:63], v4 offset:46080
    v_mfma_f32_32x32x16_bf16 v[124:139], v[84:87], a[0:3], 0
    ds_read_b128 v[64:67], v4 offset:47104
    s_waitcnt vmcnt(2)
    v_readfirstlane_b32 s24, v19
    s_cmp_ge_u32 s24, 16
    s_cbranch_scc0 L_slow_35
L_ok_36:
    v_mfma_f32_32x32x16_bf16 v[124:139], v[88:91], a[4:7], v[124:139]
    ds_read_b128 v[68:71], v4 offset:48128
    buffer_load_dwordx4 a[0:3], v8, s[8:11], s56 offen sc1
    s_waitcnt lgkmcnt(2)
    v_mfma_f32_32x32x16_bf16 v[124:139], v[48:51], a[8:11], v[124:139]
    ds_read_b128 v[84:87], v4 offset:49152
    v_mul_f32 v72, v108, v108
    v_mul_f32 v73, v109, v109
    v_fma_f32 v72, v72, v45, v44
    v_fma_f32 v73, v73, v45, v44
    v_mfma_f32_32x32x16_bf16 v[124:139], v[52:55], a[12:15], v[124:139]
    ds_read_b128 v[88:91], v4 offset:50176
    buffer_load_dwordx4 a[4:7], v9, s[8:11], s56 offen sc1
    v_mul_f32 v72, v72, v108
    v_mfma_f32_32x32x16_bf16 v[124:139], v[56:59], a[16:19], v[124:139]
    ds_read_b128 v[48:51], v4 offset:51200
    v_mul_f32 v73, v73, v109
    v_exp_f32 v72, v72
    v_mfma_f32_32x32x16_bf16 v[124:139], v[60:63], a[20:23], v[124:139]
    ds_read_b128 v[52:55], v4 offset:52224
    buffer_load_dwordx4 a[8:11], v10, s[8:11], s56 offen sc1
    s_waitcnt lgkmcnt(2)
    v_mfma_f32_32x32x16_bf16 v[124:139], v[64:67], a[24:27], v[124:139]
    ds_read_b128 v[56:59], v4 offset:53248
    v_exp_f32 v73, v73
    v_mul_f32 v116, v108, v116
    v_fma_f32 v72, v72, v46, v46
    v_mfma_f32_32x32x16_bf16 v[124:139], v[68:71], a[28:31], v[124:139]
    ds_read_b128 v[60:63], v4 offset:54272
    buffer_load_dwordx4 a[12:15], v11, s[8:11], s56 offen sc1
    v_fma_f32 v73, v73, v46, v46
    v_mfma_f32_32x32x16_bf16 v[124:139], v[84:87], a[32:35], v[124:139]
    ds_read_b128 v[64:67], v4 offset:55296
    v_rcp_f32 v72, v72
    v_rcp_f32 v73, v73
    v_mfma_f32_32x32x16_bf16 v[124:139], v[88:91], a[36:39], v[124:139]
    ds_read_b128 v[68:71], v4 offset:56320
    buffer_load_dwordx4 a[16:19], v8, s[8:11], s57 offen sc1
    v_mul_f32 v117, v109, v117
    s_waitcnt lgkmcnt(2)
    v_mfma_f32_32x32x16_bf16 v[124:139], v[48:51], a[40:43], v[124:139]
    ds_read_b128 v[84:87], v4 offset:57344
    v_mul_f32 v116, v116, v72
    v_mul_f32 v117, v117, v73
    v_cvt_pk_bf16_f32 v80, v116, v117
    v_mul_f32 v74, v110, v110
    v_mfma_f32_32x32x16_bf16 v[124:139], v[52:55], a[44:47], v[124:139]
    ds_read_b128 v[88:91], v4 offset:58368
    buffer_load_dwordx4 a[20:23], v9, s[8:11], s57 offen sc1
    v_mul_f32 v75, v111, v111
    v_mfma_f32_32x32x16_bf16 v[124:139], v[56:59], a[48:51], v[124:139]
    ds_read_b128 v[48:51], v4 offset:59392
    v_fma_f32 v74, v74, v45, v44
    v_fma_f32 v75, v75, v45, v44
    v_mul_f32 v74, v74, v110
    v_mul_f32 v75, v75, v111
    v_mfma_f32_32x32x16_bf16 v[124:139], v[60:63], a[52:55], v[124:139]
    ds_read_b128 v[52:55], v4 offset:60416
    buffer_load_dwordx4 a[24:27], v10, s[8:11], s57 offen sc1
    s_waitcnt lgkmcnt(2)
    v_mfma_f32_32x32x16_bf16 v[124:139], v[64:67], a[56:59], v[124:139]
    ds_read_b128 v[56:59], v4 offset:61440
    v_exp_f32 v74, v74
    s_waitcnt vmcnt(8)
    s_waitcnt vmcnt(7)
    s_barrier
    s_cmp_lg_u32 s20, 0
    s_cbranch_scc1 L_sig_37
    s_mov_b64 exec, 1
    buffer_atomic_add v18, off, s[4:7], s74 offset:768 sc1
    s_mov_b64 exec, -1
L_sig_37:
    v_mfma_f32_32x32x16_bf16 v[124:139], v[68:71], a[60:63], v[124:139]
    ds_read_b128 v[60:63], v4 offset:62464
    v_exp_f32 v75, v75
    v_mul_f32 v118, v110, v118
    v_fma_f32 v74, v74, v46, v46
    v_mfma_f32_32x32x16_bf16 v[124:139], v[84:87], a[64:67], v[124:139]
    ds_read_b128 v[64:67], v4 offset:63488
    buffer_load_dwordx4 a[28:31], v11, s[8:11], s57 offen sc1
    v_fma_f32 v75, v75, v46, v46
    v_mfma_f32_32x32x16_bf16 v[124:139], v[88:91], a[68:71], v[124:139]
    ds_read_b128 v[68:71], v4 offset:64512
    v_rcp_f32 v74, v74
    s_waitcnt lgkmcnt(2)
    v_mfma_f32_32x32x16_bf16 v[124:139], v[48:51], a[72:75], v[124:139]
    ds_read_b128 v[84:87], v5 offset:0
    buffer_load_dwordx4 a[32:35], v8, s[8:11], s58 offen sc1
    v_mfma_f32_32x32x16_bf16 v[124:139], v[52:55], a[76:79], v[124:139]
    ds_read_b128 v[88:91], v5 offset:1024
    v_rcp_f32 v75, v75
    v_mul_f32 v119, v111, v119
    v_mul_f32 v118, v118, v74
    v_mfma_f32_32x32x16_bf16 v[124:139], v[56:59], a[80:83], v[124:139]
    ds_read_b128 v[48:51], v5 offset:2048
    buffer_load_dwordx4 a[36:39], v9, s[8:11], s58 offen sc1
    v_mul_f32 v119, v119, v75
    v_mfma_f32_32x32x16_bf16 v[124:139], v[60:63], a[84:87], v[124:139]
    ds_read_b128 v[52:55], v5 offset:3072
    v_cvt_pk_bf16_f32 v81, v118, v119
    v_mul_f32 v72, v112, v112
    v_mul_f32 v73, v113, v113
    s_waitcnt lgkmcnt(2)
    v_mfma_f32_32x32x16_bf16 v[124:139], v[64:67], a[88:91], v[124:139]
    ds_read_b128 v[56:59], v5 offset:4096
    buffer_load_dwordx4 a[40:43], v10, s[8:11], s58 offen sc1
    v_fma_f32 v72, v72, v45, v44
    v_mfma_f32_32x32x16_bf16 v[124:139], v[68:71], a[92:95], v[124:139]
    ds_read_b128 v[60:63], v5 offset:5120
    v_fma_f32 v73, v73, v45, v44
    v_mul_f32 v72, v72, v112
    v_mul_f32 v73, v73, v113
    v_mfma_f32_32x32x16_bf16 v[124:139], v[84:87], a[96:99], v[124:139]
    ds_read_b128 v[64:67], v5 offset:6144
    v_exp_f32 v72, v72
    v_exp_f32 v73, v73
    v_mfma_f32_32x32x16_bf16 v[124:139], v[88:91], a[100:103], v[124:139]
    ds_read_b128 v[68:71], v5 offset:7168
    buffer_load_dwordx4 a[44:47], v11, s[8:11], s58 offen sc1
    v_mul_f32 v120, v112, v120
    s_waitcnt lgkmcnt(2)
    v_mfma_f32_32x32x16_bf16 v[124:139], v[48:51], a[104:107], v[124:139]
    ds_read_b128 v[84:87], v5 offset:8192
    buffer_load_dwordx4 a[48:51], v8, s[8:11], s59 offen sc1
    v_fma_f32 v72, v72, v46, v46
    v_mfma_f32_32x32x16_bf16 v[124:139], v[52:55], a[108:111], v[124:139]
    ds_read_b128 v[88:91], v5 offset:9216
    v_fma_f32 v73, v73, v46, v46
    v_rcp_f32 v72, v72
    v_mfma_f32_32x32x16_bf16 v[124:139], v[56:59], a[112:115], v[124:139]
    ds_read_b128 v[48:51], v5 offset:10240
    v_rcp_f32 v73, v73
    v_mul_f32 v121, v113, v121
    v_mul_f32 v120, v120, v72
    v_mfma_f32_32x32x16_bf16 v[124:139], v[60:63], a[116:119], v[124:139]
    ds_read_b128 v[52:55], v5 offset:11264
    buffer_load_dwordx4 a[52:55], v9, s[8:11], s59 offen sc1
    v_mul_f32 v121, v121, v73
    s_waitcnt lgkmcnt(2)
    v_mfma_f32_32x32x16_bf16 v[124:139], v[64:67], a[120:123], v[124:139]
    ds_read_b128 v[56:59], v5 offset:12288
    v_cvt_pk_bf16_f32 v82, v120, v121
    buffer_load_dwordx4 a[56:59], v10, s[8:11], s59 offen sc1
    v_mfma_f32_32x32x16_bf16 v[124:139], v[68:71], a[124:127], v[124:139]
    ds_read_b128 v[60:63], v5 offset:13312
    v_mul_f32 v74, v114, v114
    v_mul_f32 v75, v115, v115
    v_fma_f32 v74, v74, v45, v44
    v_fma_f32 v75, v75, v45, v44
    v_mfma_f32_32x32x16_bf16 v[124:139], v[84:87], a[128:131], v[124:139]
    ds_read_b128 v[64:67], v5 offset:14336
    buffer_load_dwordx4 a[60:63], v11, s[8:11], s59 offen sc1
    v_mul_f32 v74, v74, v114
    v_mfma_f32_32x32x16_bf16 v[124:139], v[88:91], a[132:135], v[124:139]
    ds_read_b128 v[68:71], v5 offset:15360
    v_mul_f32 v75, v75, v115
    v_exp_f32 v74, v74
    s_waitcnt lgkmcnt(2)
    v_mfma_f32_32x32x16_bf16 v[124:139], v[48:51], a[136:139], v[124:139]
    ds_read_b128 v[84:87], v2 offset:6144
    v_exp_f32 v75, v75
    v_mul_f32 v122, v114, v122
    v_fma_f32 v74, v74, v46, v46
    v_mfma_f32_32x32x16_bf16 v[124:139], v[52:55], a[140:143], v[124:139]
    buffer_load_dwordx4 a[76:79], v12, s[4:7], s65 offen offset:0 sc1
    v_fma_f32 v75, v75, v46, v46
    v_mfma_f32_32x32x16_bf16 v[124:139], v[56:59], a[144:147], v[124:139]
    v_rcp_f32 v74, v74
    buffer_load_dwordx4 a[80:83], v16, s[4:7], s66 offen offset:0 sc1
    v_mfma_f32_32x32x16_bf16 v[124:139], v[60:63], a[148:151], v[124:139]
    v_rcp_f32 v75, v75
    v_mul_f32 v123, v115, v123
    v_mul_f32 v122, v122, v74
    s_waitcnt lgkmcnt(0)
    v_mfma_f32_32x32x16_bf16 v[124:139], v[64:67], a[152:155], v[124:139]
    buffer_load_dwordx4 a[84:87], v16, s[4:7], s66 offen offset:1024 sc1
    v_mul_f32 v123, v123, v75
    v_cvt_pk_bf16_f32 v83, v122, v123
    v_mfma_f32_32x32x16_bf16 v[124:139], v[68:71], a[156:159], v[124:139]
    buffer_store_dwordx4 v[80:83], v7, s[8:11], s54 offen sc1
    buffer_load_dwordx4 a[88:91], v16, s[4:7], s66 offen offset:2048 sc1
    v_mfma_f32_32x32x16_bf16 v[124:139], v[84:87], v[40:43], v[124:139]
    buffer_load_dwordx4 a[92:95], v16, s[4:7], s66 offen offset:3072 sc1
    buffer_load_dwordx4 a[96:99], v12, s[4:7], s66 offen offset:0 sc1
    s_nop 9
    v_pk_mul_f32 v[72:73], v[124:125], v[124:125]
    v_pk_fma_f32 v[72:73], v[72:73], v[44:45], v[44:45] op_sel:[0,1,0] op_sel_hi:[1,1,0]
    v_pk_mul_f32 v[72:73], v[72:73], v[124:125]
    v_exp_f32 v72, v72
    v_exp_f32 v73, v73
    v_pk_mul_f32 v[132:133], v[124:125], v[132:133]
    v_pk_fma_f32 v[72:73], v[72:73], v[46:47], v[46:47] op_sel_hi:[1,0,0]
    v_rcp_f32 v72, v72
    v_rcp_f32 v73, v73
    s_nop 0
    v_pk_mul_f32 v[132:133], v[132:133], v[72:73]
    v_cvt_pk_bf16_f32 v76, v132, v133
    v_pk_mul_f32 v[74:75], v[126:127], v[126:127]
    v_pk_fma_f32 v[74:75], v[74:75], v[44:45], v[44:45] op_sel:[0,1,0] op_sel_hi:[1,1,0]
    v_pk_mul_f32 v[74:75], v[74:75], v[126:127]
    v_exp_f32 v74, v74
    v_exp_f32 v75, v75
    v_pk_mul_f32 v[134:135], v[126:127], v[134:135]
    v_pk_fma_f32 v[74:75], v[74:75], v[46:47], v[46:47] op_sel_hi:[1,0,0]
    v_rcp_f32 v74, v74
    v_rcp_f32 v75, v75
    s_nop 0
    v_pk_mul_f32 v[134:135], v[134:135], v[74:75]
    v_cvt_pk_bf16_f32 v77, v134, v135
    v_pk_mul_f32 v[72:73], v[128:129], v[128:129]
    v_pk_fma_f32 v[72:73], v[72:73], v[44:45], v[44:45] op_sel:[0,1,0] op_sel_hi:[1,1,0]
    v_pk_mul_f32 v[72:73], v[72:73], v[128:129]
    v_exp_f32 v72, v72
    v_exp_f32 v73, v73
    v_pk_mul_f32 v[136:137], v[128:129], v[136:137]
    v_pk_fma_f32 v[72:73], v[72:73], v[46:47], v[46:47] op_sel_hi:[1,0,0]
    v_rcp_f32 v72, v72
    v_rcp_f32 v73, v73
    s_nop 0
    v_pk_mul_f32 v[136:137], v[136:137], v[72:73]
    v_cvt_pk_bf16_f32 v78, v136, v137
    v_pk_mul_f32 v[74:75], v[130:131], v[130:131]
    v_pk_fma_f32 v[74:75], v[74:75], v[44:45], v[44:45] op_sel:[0,1,0] op_sel_hi:[1,1,0]
    v_pk_mul_f32 v[74:75], v[74:75], v[130:131]
    v_exp_f32 v74, v74
    v_exp_f32 v75, v75
    v_pk_mul_f32 v[138:139], v[130:131], v[138:139]
    v_pk_fma_f32 v[74:75], v[74:75], v[46:47], v[46:47] op_sel_hi:[1,0,0]
    v_rcp_f32 v74, v74
    v_rcp_f32 v75, v75
    s_nop 0
    v_pk_mul_f32 v[138:139], v[138:139], v[74:75]
    v_cvt_pk_bf16_f32 v79, v138, v139
    buffer_store_dwordx4 v[76:79], v7, s[8:11], s55 offen sc1
    s_waitcnt vmcnt(22)
    v_mfma_f32_16x16x32_bf16 v[92:95], v[156:159], a[4:7], 0
    v_lshlrev_b32 v72, 16, v30
    v_and_b32 v73, 0xffff0000, v30
    v_mfma_f32_16x16x32_bf16 v[96:99], v[160:163], a[4:7], 0
    v_lshlrev_b32 v74, 16, v31
    v_and_b32 v75, 0xffff0000, v31
    v_mfma_f32_16x16x32_bf16 v[100:103], v[164:167], a[4:7], 0
    buffer_load_dword v19, off, s[4:7], s74 offset:768 sc1
    v_lshlrev_b32 v76, 16, v32
    v_and_b32 v77, 0xffff0000, v32
    v_mfma_f32_16x16x32_bf16 v[104:107], v[168:171], a[4:7], 0
    v_lshlrev_b32 v78, 16, v33
    v_and_b32 v79, 0xffff0000, v33
    v_mfma_f32_16x16x32_bf16 v[108:111], v[172:175], a[4:7], 0
    v_lshlrev_b32 v80, 16, v34
    v_and_b32 v81, 0xffff0000, v34
    s_waitcnt vmcnt(22)
    v_mfma_f32_16x16x32_bf16 v[112:115], v[156:159], a[8:11], 0
    buffer_load_dwordx4 a[64:67], v8, s[8:11], s60 offen sc1
    v_mfma_f32_16x16x32_bf16 v[116:119], v[160:163], a[8:11], 0
    v_lshlrev_b32 v82, 16, v35
    v_and_b32 v83, 0xffff0000, v35
    v_mfma_f32_16x16x32_bf16 v[120:123], v[164:167], a[8:11], 0
    v_lshlrev_b32 v84, 16, v36
    v_and_b32 v85, 0xffff0000, v36
    v_mfma_f32_16x16x32_bf16 v[124:127], v[168:171], a[8:11], 0
    v_lshlrev_b32 v86, 16, v37
    v_and_b32 v87, 0xffff0000, v37
    v_mfma_f32_16x16x32_bf16 v[128:131], v[172:175], a[8:11], 0
    v_lshlrev_b32 v88, 16, v38
    v_and_b32 v89, 0xffff0000, v38
    s_waitcnt vmcnt(22)
    v_mfma_f32_16x16x32_bf16 v[132:135], v[156:159], a[12:15], 0
    v_lshlrev_b32 v90, 16, v39
    v_and_b32 v91, 0xffff0000, v39
    v_mfma_f32_16x16x32_bf16 v[136:139], v[160:163], a[12:15], 0
    buffer_load_dwordx4 a[68:71], v9, s[8:11], s60 offen sc1
    v_mfma_f32_16x16x32_bf16 v[140:143], v[164:167], a[12:15], 0
    buffer_load_dwordx4 a[72:75], v10, s[8:11], s60 offen sc1
    v_mfma_f32_16x16x32_bf16 v[144:147], v[168:171], a[12:15], 0
    v_mfma_f32_16x16x32_bf16 v[148:151], v[172:175], a[12:15], 0
    buffer_load_dwordx4 v[48:51], v11, s[8:11], s60 offen sc1
    v_mfma_f32_16x16x32_bf16 v[72:75], v[156:159], a[0:3], v[72:75]
    v_mfma_f32_16x16x32_bf16 v[76:79], v[160:163], a[0:3], v[76:79]
    v_mfma_f32_16x16x32_bf16 v[80:83], v[164:167], a[0:3], v[80:83]
    v_mfma_f32_16x16x32_bf16 v[84:87], v[168:171], a[0:3], v[84:87]
    v_mfma_f32_16x16x32_bf16 v[88:91], v[172:175], a[0:3], v[88:91]
    s_waitcnt vmcnt(24)
    v_mfma_f32_16x16x32_bf16 v[72:75], v[176:179], a[16:19], v[72:75]
    buffer_load_dwordx4 v[52:55], v8, s[8:11], s61 offen sc1
    v_mfma_f32_16x16x32_bf16 v[76:79], v[180:183], a[16:19], v[76:79]
    v_mfma_f32_16x16x32_bf16 v[80:83], v[184:187], a[16:19], v[80:83]
    v_mfma_f32_16x16x32_bf16 v[84:87], v[188:191], a[16:19], v[84:87]
    v_mfma_f32_16x16x32_bf16 v[88:91], v[192:195], a[16:19], v[88:91]
    buffer_load_dwordx4 v[56:59], v9, s[8:11], s61 offen sc1
    s_waitcnt vmcnt(25)
    v_mfma_f32_16x16x32_bf16 v[92:95], v[176:179], a[20:23], v[92:95]
    v_mfma_f32_16x16x32_bf16 v[96:99], v[180:183], a[20:23], v[96:99]
    v_mfma_f32_16x16x32_bf16 v[100:103], v[184:187], a[20:23], v[100:103]
    v_mfma_f32_16x16x32_bf16 v[104:107], v[188:191], a[20:23], v[104:107]
    v_mfma_f32_16x16x32_bf16 v[108:111], v[192:195], a[20:23], v[108:111]
    buffer_load_dwordx4 v[60:63], v10, s[8:11], s61 offen sc1
    s_waitcnt vmcnt(25)
    v_mfma_f32_16x16x32_bf16 v[112:115], v[176:179], a[24:27], v[112:115]
    buffer_load_dwordx4 a[100:103], v16, s[4:7], s67 offen offset:0 sc1
    v_mfma_f32_16x16x32_bf16 v[116:119], v[180:183], a[24:27], v[116:119]
    v_mfma_f32_16x16x32_bf16 v[120:123], v[184:187], a[24:27], v[120:123]
    v_mfma_f32_16x16x32_bf16 v[124:127], v[188:191], a[24:27], v[124:127]
    v_mfma_f32_16x16x32_bf16 v[128:131], v[192:195], a[24:27], v[128:131]
    buffer_load_dwordx4 v[64:67], v11, s[8:11], s61 offen sc1
    s_waitcnt vmcnt(26)
    v_mfma_f32_16x16x32_bf16 v[132:135], v[176:179], a[28:31], v[132:135]
    buffer_load_dwordx4 a[104:107], v16, s[4:7], s67 offen offset:1024 sc1
    v_mfma_f32_16x16x32_bf16 v[136:139], v[180:183], a[28:31], v[136:139]
    v_mfma_f32_16x16x32_bf16 v[140:143], v[184:187], a[28:31], v[140:143]
    v_mfma_f32_16x16x32_bf16 v[144:147], v[188:191], a[28:31], v[144:147]
    v_mfma_f32_16x16x32_bf16 v[148:151], v[192:195], a[28:31], v[148:151]
    s_waitcnt vmcnt(26)
    v_mfma_f32_16x16x32_bf16 v[72:75], v[196:199], a[32:35], v[72:75]
    v_mfma_f32_16x16x32_bf16 v[76:79], v[200:203], a[32:35], v[76:79]
    buffer_load_dwordx4 a[108:111], v16, s[4:7], s67 offen offset:2048 sc1
    v_mfma_f32_16x16x32_bf16 v[80:83], v[204:207], a[32:35], v[80:83]
    v_mfma_f32_16x16x32_bf16 v[84:87], v[208:211], a[32:35], v[84:87]
    v_mfma_f32_16x16x32_bf16 v[88:91], v[212:215], a[32:35], v[88:91]
    s_waitcnt vmcnt(26)
    v_mfma_f32_16x16x32_bf16 v[92:95], v[196:199], a[36:39], v[92:95]
    v_mfma_f32_16x16x32_bf16 v[96:99], v[200:203], a[36:39], v[96:99]
    buffer_load_dwordx4 a[112:115], v16, s[4:7], s67 offen offset:3072 sc1
    v_mfma_f32_16x16x32_bf16 v[100:103], v[204:207], a[36:39], v[100:103]
    v_mfma_f32_16x16x32_bf16 v[104:107], v[208:211], a[36:39], v[104:107]
    v_mfma_f32_16x16x32_bf16 v[108:111], v[212:215], a[36:39], v[108:111]
    s_waitcnt vmcnt(26)
    v_mfma_f32_16x16x32_bf16 v[112:115], v[196:199], a[40:43], v[112:115]
    v_mfma_f32_16x16x32_bf16 v[116:119], v[200:203], a[40:43], v[116:119]
    v_mfma_f32_16x16x32_bf16 v[120:123], v[204:207], a[40:43], v[120:123]
    buffer_load_dwordx4 a[116:119], v12, s[4:7], s67 offen offset:0 sc1
    v_mfma_f32_16x16x32_bf16 v[124:127], v[208:211], a[40:43], v[124:127]
    v_mfma_f32_16x16x32_bf16 v[128:131], v[212:215], a[40:43], v[128:131]
    s_waitcnt vmcnt(26)
    v_mfma_f32_16x16x32_bf16 v[132:135], v[196:199], a[44:47], v[132:135]
    v_mfma_f32_16x16x32_bf16 v[136:139], v[200:203], a[44:47], v[136:139]
    s_waitcnt vmcnt(14)
    s_barrier
    s_cmp_lg_u32 s20, 0
    s_cbranch_scc1 L_sig_38
    s_mov_b64 exec, 1
    buffer_atomic_add v18, off, s[4:7], s74 offset:512 sc1
    s_mov_b64 exec, -1
L_sig_38:
    v_mfma_f32_16x16x32_bf16 v[140:143], v[204:207], a[44:47], v[140:143]
    v_mfma_f32_16x16x32_bf16 v[144:147], v[208:211], a[44:47], v[144:147]
    s_waitcnt vmcnt(13)
    v_readfirstlane_b32 s24, v19
    s_cmp_ge_u32 s24, 16
    s_cbranch_scc0 L_slow_39
L_ok_40:
    v_mfma_f32_16x16x32_bf16 v[148:151], v[212:215], a[44:47], v[148:151]
    buffer_load_dwordx4 a[4:7], v8, s[8:11], s62 offen sc1
    v_mfma_f32_16x16x32_bf16 v[72:75], v[216:219], a[48:51], v[72:75]
    buffer_load_dwordx4 a[8:11], v9, s[8:11], s62 offen sc1
    v_mfma_f32_16x16x32_bf16 v[76:79], v[220:223], a[48:51], v[76:79]
    v_mfma_f32_16x16x32_bf16 v[80:83], v[224:227], a[48:51], v[80:83]
    buffer_load_dwordx4 a[12:15], v10, s[8:11], s62 offen sc1
    v_mfma_f32_16x16x32_bf16 v[84:87], v[228:231], a[48:51], v[84:87]
    v_mfma_f32_16x16x32_bf16 v[88:91], v[232:235], a[48:51], v[88:91]
    buffer_load_dwordx4 a[0:3], v11, s[8:11], s62 offen sc1
    v_mfma_f32_16x16x32_bf16 v[92:95], v[216:219], a[52:55], v[92:95]
    buffer_load_dwordx4 a[16:19], v8, s[8:11], s63 offen sc1
    v_mfma_f32_16x16x32_bf16 v[96:99], v[220:223], a[52:55], v[96:99]
    v_mfma_f32_16x16x32_bf16 v[100:103], v[224:227], a[52:55], v[100:103]
    buffer_load_dwordx4 a[20:23], v9, s[8:11], s63 offen sc1
    v_mfma_f32_16x16x32_bf16 v[104:107], v[228:231], a[52:55], v[104:107]
    v_mfma_f32_16x16x32_bf16 v[108:111], v[232:235], a[52:55], v[108:111]
    buffer_load_dwordx4 a[24:27], v10, s[8:11], s63 offen sc1
    v_mfma_f32_16x16x32_bf16 v[112:115], v[216:219], a[56:59], v[112:115]
    v_mfma_f32_16x16x32_bf16 v[116:119], v[220:223], a[56:59], v[116:119]
    v_mfma_f32_16x16x32_bf16 v[120:123], v[224:227], a[56:59], v[120:123]
    v_mfma_f32_16x16x32_bf16 v[124:127], v[228:231], a[56:59], v[124:127]
    v_mfma_f32_16x16x32_bf16 v[128:131], v[232:235], a[56:59], v[128:131]
    buffer_load_dwordx4 a[28:31], v11, s[8:11], s63 offen sc1
    v_mfma_f32_16x16x32_bf16 v[132:135], v[216:219], a[60:63], v[132:135]
    v_mfma_f32_16x16x32_bf16 v[136:139], v[220:223], a[60:63], v[136:139]
    v_mfma_f32_16x16x32_bf16 v[140:143], v[224:227], a[60:63], v[140:143]
    v_mfma_f32_16x16x32_bf16 v[144:147], v[228:231], a[60:63], v[144:147]
    v_mfma_f32_16x16x32_bf16 v[148:151], v[232:235], a[60:63], v[148:151]
    s_waitcnt vmcnt(20)
    v_mfma_f32_16x16x32_bf16 v[72:75], v[236:239], a[64:67], v[72:75]
    buffer_load_dwordx4 a[32:35], v8, s[8:11], s64 offen sc1
    v_mfma_f32_16x16x32_bf16 v[76:79], v[240:243], a[64:67], v[76:79]
    v_mfma_f32_16x16x32_bf16 v[80:83], v[244:247], a[64:67], v[80:83]
    v_mfma_f32_16x16x32_bf16 v[84:87], v[248:251], a[64:67], v[84:87]
    v_mfma_f32_16x16x32_bf16 v[88:91], v[252:255], a[64:67], v[88:91]
    buffer_load_dwordx4 a[36:39], v9, s[8:11], s64 offen sc1
    s_waitcnt vmcnt(21)
    v_mfma_f32_16x16x32_bf16 v[92:95], v[236:239], a[68:71], v[92:95]
    v_mfma_f32_16x16x32_bf16 v[96:99], v[240:243], a[68:71], v[96:99]
    v_mfma_f32_16x16x32_bf16 v[100:103], v[244:247], a[68:71], v[100:103]
    v_mfma_f32_16x16x32_bf16 v[104:107], v[248:251], a[68:71], v[104:107]
    v_mfma_f32_16x16x32_bf16 v[108:111], v[252:255], a[68:71], v[108:111]
    buffer_load_dwordx4 a[40:43], v10, s[8:11], s64 offen sc1
    s_waitcnt vmcnt(21)
    v_mfma_f32_16x16x32_bf16 v[112:115], v[236:239], a[72:75], v[112:115]
    v_mfma_f32_16x16x32_bf16 v[116:119], v[240:243], a[72:75], v[116:119]
    v_mfma_f32_16x16x32_bf16 v[120:123], v[244:247], a[72:75], v[120:123]
    v_mfma_f32_16x16x32_bf16 v[124:127], v[248:251], a[72:75], v[124:127]
    v_mfma_f32_16x16x32_bf16 v[128:131], v[252:255], a[72:75], v[128:131]
    buffer_load_dwordx4 a[44:47], v11, s[8:11], s64 offen sc1
    s_waitcnt vmcnt(21)
    v_mfma_f32_16x16x32_bf16 v[132:135], v[236:239], v[48:51], v[132:135]
    v_mfma_f32_16x16x32_bf16 v[136:139], v[240:243], v[48:51], v[136:139]
    v_mfma_f32_16x16x32_bf16 v[140:143], v[244:247], v[48:51], v[140:143]
    v_mfma_f32_16x16x32_bf16 v[144:147], v[248:251], v[48:51], v[144:147]
    v_mfma_f32_16x16x32_bf16 v[148:151], v[252:255], v[48:51], v[148:151]
    s_waitcnt vmcnt(20)
    v_mfma_f32_16x16x32_bf16 v[72:75], a[160:163], v[52:55], v[72:75]
    buffer_load_dwordx4 a[48:51], v8, s[8:11], s65 offen sc1
    v_mfma_f32_16x16x32_bf16 v[76:79], a[164:167], v[52:55], v[76:79]
    v_mfma_f32_16x16x32_bf16 v[80:83], a[168:171], v[52:55], v[80:83]
    v_mfma_f32_16x16x32_bf16 v[84:87], a[172:175], v[52:55], v[84:87]
    v_mfma_f32_16x16x32_bf16 v[88:91], a[176:179], v[52:55], v[88:91]
    buffer_load_dwordx4 a[52:55], v9, s[8:11], s65 offen sc1
    s_waitcnt vmcnt(21)
    v_mfma_f32_16x16x32_bf16 v[92:95], a[160:163], v[56:59], v[92:95]
    v_mfma_f32_16x16x32_bf16 v[96:99], a[164:167], v[56:59], v[96:99]
    v_mfma_f32_16x16x32_bf16 v[100:103], a[168:171], v[56:59], v[100:103]
    v_mfma_f32_16x16x32_bf16 v[104:107], a[172:175], v[56:59], v[104:107]
    v_mfma_f32_16x16x32_bf16 v[108:111], a[176:179], v[56:59], v[108:111]
    buffer_load_dwordx4 a[56:59], v10, s[8:11], s65 offen sc1
    s_waitcnt vmcnt(21)
    v_mfma_f32_16x16x32_bf16 v[112:115], a[160:163], v[60:63], v[112:115]
    v_mfma_f32_16x16x32_bf16 v[116:119], a[164:167], v[60:63], v[116:119]
    v_mfma_f32_16x16x32_bf16 v[120:123], a[168:171], v[60:63], v[120:123]
    v_mfma_f32_16x16x32_bf16 v[124:127], a[172:175], v[60:63], v[124:127]
    v_mfma_f32_16x16x32_bf16 v[128:131], a[176:179], v[60:63], v[128:131]
    buffer_load_dwordx4 a[60:63], v11, s[8:11], s65 offen sc1
    s_waitcnt vmcnt(20)
    v_mfma_f32_16x16x32_bf16 v[132:135], a[160:163], v[64:67], v[132:135]
    buffer_load_dword v19, off, s[4:7], s74 offset:512 sc1
    v_mfma_f32_16x16x32_bf16 v[136:139], a[164:167], v[64:67], v[136:139]
    buffer_load_dwordx4 a[120:123], v16, s[4:7], s68 offen offset:0 sc1
    v_mfma_f32_16x16x32_bf16 v[140:143], a[168:171], v[64:67], v[140:143]
    v_mfma_f32_16x16x32_bf16 v[144:147], a[172:175], v[64:67], v[144:147]
    v_mfma_f32_16x16x32_bf16 v[148:151], a[176:179], v[64:67], v[148:151]
    s_waitcnt vmcnt(17)
    v_mfma_f32_16x16x32_bf16 v[72:75], a[180:183], a[4:7], v[72:75]
    buffer_load_dwordx4 a[124:127], v16, s[4:7], s68 offen offset:1024 sc1
    v_mfma_f32_16x16x32_bf16 v[76:79], a[184:187], a[4:7], v[76:79]
    v_mfma_f32_16x16x32_bf16 v[80:83], a[188:191], a[4:7], v[80:83]
    v_mfma_f32_16x16x32_bf16 v[84:87], a[192:195], a[4:7], v[84:87]
    v_mfma_f32_16x16x32_bf16 v[88:91], a[196:199], a[4:7], v[88:91]
    buffer_load_dwordx4 a[128:131], v16, s[4:7], s68 offen offset:2048 sc1
    s_waitcnt vmcnt(18)
    v_mfma_f32_16x16x32_bf16 v[92:95], a[180:183], a[8:11], v[92:95]
    v_mfma_f32_16x16x32_bf16 v[96:99], a[184:187], a[8:11], v[96:99]
    v_mfma_f32_16x16x32_bf16 v[100:103], a[188:191], a[8:11], v[100:103]
    v_mfma_f32_16x16x32_bf16 v[104:107], a[192:195], a[8:11], v[104:107]
    buffer_load_dwordx4 a[132:135], v16, s[4:7], s68 offen offset:3072 sc1
    v_mfma_f32_16x16x32_bf16 v[108:111], a[196:199], a[8:11], v[108:111]
    s_waitcnt vmcnt(18)
    v_mfma_f32_16x16x32_bf16 v[112:115], a[180:183], a[12:15], v[112:115]
    v_mfma_f32_16x16x32_bf16 v[116:119], a[184:187], a[12:15], v[116:119]
    v_mfma_f32_16x16x32_bf16 v[120:123], a[188:191], a[12:15], v[120:123]
    buffer_load_dwordx4 a[136:139], v12, s[4:7], s68 offen offset:0 sc1
    v_mfma_f32_16x16x32_bf16 v[124:127], a[192:195], a[12:15], v[124:127]
    v_mfma_f32_16x16x32_bf16 v[128:131], a[196:199], a[12:15], v[128:131]
    s_waitcnt vmcnt(18)
    v_mfma_f32_16x16x32_bf16 v[132:135], a[180:183], a[0:3], v[132:135]
    v_mfma_f32_16x16x32_bf16 v[136:139], a[184:187], a[0:3], v[136:139]
    buffer_load_dwordx4 a[140:143], v16, s[4:7], s69 offen offset:0 sc1
    v_mfma_f32_16x16x32_bf16 v[140:143], a[188:191], a[0:3], v[140:143]
    v_mfma_f32_16x16x32_bf16 v[144:147], a[192:195], a[0:3], v[144:147]
    v_mfma_f32_16x16x32_bf16 v[148:151], a[196:199], a[0:3], v[148:151]
    s_waitcnt vmcnt(18)
    v_mfma_f32_16x16x32_bf16 v[72:75], a[200:203], a[16:19], v[72:75]
    v_mfma_f32_16x16x32_bf16 v[76:79], a[204:207], a[16:19], v[76:79]
    buffer_load_dwordx4 a[144:147], v16, s[4:7], s69 offen offset:1024 sc1
    v_mfma_f32_16x16x32_bf16 v[80:83], a[208:211], a[16:19], v[80:83]
    v_mfma_f32_16x16x32_bf16 v[84:87], a[212:215], a[16:19], v[84:87]
    v_mfma_f32_16x16x32_bf16 v[88:91], a[216:219], a[16:19], v[88:91]
    s_waitcnt vmcnt(18)
    v_mfma_f32_16x16x32_bf16 v[92:95], a[200:203], a[20:23], v[92:95]
    buffer_load_dwordx4 a[148:151], v16, s[4:7], s69 offen offset:2048 sc1
    v_mfma_f32_16x16x32_bf16 v[96:99], a[204:207], a[20:23], v[96:99]
    v_mfma_f32_16x16x32_bf16 v[100:103], a[208:211], a[20:23], v[100:103]
    v_mfma_f32_16x16x32_bf16 v[104:107], a[212:215], a[20:23], v[104:107]
    v_mfma_f32_16x16x32_bf16 v[108:111], a[216:219], a[20:23], v[108:111]
    buffer_load_dwordx4 a[152:155], v16, s[4:7], s69 offen offset:3072 sc1
    s_waitcnt vmcnt(19)
    v_mfma_f32_16x16x32_bf16 v[112:115], a[200:203], a[24:27], v[112:115]
    v_mfma_f32_16x16x32_bf16 v[116:119], a[204:207], a[24:27], v[116:119]
    v_mfma_f32_16x16x32_bf16 v[120:123], a[208:211], a[24:27], v[120:123]
    v_mfma_f32_16x16x32_bf16 v[124:127], a[212:215], a[24:27], v[124:127]
    buffer_load_dwordx4 a[156:159], v12, s[4:7], s69 offen offset:0 sc1
    v_mfma_f32_16x16x32_bf16 v[128:131], a[216:219], a[24:27], v[128:131]
    s_waitcnt vmcnt(19)
    v_mfma_f32_16x16x32_bf16 v[132:135], a[200:203], a[28:31], v[132:135]
    v_mfma_f32_16x16x32_bf16 v[136:139], a[204:207], a[28:31], v[136:139]
    v_mfma_f32_16x16x32_bf16 v[140:143], a[208:211], a[28:31], v[140:143]
    v_mfma_f32_16x16x32_bf16 v[144:147], a[212:215], a[28:31], v[144:147]
    s_waitcnt vmcnt(10)
    v_readfirstlane_b32 s24, v19
    s_cmp_ge_u32 s24, 16
    s_cbranch_scc0 L_slow_41
L_ok_42:
    v_mfma_f32_16x16x32_bf16 v[148:151], a[216:219], a[28:31], v[148:151]
    buffer_load_dwordx4 a[64:67], v8, s[8:11], s66 offen sc1
    v_mfma_f32_16x16x32_bf16 v[72:75], a[220:223], a[32:35], v[72:75]
    buffer_load_dwordx4 a[68:71], v9, s[8:11], s66 offen sc1
    v_mfma_f32_16x16x32_bf16 v[76:79], a[224:227], a[32:35], v[76:79]
    v_mfma_f32_16x16x32_bf16 v[80:83], a[228:231], a[32:35], v[80:83]
    buffer_load_dwordx4 a[72:75], v10, s[8:11], s66 offen sc1
    v_mfma_f32_16x16x32_bf16 v[84:87], a[232:235], a[32:35], v[84:87]
    v_mfma_f32_16x16x32_bf16 v[88:91], a[236:239], a[32:35], v[88:91]
    buffer_load_dwordx4 v[48:51], v11, s[8:11], s66 offen sc1
    v_mfma_f32_16x16x32_bf16 v[92:95], a[220:223], a[36:39], v[92:95]
    buffer_load_dwordx4 v[52:55], v8, s[8:11], s67 offen sc1
    v_mfma_f32_16x16x32_bf16 v[96:99], a[224:227], a[36:39], v[96:99]
    v_mfma_f32_16x16x32_bf16 v[100:103], a[228:231], a[36:39], v[100:103]
    buffer_load_dwordx4 v[56:59], v9, s[8:11], s67 offen sc1
    v_mfma_f32_16x16x32_bf16 v[104:107], a[232:235], a[36:39], v[104:107]
    v_mfma_f32_16x16x32_bf16 v[108:111], a[236:239], a[36:39], v[108:111]
    buffer_load_dwordx4 v[60:63], v10, s[8:11], s67 offen sc1
    v_mfma_f32_16x16x32_bf16 v[112:115], a[220:223], a[40:43], v[112:115]
    s_add_u32 s25, s20, 1
    s_and_b32 s25, s25, 3
    v_mfma_f32_16x16x32_bf16 v[116:119], a[224:227], a[40:43], v[116:119]
    buffer_load_dwordx4 v[64:67], v11, s[8:11], s67 offen sc1
    v_mfma_f32_16x16x32_bf16 v[120:123], a[228:231], a[40:43], v[120:123]
    s_mul_i32 s25, s25, 15360
    s_add_u32 s25, s25, 90112
    v_mfma_f32_16x16x32_bf16 v[124:127], a[232:235], a[40:43], v[124:127]
    v_add_u32 v69, s25, v2
    v_mfma_f32_16x16x32_bf16 v[128:131], a[236:239], a[40:43], v[128:131]
    buffer_load_dwordx4 a[4:7], v8, s[8:11], s68 offen sc1
    v_mfma_f32_16x16x32_bf16 v[132:135], a[220:223], a[44:47], v[132:135]
    s_add_u32 s25, s20, 2
    s_and_b32 s25, s25, 3
    v_mfma_f32_16x16x32_bf16 v[136:139], a[224:227], a[44:47], v[136:139]
    buffer_load_dwordx4 a[8:11], v9, s[8:11], s68 offen sc1
    v_mfma_f32_16x16x32_bf16 v[140:143], a[228:231], a[44:47], v[140:143]
    s_mul_i32 s25, s25, 15360
    s_add_u32 s25, s25, 95232
    v_mfma_f32_16x16x32_bf16 v[144:147], a[232:235], a[44:47], v[144:147]
    buffer_load_dwordx4 a[12:15], v10, s[8:11], s68 offen sc1
    v_mfma_f32_16x16x32_bf16 v[148:151], a[236:239], a[44:47], v[148:151]
    v_add_u32 v70, s25, v2
    v_mfma_f32_16x16x32_bf16 v[72:75], a[240:243], a[48:51], v[72:75]
    buffer_load_dwordx4 a[0:3], v11, s[8:11], s68 offen sc1
    v_mfma_f32_16x16x32_bf16 v[76:79], a[244:247], a[48:51], v[76:79]
    s_add_u32 s25, s20, 3
    s_and_b32 s25, s25, 3
    v_mfma_f32_16x16x32_bf16 v[80:83], a[248:251], a[48:51], v[80:83]
    s_mul_i32 s25, s25, 15360
    s_add_u32 s25, s25, 100352
    v_mfma_f32_16x16x32_bf16 v[84:87], a[252:255], a[48:51], v[84:87]
    buffer_load_dwordx4 a[16:19], v8, s[8:11], s69 offen sc1
    v_mfma_f32_16x16x32_bf16 v[88:91], a[76:79], a[48:51], v[88:91]
    v_add_u32 v71, s25, v2
    v_mfma_f32_16x16x32_bf16 v[92:95], a[240:243], a[52:55], v[92:95]
    buffer_load_dwordx4 a[20:23], v9, s[8:11], s69 offen sc1
    v_mfma_f32_16x16x32_bf16 v[96:99], a[244:247], a[52:55], v[96:99]
    s_mul_i32 s25, s20, 15360
    s_add_u32 s25, s25, 90112
    v_mfma_f32_16x16x32_bf16 v[100:103], a[248:251], a[52:55], v[100:103]
    v_mfma_f32_16x16x32_bf16 v[104:107], a[252:255], a[52:55], v[104:107]
    v_add_u32 v68, s25, v2
    v_mfma_f32_16x16x32_bf16 v[108:111], a[76:79], a[52:55], v[108:111]
    buffer_load_dwordx4 a[24:27], v10, s[8:11], s69 offen sc1
    v_mfma_f32_16x16x32_bf16 v[112:115], a[240:243], a[56:59], v[112:115]
    v_mfma_f32_16x16x32_bf16 v[116:119], a[244:247], a[56:59], v[116:119]
    v_mfma_f32_16x16x32_bf16 v[120:123], a[248:251], a[56:59], v[120:123]
    v_mfma_f32_16x16x32_bf16 v[124:127], a[252:255], a[56:59], v[124:127]
    v_mfma_f32_16x16x32_bf16 v[128:131], a[76:79], a[56:59], v[128:131]
    buffer_load_dwordx4 a[28:31], v11, s[8:11], s69 offen sc1
    v_mfma_f32_16x16x32_bf16 v[132:135], a[240:243], a[60:63], v[132:135]
    v_mfma_f32_16x16x32_bf16 v[136:139], a[244:247], a[60:63], v[136:139]
    v_mfma_f32_16x16x32_bf16 v[140:143], a[248:251], a[60:63], v[140:143]
    v_mfma_f32_16x16x32_bf16 v[144:147], a[252:255], a[60:63], v[144:147]
    v_mfma_f32_16x16x32_bf16 v[148:151], a[76:79], a[60:63], v[148:151]
    s_waitcnt vmcnt(15)
    v_mfma_f32_16x16x32_bf16 v[72:75], a[80:83], a[64:67], v[72:75]
    v_mfma_f32_16x16x32_bf16 v[76:79], a[84:87], a[64:67], v[76:79]
    v_mfma_f32_16x16x32_bf16 v[80:83], a[88:91], a[64:67], v[80:83]
    v_mfma_f32_16x16x32_bf16 v[84:87], a[92:95], a[64:67], v[84:87]
    v_mfma_f32_16x16x32_bf16 v[88:91], a[96:99], a[64:67], v[88:91]
    s_waitcnt vmcnt(14)
    v_mfma_f32_16x16x32_bf16 v[92:95], a[80:83], a[68:71], v[92:95]
    v_mfma_f32_16x16x32_bf16 v[96:99], a[84:87], a[68:71], v[96:99]
    v_mfma_f32_16x16x32_bf16 v[100:103], a[88:91], a[68:71], v[100:103]
    v_mfma_f32_16x16x32_bf16 v[104:107], a[92:95], a[68:71], v[104:107]
    v_mfma_f32_16x16x32_bf16 v[108:111], a[96:99], a[68:71], v[108:111]
    s_waitcnt vmcnt(13)
    v_mfma_f32_16x16x32_bf16 v[112:115], a[80:83], a[72:75], v[112:115]
    v_mfma_f32_16x16x32_bf16 v[116:119], a[84:87], a[72:75], v[116:119]
    v_mfma_f32_16x16x32_bf16 v[120:123], a[88:91], a[72:75], v[120:123]
    v_mfma_f32_16x16x32_bf16 v[124:127], a[92:95], a[72:75], v[124:127]
    v_mfma_f32_16x16x32_bf16 v[128:131], a[96:99], a[72:75], v[128:131]
    s_waitcnt vmcnt(12)
    v_mfma_f32_16x16x32_bf16 v[132:135], a[80:83], v[48:51], v[132:135]
    v_mfma_f32_16x16x32_bf16 v[136:139], a[84:87], v[48:51], v[136:139]
    v_mfma_f32_16x16x32_bf16 v[140:143], a[88:91], v[48:51], v[140:143]
    v_mfma_f32_16x16x32_bf16 v[144:147], a[92:95], v[48:51], v[144:147]
    v_mfma_f32_16x16x32_bf16 v[148:151], a[96:99], v[48:51], v[148:151]
    s_waitcnt vmcnt(11)
    v_mfma_f32_16x16x32_bf16 v[72:75], a[100:103], v[52:55], v[72:75]
    v_mfma_f32_16x16x32_bf16 v[76:79], a[104:107], v[52:55], v[76:79]
    v_mfma_f32_16x16x32_bf16 v[80:83], a[108:111], v[52:55], v[80:83]
    v_mfma_f32_16x16x32_bf16 v[84:87], a[112:115], v[52:55], v[84:87]
    v_mfma_f32_16x16x32_bf16 v[88:91], a[116:119], v[52:55], v[88:91]
    s_waitcnt vmcnt(10)
    v_mfma_f32_16x16x32_bf16 v[92:95], a[100:103], v[56:59], v[92:95]
    v_mfma_f32_16x16x32_bf16 v[96:99], a[104:107], v[56:59], v[96:99]
    v_mfma_f32_16x16x32_bf16 v[100:103], a[108:111], v[56:59], v[100:103]
    v_mfma_f32_16x16x32_bf16 v[104:107], a[112:115], v[56:59], v[104:107]
    v_mfma_f32_16x16x32_bf16 v[108:111], a[116:119], v[56:59], v[108:111]
    s_waitcnt vmcnt(9)
    v_mfma_f32_16x16x32_bf16 v[112:115], a[100:103], v[60:63], v[112:115]
    v_mfma_f32_16x16x32_bf16 v[116:119], a[104:107], v[60:63], v[116:119]
    v_mfma_f32_16x16x32_bf16 v[120:123], a[108:111], v[60:63], v[120:123]
    v_mfma_f32_16x16x32_bf16 v[124:127], a[112:115], v[60:63], v[124:127]
    v_mfma_f32_16x16x32_bf16 v[128:131], a[116:119], v[60:63], v[128:131]
    s_waitcnt vmcnt(8)
    v_mfma_f32_16x16x32_bf16 v[132:135], a[100:103], v[64:67], v[132:135]
    v_mfma_f32_16x16x32_bf16 v[136:139], a[104:107], v[64:67], v[136:139]
    v_mfma_f32_16x16x32_bf16 v[140:143], a[108:111], v[64:67], v[140:143]
    v_mfma_f32_16x16x32_bf16 v[144:147], a[112:115], v[64:67], v[144:147]
    v_mfma_f32_16x16x32_bf16 v[148:151], a[116:119], v[64:67], v[148:151]
    s_waitcnt vmcnt(6)
    v_mfma_f32_16x16x32_bf16 v[92:95], a[120:123], a[8:11], v[92:95]
    v_mfma_f32_16x16x32_bf16 v[96:99], a[124:127], a[8:11], v[96:99]
    v_mfma_f32_16x16x32_bf16 v[100:103], a[128:131], a[8:11], v[100:103]
    v_mfma_f32_16x16x32_bf16 v[104:107], a[132:135], a[8:11], v[104:107]
    v_mfma_f32_16x16x32_bf16 v[108:111], a[136:139], a[8:11], v[108:111]
    s_waitcnt vmcnt(2)
    v_mfma_f32_16x16x32_bf16 v[92:95], a[140:143], a[20:23], v[92:95]
    v_mfma_f32_16x16x32_bf16 v[96:99], a[144:147], a[20:23], v[96:99]
    v_mfma_f32_16x16x32_bf16 v[100:103], a[148:151], a[20:23], v[100:103]
    v_mfma_f32_16x16x32_bf16 v[104:107], a[152:155], a[20:23], v[104:107]
    v_mfma_f32_16x16x32_bf16 v[108:111], a[156:159], a[20:23], v[108:111]
    v_mfma_f32_16x16x32_bf16 v[112:115], a[120:123], a[12:15], v[112:115]
    v_mfma_f32_16x16x32_bf16 v[116:119], a[124:127], a[12:15], v[116:119]
    v_mfma_f32_16x16x32_bf16 v[120:123], a[128:131], a[12:15], v[120:123]
    v_mfma_f32_16x16x32_bf16 v[124:127], a[132:135], a[12:15], v[124:127]
    ds_write_b128 v69, v[92:95] offset:0
    v_mfma_f32_16x16x32_bf16 v[128:131], a[136:139], a[12:15], v[128:131]
    ds_write_b128 v69, v[96:99] offset:1024
    s_waitcnt vmcnt(1)
    v_mfma_f32_16x16x32_bf16 v[112:115], a[140:143], a[24:27], v[112:115]
    v_mfma_f32_16x16x32_bf16 v[116:119], a[144:147], a[24:27], v[116:119]
    ds_write_b128 v69, v[100:103] offset:2048
    v_mfma_f32_16x16x32_bf16 v[120:123], a[148:151], a[24:27], v[120:123]
    v_mfma_f32_16x16x32_bf16 v[124:127], a[152:155], a[24:27], v[124:127]
    ds_write_b128 v69, v[104:107] offset:3072
    v_mfma_f32_16x16x32_bf16 v[128:131], a[156:159], a[24:27], v[128:131]
    v_mfma_f32_16x16x32_bf16 v[132:135], a[120:123], a[0:3], v[132:135]
    ds_write_b128 v69, v[108:111] offset:4096
    v_mfma_f32_16x16x32_bf16 v[136:139], a[124:127], a[0:3], v[136:139]
    v_mfma_f32_16x16x32_bf16 v[140:143], a[128:131], a[0:3], v[140:143]
    v_mfma_f32_16x16x32_bf16 v[144:147], a[132:135], a[0:3], v[144:147]
    ds_write_b128 v70, v[112:115] offset:0
    v_mfma_f32_16x16x32_bf16 v[148:151], a[136:139], a[0:3], v[148:151]
    ds_write_b128 v70, v[116:119] offset:1024
    s_waitcnt vmcnt(0)
    v_mfma_f32_16x16x32_bf16 v[132:135], a[140:143], a[28:31], v[132:135]
    v_mfma_f32_16x16x32_bf16 v[136:139], a[144:147], a[28:31], v[136:139]
    ds_write_b128 v70, v[120:123] offset:2048
    v_mfma_f32_16x16x32_bf16 v[140:143], a[148:151], a[28:31], v[140:143]
    v_mfma_f32_16x16x32_bf16 v[144:147], a[152:155], a[28:31], v[144:147]
    ds_write_b128 v70, v[124:127] offset:3072
    v_mfma_f32_16x16x32_bf16 v[148:151], a[156:159], a[28:31], v[148:151]
    v_mfma_f32_16x16x32_bf16 v[72:75], a[120:123], a[4:7], v[72:75]
    ds_write_b128 v70, v[128:131] offset:4096
    v_mfma_f32_16x16x32_bf16 v[76:79], a[124:127], a[4:7], v[76:79]
    v_mfma_f32_16x16x32_bf16 v[80:83], a[128:131], a[4:7], v[80:83]
    v_mfma_f32_16x16x32_bf16 v[84:87], a[132:135], a[4:7], v[84:87]
    ds_write_b128 v71, v[132:135] offset:0
    v_mfma_f32_16x16x32_bf16 v[88:91], a[136:139], a[4:7], v[88:91]
    ds_write_b128 v71, v[136:139] offset:1024
    v_mfma_f32_16x16x32_bf16 v[72:75], a[140:143], a[16:19], v[72:75]
    v_mfma_f32_16x16x32_bf16 v[76:79], a[144:147], a[16:19], v[76:79]
    ds_write_b128 v71, v[140:143] offset:2048
    v_mfma_f32_16x16x32_bf16 v[80:83], a[148:151], a[16:19], v[80:83]
    v_mfma_f32_16x16x32_bf16 v[84:87], a[152:155], a[16:19], v[84:87]
    ds_write_b128 v71, v[144:147] offset:3072
    v_mfma_f32_16x16x32_bf16 v[88:91], a[156:159], a[16:19], v[88:91]
    ds_write_b128 v71, v[148:151] offset:4096
    s_waitcnt lgkmcnt(0)
    s_barrier
    ds_read_b128 v[92:95], v68 offset:0
    ds_read_b128 v[96:99], v68 offset:1024
    ds_read_b128 v[100:103], v68 offset:2048
    ds_read_b128 v[104:107], v68 offset:3072
    ds_read_b128 v[108:111], v68 offset:4096
    ds_read_b128 v[112:115], v68 offset:5120
    ds_read_b128 v[116:119], v68 offset:6144
    ds_read_b128 v[120:123], v68 offset:7168
    ds_read_b128 v[124:127], v68 offset:8192
    ds_read_b128 v[128:131], v68 offset:9216
    ds_read_b128 v[132:135], v68 offset:10240
    ds_read_b128 v[136:139], v68 offset:11264
    ds_read_b128 v[140:143], v68 offset:12288
    ds_read_b128 v[144:147], v68 offset:13312
    ds_read_b128 v[148:151], v68 offset:14336
    s_waitcnt lgkmcnt(14)
    v_pk_add_f32 v[72:73], v[72:73], v[92:93]
    v_pk_add_f32 v[74:75], v[74:75], v[94:95]
    s_waitcnt lgkmcnt(13)
    v_pk_add_f32 v[76:77], v[76:77], v[96:97]
    v_pk_add_f32 v[78:79], v[78:79], v[98:99]
    s_waitcnt lgkmcnt(12)
    v_pk_add_f32 v[80:81], v[80:81], v[100:101]
    v_pk_add_f32 v[82:83], v[82:83], v[102:103]
    s_waitcnt lgkmcnt(11)
    v_pk_add_f32 v[84:85], v[84:85], v[104:105]
    v_pk_add_f32 v[86:87], v[86:87], v[106:107]
    s_waitcnt lgkmcnt(10)
    v_pk_add_f32 v[88:89], v[88:89], v[108:109]
    v_pk_add_f32 v[90:91], v[90:91], v[110:111]
    s_waitcnt lgkmcnt(9)
    v_pk_add_f32 v[72:73], v[72:73], v[112:113]
    v_pk_add_f32 v[74:75], v[74:75], v[114:115]
    s_waitcnt lgkmcnt(8)
    v_pk_add_f32 v[76:77], v[76:77], v[116:117]
    v_pk_add_f32 v[78:79], v[78:79], v[118:119]
    s_waitcnt lgkmcnt(7)
    v_pk_add_f32 v[80:81], v[80:81], v[120:121]
    v_pk_add_f32 v[82:83], v[82:83], v[122:123]
    s_waitcnt lgkmcnt(6)
    v_pk_add_f32 v[84:85], v[84:85], v[124:125]
    v_pk_add_f32 v[86:87], v[86:87], v[126:127]
    s_waitcnt lgkmcnt(5)
    v_pk_add_f32 v[88:89], v[88:89], v[128:129]
    v_pk_add_f32 v[90:91], v[90:91], v[130:131]
    s_waitcnt lgkmcnt(4)
    v_pk_add_f32 v[72:73], v[72:73], v[132:133]
    v_pk_add_f32 v[74:75], v[74:75], v[134:135]
    s_waitcnt lgkmcnt(3)
    v_pk_add_f32 v[76:77], v[76:77], v[136:137]
    v_pk_add_f32 v[78:79], v[78:79], v[138:139]
    s_waitcnt lgkmcnt(2)
    v_pk_add_f32 v[80:81], v[80:81], v[140:141]
    v_pk_add_f32 v[82:83], v[82:83], v[142:143]
    s_waitcnt lgkmcnt(1)
    v_pk_add_f32 v[84:85], v[84:85], v[144:145]
    v_pk_add_f32 v[86:87], v[86:87], v[146:147]
    s_waitcnt lgkmcnt(0)
    v_pk_add_f32 v[88:89], v[88:89], v[148:149]
    v_pk_add_f32 v[90:91], v[90:91], v[150:151]
    v_lshrrev_b32 v60, 4, v1
    v_and_b32 v61, 1, v60
    v_mul_u32_u24 v61, 24, v61
    v_add_u32 v17, v17, v61
    v_cvt_pk_bf16_f32 v48, v72, v73
    v_cvt_pk_bf16_f32 v49, v74, v75
    v_cvt_pk_bf16_f32 v50, v76, v77
    v_cvt_pk_bf16_f32 v51, v78, v79
    s_nop 1
    v_permlane16_swap_b32 v48, v50
    v_permlane16_swap_b32 v49, v51
    buffer_store_dwordx4 v[48:51], v17, s[12:15], 0 offen offset:0
    v_cvt_pk_bf16_f32 v52, v80, v81
    v_cvt_pk_bf16_f32 v53, v82, v83
    v_cvt_pk_bf16_f32 v54, v84, v85
    v_cvt_pk_bf16_f32 v55, v86, v87
    s_nop 1
    v_permlane16_swap_b32 v52, v54
    v_permlane16_swap_b32 v53, v55
    buffer_store_dwordx4 v[52:55], v17, s[12:15], 0 offen offset:64
    v_cvt_pk_bf16_f32 v56, v88, v89
    v_cvt_pk_bf16_f32 v57, v90, v91
    s_nop 1
    v_permlane16_swap_b32 v56, v58
    v_permlane16_swap_b32 v57, v59
    s_mov_b32 exec_lo, 0xffff
    s_mov_b32 exec_hi, 0xffff
    buffer_store_dwordx4 v[56:59], v17, s[12:15], 0 offen offset:128
    s_mov_b64 exec, -1
    s_cmp_lg_u32 s2, 0
    s_cbranch_scc1 L_noep
    v_mov_b32 v60, s83
    s_mov_b32 s24, 19922944
    buffer_store_dword v60, off, s[4:7], s24 sc1
L_noep:
L_exit:
    s_endpgm
L_slow_1:
    s_movk_i32 s79, 30000
L_spin_43:
    buffer_load_dword v182, off, s[4:7], s25 offset:0 sc1
    s_waitcnt vmcnt(0)
    v_readfirstlane_b32 s24, v182
    s_cmp_eq_u32 s24, s83
    s_cbranch_scc1 L_ok_2
    s_sub_u32 s79, s79, 1
    s_cbranch_scc0 L_spin_43
    s_branch L_ok_2
L_slow_7:
    s_movk_i32 s79, 30000
L_spin_44:
    buffer_load_dword v19, off, s[4:7], s3 offset:0 sc1
    s_waitcnt vmcnt(0)
    v_readfirstlane_b32 s24, v19
    s_cmp_ge_u32 s24, 96
    s_cbranch_scc1 L_ok_8
    s_sleep 4
    s_sub_u32 s79, s79, 1
    s_cbranch_scc0 L_spin_44
    s_branch L_ok_8
L_slow_17:
    s_movk_i32 s79, 30000
L_spin_45:
    buffer_load_dword v19, off, s[4:7], s3 offset:2048 sc1
    s_waitcnt vmcnt(0)
    v_readfirstlane_b32 s24, v19
    s_cmp_ge_u32 s24, 92
    s_cbranch_scc1 L_ok_18
    s_sub_u32 s79, s79, 1
    s_cbranch_scc0 L_spin_45
    s_branch L_ok_18
L_slow_20:
    s_movk_i32 s79, 30000
L_spin_46:
    buffer_load_dword v19, off, s[4:7], s74 offset:256 sc1
    s_waitcnt vmcnt(0)
    v_readfirstlane_b32 s24, v19
    s_cmp_ge_u32 s24, 16
    s_cbranch_scc1 L_ok_21
    s_sub_u32 s79, s79, 1
    s_cbranch_scc0 L_spin_46
    s_branch L_ok_21
L_slow_24:
    s_movk_i32 s79, 30000
L_spin_47:
    buffer_load_dword v19, off, s[4:7], s74 offset:768 sc1
    s_waitcnt vmcnt(0)
    v_readfirstlane_b32 s24, v19
    s_cmp_ge_u32 s24, 16
    s_cbranch_scc1 L_ok_25
    s_sub_u32 s79, s79, 1
    s_cbranch_scc0 L_spin_47
    s_branch L_ok_25
L_slow_26:
    s_movk_i32 s79, 30000
L_spin_48:
    buffer_load_dword v19, off, s[4:7], s74 offset:512 sc1
    s_waitcnt vmcnt(0)
    v_readfirstlane_b32 s24, v19
    s_cmp_ge_u32 s24, 16
    s_cbranch_scc1 L_ok_27
    s_sub_u32 s79, s79, 1
    s_cbranch_scc0 L_spin_48
    s_branch L_ok_27
L_slow_35:
    s_movk_i32 s79, 30000
L_spin_49:
    buffer_load_dword v19, off, s[4:7], s74 offset:256 sc1
    s_waitcnt vmcnt(0)
    v_readfirstlane_b32 s24, v19
    s_cmp_ge_u32 s24, 16
    s_cbranch_scc1 L_ok_36
    s_sub_u32 s79, s79, 1
    s_cbranch_scc0 L_spin_49
    s_branch L_ok_36
L_slow_39:
    s_movk_i32 s79, 30000
L_spin_50:
    buffer_load_dword v19, off, s[4:7], s74 offset:768 sc1
    s_waitcnt vmcnt(0)
    v_readfirstlane_b32 s24, v19
    s_cmp_ge_u32 s24, 16
    s_cbranch_scc1 L_ok_40
    s_sub_u32 s79, s79, 1
    s_cbranch_scc0 L_spin_50
    s_branch L_ok_40
L_slow_41:
    s_movk_i32 s79, 30000
L_spin_51:
    buffer_load_dword v19, off, s[4:7], s74 offset:512 sc1
    s_waitcnt vmcnt(0)
    v_readfirstlane_b32 s24, v19
    s_cmp_ge_u32 s24, 16
    s_cbranch_scc1 L_ok_42
    s_sub_u32 s79, s79, 1
    s_cbranch_scc0 L_spin_51
    s_branch L_ok_42
L_side:
    buffer_load_dword v250, off, s[4:7], s54 sc1
    s_sub_u32 s101, s21, 20
    s_lshl_b32 s101, s101, 3
    s_add_u32 s101, s101, s22
    s_mul_i32 s53, s20, 96
    s_add_u32 s53, s53, s101
    s_cmp_lg_u32 s53, 383
    s_cbranch_scc1 L_noinit
    s_mov_b32 s25, 19927040
    v_mov_b32 v8, 0
    v_mov_b32 v9, 0
    v_mov_b32 v10, 0
    v_mov_b32 v11, 0
    v_mul_u32_u24 v2, 256, v1
    buffer_store_dword v8, v2, s[4:7], s25 offen sc1
    s_add_u32 s25, s25, 16384
    s_waitcnt vmcnt(0)
    v_add_u32 v4, 1, v250
    s_mov_b32 s26, 19923200
    s_mov_b64 exec, 1
    buffer_store_dword v4, off, s[4:7], s26 sc1
    s_mov_b64 exec, -1
    s_mov_b32 s25, 19939328
    buffer_store_dword v8, v2, s[4:7], s25 offen sc1
    s_add_u32 s25, s25, 16384
    buffer_store_dword v8, v2, s[4:7], s25 offen sc1
    s_add_u32 s25, s25, 16384
L_noinit:
    s_waitcnt vmcnt(0)
    v_readfirstlane_b32 s83, v250
    s_mov_b32 s25, 19923200
    s_add_u32 s83, s83, 1
    s_sub_u32 s25, s53, 40
    s_cmp_ge_u32 s53, 328
    s_cselect_b32 s25, s25, 344
    s_cmp_ge_u32 s53, 288
    s_cselect_b32 s53, s25, s53
    s_cmp_ge_u32 s53, 344
    s_cbranch_scc1 L_sideend_53
    s_cmp_ge_u32 s53, 216
    s_cbranch_scc1 L_q4_52
    s_and_b32 s28, s53, 3
    s_lshr_b32 s27, s53, 3
    s_bitcmp1_b32 s53, 2
    s_cselect_b32 s26, 1, 0
    s_cselect_b64 s[32:33], s[72:73], s[70:71]
    s_mov_b32 s34, 0x21c000
    s_mov_b32 s35, 0x20000
    v_lshrrev_b32 v2, 3, v1
    v_and_b32 v3, 7, v1
    s_mul_i32 s29, s28, 160
    v_add_u32 v4, s29, v2
    v_mul_u32_u24 v4, 3456, v4
    v_lshl_add_u32 v4, v3, 4, v4
    s_lshl_b32 s36, s27, 7
    buffer_load_dwordx4 v[32:35], v4, s[32:35], s36 offen
    s_add_u32 s36, s36, 27648
    buffer_load_dwordx4 v[36:39], v4, s[32:35], s36 offen
    s_add_u32 s36, s36, 27648
    buffer_load_dwordx4 v[40:43], v4, s[32:35], s36 offen
    s_add_u32 s36, s36, 27648
    buffer_load_dwordx4 v[44:47], v4, s[32:35], s36 offen
    s_add_u32 s36, s36, 27648
    buffer_load_dwordx4 v[48:51], v4, s[32:35], s36 offen
    s_add_u32 s36, s36, 27648
    buffer_load_dwordx4 v[52:55], v4, s[32:35], s36 offen
    s_add_u32 s36, s36, 27648
    buffer_load_dwordx4 v[56:59], v4, s[32:35], s36 offen
    s_add_u32 s36, s36, 27648
    buffer_load_dwordx4 v[60:63], v4, s[32:35], s36 offen
    s_add_u32 s36, s36, 27648
    buffer_load_dwordx4 v[64:67], v4, s[32:35], s36 offen
    s_add_u32 s36, s36, 27648
    buffer_load_dwordx4 v[68:71], v4, s[32:35], s36 offen
    s_add_u32 s36, s36, 27648
    buffer_load_dwordx4 v[72:75], v4, s[32:35], s36 offen
    s_add_u32 s36, s36, 27648
    buffer_load_dwordx4 v[76:79], v4, s[32:35], s36 offen
    s_add_u32 s36, s36, 27648
    s_mul_i32 s29, s20, 20992
    v_bfe_u32 v5, v2, 1, 1
    v_lshlrev_b32 v5, 2, v5
    v_xor_b32 v5, v5, v3
    v_lshlrev_b32 v5, 4, v5
    v_lshl_add_u32 v5, v2, 7, v5
    v_add_u32 v5, s29, v5
    v_bfe_u32 v6, v1, 2, 2
    v_lshrrev_b32 v7, 5, v1
    v_lshl_add_u32 v7, v7, 3, v6
    v_lshlrev_b32 v7, 7, v7
    v_bfe_u32 v8, v1, 4, 1
    v_bfe_u32 v9, v1, 1, 1
    v_lshl_add_u32 v9, v8, 1, v9
    v_lshrrev_b32 v6, 1, v6
    v_lshlrev_b32 v6, 2, v6
    v_xor_b32 v9, v9, v6
    v_lshl_add_u32 v7, v9, 4, v7
    v_and_b32 v6, 1, v1
    v_lshl_add_u32 v7, v6, 3, v7
    v_add_u32 v7, s29, v7
    v_xor_b32 v6, 64, v7
    v_and_b32 v9, 15, v1
    v_lshlrev_b32 v9, 4, v9
    v_lshl_add_u32 v10, v8, 10, v9
    v_mul_u32_u24 v8, 40960, v8
    v_add_u32 v8, v8, v9
    v_lshrrev_b32 v9, 5, v1
    v_lshl_add_u32 v8, v9, 9, v8
    s_lshl_b32 s30, s26, 8
    s_mul_i32 s31, s27, 163840
    s_add_u32 s30, s30, s31
    s_mul_i32 s31, s28, 10240
    s_add_u32 s30, s30, s31
    s_add_u32 s30, s30, 8388608
    s_add_u32 s31, s30, 81920
    v_mov_b32 v12, 0x3f803f80
    v_mov_b32 v13, 0x3f803f80
    v_mov_b32 v14, 0x3f803f80
    v_mov_b32 v15, 0x3f803f80
    s_waitcnt vmcnt(11)
    ds_write_b128 v5, v[32:35] offset:0
    buffer_load_dwordx4 v[80:83], v4, s[32:35], s36 offen
    s_add_u32 s36, s36, 27648
    s_waitcnt vmcnt(11)
    ds_write_b128 v5, v[36:39] offset:1024
    buffer_load_dwordx4 v[84:87], v4, s[32:35], s36 offen
    s_add_u32 s36, s36, 27648
    s_waitcnt lgkmcnt(0)
    ds_read_b64_tr_b16 v[16:17], v7 offset:0
    ds_read_b64_tr_b16 v[18:19], v7 offset:512
    ds_read_b64_tr_b16 v[20:21], v6 offset:0
    ds_read_b64_tr_b16 v[22:23], v6 offset:512
    s_waitcnt lgkmcnt(2)
    v_mfma_f32_32x32x16_bf16 v[112:127], v[12:15], v[16:19], 0
    buffer_store_dwordx4 v[16:19], v8, s[4:7], s30 offen sc1
    s_add_u32 s30, s30, 1024
    s_waitcnt lgkmcnt(0)
    v_mfma_f32_32x32x16_bf16 v[128:143], v[12:15], v[20:23], 0
    buffer_store_dwordx4 v[20:23], v8, s[4:7], s31 offen sc1
    s_add_u32 s31, s31, 1024
    s_waitcnt vmcnt(13)
    ds_write_b128 v5, v[40:43] offset:2048
    buffer_load_dwordx4 v[88:91], v4, s[32:35], s36 offen
    s_add_u32 s36, s36, 27648
    s_waitcnt vmcnt(13)
    ds_write_b128 v5, v[44:47] offset:3072
    buffer_load_dwordx4 v[92:95], v4, s[32:35], s36 offen
    s_add_u32 s36, s36, 27648
    s_waitcnt lgkmcnt(0)
    ds_read_b64_tr_b16 v[24:25], v7 offset:2048
    ds_read_b64_tr_b16 v[26:27], v7 offset:2560
    ds_read_b64_tr_b16 v[28:29], v6 offset:2048
    ds_read_b64_tr_b16 v[30:31], v6 offset:2560
    s_waitcnt lgkmcnt(2)
    v_mfma_f32_32x32x16_bf16 v[112:127], v[12:15], v[24:27], v[112:127]
    buffer_store_dwordx4 v[24:27], v8, s[4:7], s30 offen sc1
    s_add_u32 s30, s30, 1024
    s_waitcnt lgkmcnt(0)
    v_mfma_f32_32x32x16_bf16 v[128:143], v[12:15], v[28:31], v[128:143]
    buffer_store_dwordx4 v[28:31], v8, s[4:7], s31 offen sc1
    s_add_u32 s31, s31, 1024
    s_waitcnt vmcnt(15)
    ds_write_b128 v5, v[48:51] offset:4096
    buffer_load_dwordx4 v[96:99], v4, s[32:35], s36 offen
    s_add_u32 s36, s36, 27648
    s_waitcnt vmcnt(15)
    ds_write_b128 v5, v[52:55] offset:5120
    buffer_load_dwordx4 v[100:103], v4, s[32:35], s36 offen
    s_add_u32 s36, s36, 27648
    s_waitcnt lgkmcnt(0)
    ds_read_b64_tr_b16 v[16:17], v7 offset:4096
    ds_read_b64_tr_b16 v[18:19], v7 offset:4608
    ds_read_b64_tr_b16 v[20:21], v6 offset:4096
    ds_read_b64_tr_b16 v[22:23], v6 offset:4608
    s_waitcnt lgkmcnt(2)
    v_mfma_f32_32x32x16_bf16 v[112:127], v[12:15], v[16:19], v[112:127]
    buffer_store_dwordx4 v[16:19], v8, s[4:7], s30 offen sc1
    s_add_u32 s30, s30, 1024
    s_waitcnt lgkmcnt(0)
    v_mfma_f32_32x32x16_bf16 v[128:143], v[12:15], v[20:23], v[128:143]
    buffer_store_dwordx4 v[20:23], v8, s[4:7], s31 offen sc1
    s_add_u32 s31, s31, 1024
    s_waitcnt vmcnt(17)
    ds_write_b128 v5, v[56:59] offset:6144
    buffer_load_dwordx4 v[104:107], v4, s[32:35], s36 offen
    s_add_u32 s36, s36, 27648
    s_waitcnt vmcnt(17)
    ds_write_b128 v5, v[60:63] offset:7168
    buffer_load_dwordx4 v[108:111], v4, s[32:35], s36 offen
    s_add_u32 s36, s36, 27648
    s_waitcnt lgkmcnt(0)
    ds_read_b64_tr_b16 v[24:25], v7 offset:6144
    ds_read_b64_tr_b16 v[26:27], v7 offset:6656
    ds_read_b64_tr_b16 v[28:29], v6 offset:6144
    ds_read_b64_tr_b16 v[30:31], v6 offset:6656
    s_waitcnt lgkmcnt(2)
    v_mfma_f32_32x32x16_bf16 v[112:127], v[12:15], v[24:27], v[112:127]
    buffer_store_dwordx4 v[24:27], v8, s[4:7], s30 offen sc1
    s_add_u32 s30, s30, 1024
    s_waitcnt lgkmcnt(0)
    v_mfma_f32_32x32x16_bf16 v[128:143], v[12:15], v[28:31], v[128:143]
    buffer_store_dwordx4 v[28:31], v8, s[4:7], s31 offen sc1
    s_add_u32 s31, s31, 1024
    s_waitcnt vmcnt(19)
    ds_write_b128 v5, v[64:67] offset:8192
    s_waitcnt vmcnt(18)
    ds_write_b128 v5, v[68:71] offset:9216
    s_waitcnt lgkmcnt(0)
    ds_read_b64_tr_b16 v[16:17], v7 offset:8192
    ds_read_b64_tr_b16 v[18:19], v7 offset:8704
    ds_read_b64_tr_b16 v[20:21], v6 offset:8192
    ds_read_b64_tr_b16 v[22:23], v6 offset:8704
    s_waitcnt lgkmcnt(2)
    v_mfma_f32_32x32x16_bf16 v[112:127], v[12:15], v[16:19], v[112:127]
    buffer_store_dwordx4 v[16:19], v8, s[4:7], s30 offen sc1
    s_add_u32 s30, s30, 1024
    s_waitcnt lgkmcnt(0)
    v_mfma_f32_32x32x16_bf16 v[128:143], v[12:15], v[20:23], v[128:143]
    buffer_store_dwordx4 v[20:23], v8, s[4:7], s31 offen sc1
    s_add_u32 s31, s31, 1024
    s_waitcnt vmcnt(19)
    ds_write_b128 v5, v[72:75] offset:10240
    s_waitcnt vmcnt(18)
    ds_write_b128 v5, v[76:79] offset:11264
    s_waitcnt lgkmcnt(0)
    ds_read_b64_tr_b16 v[24:25], v7 offset:10240
    ds_read_b64_tr_b16 v[26:27], v7 offset:10752
    ds_read_b64_tr_b16 v[28:29], v6 offset:10240
    ds_read_b64_tr_b16 v[30:31], v6 offset:10752
    s_waitcnt lgkmcnt(2)
    v_mfma_f32_32x32x16_bf16 v[112:127], v[12:15], v[24:27], v[112:127]
    buffer_store_dwordx4 v[24:27], v8, s[4:7], s30 offen sc1
    s_add_u32 s30, s30, 1024
    s_waitcnt lgkmcnt(0)
    v_mfma_f32_32x32x16_bf16 v[128:143], v[12:15], v[28:31], v[128:143]
    buffer_store_dwordx4 v[28:31], v8, s[4:7], s31 offen sc1
    s_add_u32 s31, s31, 1024
    s_waitcnt vmcnt(19)
    ds_write_b128 v5, v[80:83] offset:12288
    s_waitcnt vmcnt(18)
    ds_write_b128 v5, v[84:87] offset:13312
    s_waitcnt lgkmcnt(0)
    ds_read_b64_tr_b16 v[16:17], v7 offset:12288
    ds_read_b64_tr_b16 v[18:19], v7 offset:12800
    ds_read_b64_tr_b16 v[20:21], v6 offset:12288
    ds_read_b64_tr_b16 v[22:23], v6 offset:12800
    s_waitcnt lgkmcnt(2)
    v_mfma_f32_32x32x16_bf16 v[112:127], v[12:15], v[16:19], v[112:127]
    buffer_store_dwordx4 v[16:19], v8, s[4:7], s30 offen sc1
    s_add_u32 s30, s30, 1024
    s_waitcnt lgkmcnt(0)
    v_mfma_f32_32x32x16_bf16 v[128:143], v[12:15], v[20:23], v[128:143]
    buffer_store_dwordx4 v[20:23], v8, s[4:7], s31 offen sc1
    s_add_u32 s31, s31, 1024
    s_waitcnt vmcnt(17)
    ds_write_b128 v5, v[88:91] offset:14336
    s_waitcnt vmcnt(16)
    ds_write_b128 v5, v[92:95] offset:15360
    s_waitcnt lgkmcnt(0)
    ds_read_b64_tr_b16 v[24:25], v7 offset:14336
    ds_read_b64_tr_b16 v[26:27], v7 offset:14848
    ds_read_b64_tr_b16 v[28:29], v6 offset:14336
    ds_read_b64_tr_b16 v[30:31], v6 offset:14848
    s_waitcnt lgkmcnt(2)
    v_mfma_f32_32x32x16_bf16 v[112:127], v[12:15], v[24:27], v[112:127]
    buffer_store_dwordx4 v[24:27], v8, s[4:7], s30 offen sc1
    s_add_u32 s30, s30, 1024
    s_waitcnt lgkmcnt(0)
    v_mfma_f32_32x32x16_bf16 v[128:143], v[12:15], v[28:31], v[128:143]
    buffer_store_dwordx4 v[28:31], v8, s[4:7], s31 offen sc1
    s_add_u32 s31, s31, 1024
    s_waitcnt vmcnt(15)
    ds_write_b128 v5, v[96:99] offset:16384
    s_waitcnt vmcnt(14)
    ds_write_b128 v5, v[100:103] offset:17408
    s_waitcnt lgkmcnt(0)
    ds_read_b64_tr_b16 v[16:17], v7 offset:16384
    ds_read_b64_tr_b16 v[18:19], v7 offset:16896
    ds_read_b64_tr_b16 v[20:21], v6 offset:16384
    ds_read_b64_tr_b16 v[22:23], v6 offset:16896
    s_waitcnt lgkmcnt(2)
    v_mfma_f32_32x32x16_bf16 v[112:127], v[12:15], v[16:19], v[112:127]
    buffer_store_dwordx4 v[16:19], v8, s[4:7], s30 offen sc1
    s_add_u32 s30, s30, 1024
    s_waitcnt lgkmcnt(0)
    v_mfma_f32_32x32x16_bf16 v[128:143], v[12:15], v[20:23], v[128:143]
    buffer_store_dwordx4 v[20:23], v8, s[4:7], s31 offen sc1
    s_add_u32 s31, s31, 1024
    s_waitcnt vmcnt(13)
    ds_write_b128 v5, v[104:107] offset:18432
    s_waitcnt vmcnt(12)
    ds_write_b128 v5, v[108:111] offset:19456
    s_waitcnt lgkmcnt(0)
    ds_read_b64_tr_b16 v[24:25], v7 offset:18432
    ds_read_b64_tr_b16 v[26:27], v7 offset:18944
    ds_read_b64_tr_b16 v[28:29], v6 offset:18432
    ds_read_b64_tr_b16 v[30:31], v6 offset:18944
    s_waitcnt lgkmcnt(2)
    v_mfma_f32_32x32x16_bf16 v[112:127], v[12:15], v[24:27], v[112:127]
    buffer_store_dwordx4 v[24:27], v8, s[4:7], s30 offen sc1
    s_add_u32 s30, s30, 1024
    s_waitcnt lgkmcnt(0)
    v_mfma_f32_32x32x16_bf16 v[128:143], v[12:15], v[28:31], v[128:143]
    buffer_store_dwordx4 v[28:31], v8, s[4:7], s31 offen sc1
    s_add_u32 s31, s31, 1024
    s_lshl_b32 s30, s27, 12
    s_lshl_b32 s31, s26, 8
    s_add_u32 s30, s30, s31
    s_lshr_b32 s31, s28, 1
    s_lshl_b32 s31, s31, 9
    s_add_u32 s30, s30, s31
    s_and_b32 s31, s28, 1
    s_lshl_b32 s31, s31, 3
    s_add_u32 s30, s30, s31
    s_add_u32 s30, s30, 13631488
    s_nop 3
    v_cvt_pk_bf16_f32 v17, v112, v112
    v_lshlrev_b32 v18, 16, v17
    v_sub_f32 v16, v112, v18
    v_cvt_pk_bf16_f32 v18, v16, v16
    v_lshlrev_b32 v19, 16, v18
    v_sub_f32 v16, v16, v19
    v_cvt_pk_bf16_f32 v16, v16, v16
    v_and_b32 v17, 0xffff, v17
    v_or_b32 v20, v17, v19
    v_and_b32 v21, 0xffff, v16
    s_mov_b64 exec, 0xffffffff
    buffer_store_dwordx2 v[20:21], v10, s[4:7], s30 offen offset:0 sc1
    s_mov_b64 exec, -1
    v_cvt_pk_bf16_f32 v17, v128, v128
    v_lshlrev_b32 v18, 16, v17
    v_sub_f32 v16, v128, v18
    v_cvt_pk_bf16_f32 v18, v16, v16
    v_lshlrev_b32 v19, 16, v18
    v_sub_f32 v16, v16, v19
    v_cvt_pk_bf16_f32 v16, v16, v16
    v_and_b32 v17, 0xffff, v17
    v_or_b32 v22, v17, v19
    v_and_b32 v23, 0xffff, v16
    s_mov_b64 exec, 0xffffffff
    buffer_store_dwordx2 v[22:23], v10, s[4:7], s30 offen offset:2048 sc1
    s_mov_b64 exec, -1
    s_branch L_sideend_53
L_q4_52:
    s_sub_u32 s53, s53, 216
    s_lshl_b32 s53, s53, 2
    s_lshl_b32 s55, s53, 2
    v_lshrrev_b32 v2, 4, v1
    v_add_u32 v2, s55, v2
    v_and_b32 v3, 15, v1
    v_mul_u32_u24 v4, 1280, v2
    v_lshl_add_u32 v4, v3, 4, v4
    v_lshlrev_b32 v52, 3, v2
    v_add_u32 v52, 17825792, v52
    buffer_load_dwordx4 v[32:35], v4, s[16:19], 0 offen offset:0
    buffer_load_dwordx4 v[36:39], v4, s[16:19], 0 offen offset:256
    buffer_load_dwordx4 v[40:43], v4, s[16:19], 0 offen offset:512
    buffer_load_dwordx4 v[44:47], v4, s[16:19], 0 offen offset:768
    buffer_load_dwordx4 v[48:51], v4, s[16:19], 0 offen offset:1024
    s_add_u32 s53, s53, 1
    s_lshl_b32 s55, s53, 2
    v_lshrrev_b32 v2, 4, v1
    v_add_u32 v2, s55, v2
    v_and_b32 v3, 15, v1
    v_mul_u32_u24 v4, 1280, v2
    v_lshl_add_u32 v4, v3, 4, v4
    v_lshlrev_b32 v76, 3, v2
    v_add_u32 v76, 17825792, v76
    buffer_load_dwordx4 v[56:59], v4, s[16:19], 0 offen offset:0
    buffer_load_dwordx4 v[60:63], v4, s[16:19], 0 offen offset:256
    buffer_load_dwordx4 v[64:67], v4, s[16:19], 0 offen offset:512
    buffer_load_dwordx4 v[68:71], v4, s[16:19], 0 offen offset:768
    buffer_load_dwordx4 v[72:75], v4, s[16:19], 0 offen offset:1024
    s_add_u32 s53, s53, 1
    s_lshl_b32 s55, s53, 2
    v_lshrrev_b32 v2, 4, v1
    v_add_u32 v2, s55, v2
    v_and_b32 v3, 15, v1
    v_mul_u32_u24 v4, 1280, v2
    v_lshl_add_u32 v4, v3, 4, v4
    v_lshlrev_b32 v100, 3, v2
    v_add_u32 v100, 17825792, v100
    buffer_load_dwordx4 v[80:83], v4, s[16:19], 0 offen offset:0
    buffer_load_dwordx4 v[84:87], v4, s[16:19], 0 offen offset:256
    buffer_load_dwordx4 v[88:91], v4, s[16:19], 0 offen offset:512
    buffer_load_dwordx4 v[92:95], v4, s[16:19], 0 offen offset:768
    buffer_load_dwordx4 v[96:99], v4, s[16:19], 0 offen offset:1024
    s_add_u32 s53, s53, 1
    s_lshl_b32 s55, s53, 2
    v_lshrrev_b32 v2, 4, v1
    v_add_u32 v2, s55, v2
    v_and_b32 v3, 15, v1
    v_mul_u32_u24 v4, 1280, v2
    v_lshl_add_u32 v4, v3, 4, v4
    v_lshlrev_b32 v124, 3, v2
    v_add_u32 v124, 17825792, v124
    buffer_load_dwordx4 v[104:107], v4, s[16:19], 0 offen offset:0
    buffer_load_dwordx4 v[108:111], v4, s[16:19], 0 offen offset:256
    buffer_load_dwordx4 v[112:115], v4, s[16:19], 0 offen offset:512
    buffer_load_dwordx4 v[116:119], v4, s[16:19], 0 offen offset:768
    buffer_load_dwordx4 v[120:123], v4, s[16:19], 0 offen offset:1024
    s_add_u32 s53, s53, 1
    v_mov_b32 v54, 0
    v_mov_b32 v55, 0
    v_mov_b32 v53, 0x3f803f80
    s_waitcnt vmcnt(19)
    v_dot2_f32_bf16 v54, v32, v53, v54
    v_dot2_f32_bf16 v55, v32, v32, v55
    v_dot2_f32_bf16 v54, v33, v53, v54
    v_dot2_f32_bf16 v55, v33, v33, v55
    v_dot2_f32_bf16 v54, v34, v53, v54
    v_dot2_f32_bf16 v55, v34, v34, v55
    v_dot2_f32_bf16 v54, v35, v53, v54
    v_dot2_f32_bf16 v55, v35, v35, v55
    s_waitcnt vmcnt(18)
    v_dot2_f32_bf16 v54, v36, v53, v54
    v_dot2_f32_bf16 v55, v36, v36, v55
    v_dot2_f32_bf16 v54, v37, v53, v54
    v_dot2_f32_bf16 v55, v37, v37, v55
    v_dot2_f32_bf16 v54, v38, v53, v54
    v_dot2_f32_bf16 v55, v38, v38, v55
    v_dot2_f32_bf16 v54, v39, v53, v54
    v_dot2_f32_bf16 v55, v39, v39, v55
    s_waitcnt vmcnt(17)
    v_dot2_f32_bf16 v54, v40, v53, v54
    v_dot2_f32_bf16 v55, v40, v40, v55
    v_dot2_f32_bf16 v54, v41, v53, v54
    v_dot2_f32_bf16 v55, v41, v41, v55
    v_dot2_f32_bf16 v54, v42, v53, v54
    v_dot2_f32_bf16 v55, v42, v42, v55
    v_dot2_f32_bf16 v54, v43, v53, v54
    v_dot2_f32_bf16 v55, v43, v43, v55
    s_waitcnt vmcnt(16)
    v_dot2_f32_bf16 v54, v44, v53, v54
    v_dot2_f32_bf16 v55, v44, v44, v55
    v_dot2_f32_bf16 v54, v45, v53, v54
    v_dot2_f32_bf16 v55, v45, v45, v55
    v_dot2_f32_bf16 v54, v46, v53, v54
    v_dot2_f32_bf16 v55, v46, v46, v55
    v_dot2_f32_bf16 v54, v47, v53, v54
    v_dot2_f32_bf16 v55, v47, v47, v55
    s_waitcnt vmcnt(15)
    v_dot2_f32_bf16 v54, v48, v53, v54
    v_dot2_f32_bf16 v55, v48, v48, v55
    v_dot2_f32_bf16 v54, v49, v53, v54
    v_dot2_f32_bf16 v55, v49, v49, v55
    v_dot2_f32_bf16 v54, v50, v53, v54
    v_dot2_f32_bf16 v55, v50, v50, v55
    v_dot2_f32_bf16 v54, v51, v53, v54
    v_dot2_f32_bf16 v55, v51, v51, v55
    s_nop 2
    v_add_f32_dpp v54, v54, v54 row_ror:8 row_mask:0xf bank_mask:0xf
    v_add_f32_dpp v55, v55, v55 row_ror:8 row_mask:0xf bank_mask:0xf
    s_nop 0
    v_add_f32_dpp v54, v54, v54 row_ror:4 row_mask:0xf bank_mask:0xf
    v_add_f32_dpp v55, v55, v55 row_ror:4 row_mask:0xf bank_mask:0xf
    s_nop 0
    v_add_f32_dpp v54, v54, v54 row_ror:2 row_mask:0xf bank_mask:0xf
    v_add_f32_dpp v55, v55, v55 row_ror:2 row_mask:0xf bank_mask:0xf
    s_nop 0
    v_add_f32_dpp v54, v54, v54 row_ror:1 row_mask:0xf bank_mask:0xf
    v_add_f32_dpp v55, v55, v55 row_ror:1 row_mask:0xf bank_mask:0xf
    s_nop 0
    v_mul_f32 v54, s76, v54
    v_mul_f32 v32, v54, v54
    v_fma_f32 v55, v55, s76, -v32
    v_max_f32 v55, 0, v55
    v_cvt_pk_bf16_f32 v54, v54, v54
    v_lshlrev_b32 v54, 16, v54
    v_cvt_pk_bf16_f32 v55, v55, v55
    v_lshlrev_b32 v55, 16, v55
    v_add_f32 v55, 0x3727c5ac, v55
    v_cvt_pk_bf16_f32 v55, v55, v55
    v_lshlrev_b32 v55, 16, v55
    v_sqrt_f32 v55, v55
    s_nop 0
    v_cvt_pk_bf16_f32 v55, v55, v55
    v_lshlrev_b32 v55, 16, v55
    v_rcp_f32 v55, v55
    s_mov_b32 exec_lo, 0x00010001
    s_mov_b32 exec_hi, 0x00010001
    buffer_store_dwordx2 v[54:55], v52, s[4:7], 0 offen sc1
    s_mov_b64 exec, -1
    v_mov_b32 v78, 0
    v_mov_b32 v79, 0
    v_mov_b32 v77, 0x3f803f80
    s_waitcnt vmcnt(15)
    v_dot2_f32_bf16 v78, v56, v77, v78
    v_dot2_f32_bf16 v79, v56, v56, v79
    v_dot2_f32_bf16 v78, v57, v77, v78
    v_dot2_f32_bf16 v79, v57, v57, v79
    v_dot2_f32_bf16 v78, v58, v77, v78
    v_dot2_f32_bf16 v79, v58, v58, v79
    v_dot2_f32_bf16 v78, v59, v77, v78
    v_dot2_f32_bf16 v79, v59, v59, v79
    s_waitcnt vmcnt(14)
    v_dot2_f32_bf16 v78, v60, v77, v78
    v_dot2_f32_bf16 v79, v60, v60, v79
    v_dot2_f32_bf16 v78, v61, v77, v78
    v_dot2_f32_bf16 v79, v61, v61, v79
    v_dot2_f32_bf16 v78, v62, v77, v78
    v_dot2_f32_bf16 v79, v62, v62, v79
    v_dot2_f32_bf16 v78, v63, v77, v78
    v_dot2_f32_bf16 v79, v63, v63, v79
    s_waitcnt vmcnt(13)
    v_dot2_f32_bf16 v78, v64, v77, v78
    v_dot2_f32_bf16 v79, v64, v64, v79
    v_dot2_f32_bf16 v78, v65, v77, v78
    v_dot2_f32_bf16 v79, v65, v65, v79
    v_dot2_f32_bf16 v78, v66, v77, v78
    v_dot2_f32_bf16 v79, v66, v66, v79
    v_dot2_f32_bf16 v78, v67, v77, v78
    v_dot2_f32_bf16 v79, v67, v67, v79
    s_waitcnt vmcnt(12)
    v_dot2_f32_bf16 v78, v68, v77, v78
    v_dot2_f32_bf16 v79, v68, v68, v79
    v_dot2_f32_bf16 v78, v69, v77, v78
    v_dot2_f32_bf16 v79, v69, v69, v79
    v_dot2_f32_bf16 v78, v70, v77, v78
    v_dot2_f32_bf16 v79, v70, v70, v79
    v_dot2_f32_bf16 v78, v71, v77, v78
    v_dot2_f32_bf16 v79, v71, v71, v79
    s_waitcnt vmcnt(11)
    v_dot2_f32_bf16 v78, v72, v77, v78
    v_dot2_f32_bf16 v79, v72, v72, v79
    v_dot2_f32_bf16 v78, v73, v77, v78
    v_dot2_f32_bf16 v79, v73, v73, v79
    v_dot2_f32_bf16 v78, v74, v77, v78
    v_dot2_f32_bf16 v79, v74, v74, v79
    v_dot2_f32_bf16 v78, v75, v77, v78
    v_dot2_f32_bf16 v79, v75, v75, v79
    s_nop 2
    v_add_f32_dpp v78, v78, v78 row_ror:8 row_mask:0xf bank_mask:0xf
    v_add_f32_dpp v79, v79, v79 row_ror:8 row_mask:0xf bank_mask:0xf
    s_nop 0
    v_add_f32_dpp v78, v78, v78 row_ror:4 row_mask:0xf bank_mask:0xf
    v_add_f32_dpp v79, v79, v79 row_ror:4 row_mask:0xf bank_mask:0xf
    s_nop 0
    v_add_f32_dpp v78, v78, v78 row_ror:2 row_mask:0xf bank_mask:0xf
    v_add_f32_dpp v79, v79, v79 row_ror:2 row_mask:0xf bank_mask:0xf
    s_nop 0
    v_add_f32_dpp v78, v78, v78 row_ror:1 row_mask:0xf bank_mask:0xf
    v_add_f32_dpp v79, v79, v79 row_ror:1 row_mask:0xf bank_mask:0xf
    s_nop 0
    v_mul_f32 v78, s76, v78
    v_mul_f32 v56, v78, v78
    v_fma_f32 v79, v79, s76, -v56
    v_max_f32 v79, 0, v79
    v_cvt_pk_bf16_f32 v78, v78, v78
    v_lshlrev_b32 v78, 16, v78
    v_cvt_pk_bf16_f32 v79, v79, v79
    v_lshlrev_b32 v79, 16, v79
    v_add_f32 v79, 0x3727c5ac, v79
    v_cvt_pk_bf16_f32 v79, v79, v79
    v_lshlrev_b32 v79, 16, v79
    v_sqrt_f32 v79, v79
    s_nop 0
    v_cvt_pk_bf16_f32 v79, v79, v79
    v_lshlrev_b32 v79, 16, v79
    v_rcp_f32 v79, v79
    s_mov_b32 exec_lo, 0x00010001
    s_mov_b32 exec_hi, 0x00010001
    buffer_store_dwordx2 v[78:79], v76, s[4:7], 0 offen sc1
    s_mov_b64 exec, -1
    v_mov_b32 v102, 0
    v_mov_b32 v103, 0
    v_mov_b32 v101, 0x3f803f80
    s_waitcnt vmcnt(11)
    v_dot2_f32_bf16 v102, v80, v101, v102
    v_dot2_f32_bf16 v103, v80, v80, v103
    v_dot2_f32_bf16 v102, v81, v101, v102
    v_dot2_f32_bf16 v103, v81, v81, v103
    v_dot2_f32_bf16 v102, v82, v101, v102
    v_dot2_f32_bf16 v103, v82, v82, v103
    v_dot2_f32_bf16 v102, v83, v101, v102
    v_dot2_f32_bf16 v103, v83, v83, v103
    s_waitcnt vmcnt(10)
    v_dot2_f32_bf16 v102, v84, v101, v102
    v_dot2_f32_bf16 v103, v84, v84, v103
    v_dot2_f32_bf16 v102, v85, v101, v102
    v_dot2_f32_bf16 v103, v85, v85, v103
    v_dot2_f32_bf16 v102, v86, v101, v102
    v_dot2_f32_bf16 v103, v86, v86, v103
    v_dot2_f32_bf16 v102, v87, v101, v102
    v_dot2_f32_bf16 v103, v87, v87, v103
    s_waitcnt vmcnt(9)
    v_dot2_f32_bf16 v102, v88, v101, v102
    v_dot2_f32_bf16 v103, v88, v88, v103
    v_dot2_f32_bf16 v102, v89, v101, v102
    v_dot2_f32_bf16 v103, v89, v89, v103
    v_dot2_f32_bf16 v102, v90, v101, v102
    v_dot2_f32_bf16 v103, v90, v90, v103
    v_dot2_f32_bf16 v102, v91, v101, v102
    v_dot2_f32_bf16 v103, v91, v91, v103
    s_waitcnt vmcnt(8)
    v_dot2_f32_bf16 v102, v92, v101, v102
    v_dot2_f32_bf16 v103, v92, v92, v103
    v_dot2_f32_bf16 v102, v93, v101, v102
    v_dot2_f32_bf16 v103, v93, v93, v103
    v_dot2_f32_bf16 v102, v94, v101, v102
    v_dot2_f32_bf16 v103, v94, v94, v103
    v_dot2_f32_bf16 v102, v95, v101, v102
    v_dot2_f32_bf16 v103, v95, v95, v103
    s_waitcnt vmcnt(7)
    v_dot2_f32_bf16 v102, v96, v101, v102
    v_dot2_f32_bf16 v103, v96, v96, v103
    v_dot2_f32_bf16 v102, v97, v101, v102
    v_dot2_f32_bf16 v103, v97, v97, v103
    v_dot2_f32_bf16 v102, v98, v101, v102
    v_dot2_f32_bf16 v103, v98, v98, v103
    v_dot2_f32_bf16 v102, v99, v101, v102
    v_dot2_f32_bf16 v103, v99, v99, v103
    s_nop 2
    v_add_f32_dpp v102, v102, v102 row_ror:8 row_mask:0xf bank_mask:0xf
    v_add_f32_dpp v103, v103, v103 row_ror:8 row_mask:0xf bank_mask:0xf
    s_nop 0
    v_add_f32_dpp v102, v102, v102 row_ror:4 row_mask:0xf bank_mask:0xf
    v_add_f32_dpp v103, v103, v103 row_ror:4 row_mask:0xf bank_mask:0xf
    s_nop 0
    v_add_f32_dpp v102, v102, v102 row_ror:2 row_mask:0xf bank_mask:0xf
    v_add_f32_dpp v103, v103, v103 row_ror:2 row_mask:0xf bank_mask:0xf
    s_nop 0
    v_add_f32_dpp v102, v102, v102 row_ror:1 row_mask:0xf bank_mask:0xf
    v_add_f32_dpp v103, v103, v103 row_ror:1 row_mask:0xf bank_mask:0xf
    s_nop 0
    v_mul_f32 v102, s76, v102
    v_mul_f32 v80, v102, v102
    v_fma_f32 v103, v103, s76, -v80
    v_max_f32 v103, 0, v103
    v_cvt_pk_bf16_f32 v102, v102, v102
    v_lshlrev_b32 v102, 16, v102
    v_cvt_pk_bf16_f32 v103, v103, v103
    v_lshlrev_b32 v103, 16, v103
    v_add_f32 v103, 0x3727c5ac, v103
    v_cvt_pk_bf16_f32 v103, v103, v103
    v_lshlrev_b32 v103, 16, v103
    v_sqrt_f32 v103, v103
    s_nop 0
    v_cvt_pk_bf16_f32 v103, v103, v103
    v_lshlrev_b32 v103, 16, v103
    v_rcp_f32 v103, v103
    s_mov_b32 exec_lo, 0x00010001
    s_mov_b32 exec_hi, 0x00010001
    buffer_store_dwordx2 v[102:103], v100, s[4:7], 0 offen sc1
    s_mov_b64 exec, -1
    v_mov_b32 v126, 0
    v_mov_b32 v127, 0
    v_mov_b32 v125, 0x3f803f80
    s_waitcnt vmcnt(7)
    v_dot2_f32_bf16 v126, v104, v125, v126
    v_dot2_f32_bf16 v127, v104, v104, v127
    v_dot2_f32_bf16 v126, v105, v125, v126
    v_dot2_f32_bf16 v127, v105, v105, v127
    v_dot2_f32_bf16 v126, v106, v125, v126
    v_dot2_f32_bf16 v127, v106, v106, v127
    v_dot2_f32_bf16 v126, v107, v125, v126
    v_dot2_f32_bf16 v127, v107, v107, v127
    s_waitcnt vmcnt(6)
    v_dot2_f32_bf16 v126, v108, v125, v126
    v_dot2_f32_bf16 v127, v108, v108, v127
    v_dot2_f32_bf16 v126, v109, v125, v126
    v_dot2_f32_bf16 v127, v109, v109, v127
    v_dot2_f32_bf16 v126, v110, v125, v126
    v_dot2_f32_bf16 v127, v110, v110, v127
    v_dot2_f32_bf16 v126, v111, v125, v126
    v_dot2_f32_bf16 v127, v111, v111, v127
    s_waitcnt vmcnt(5)
    v_dot2_f32_bf16 v126, v112, v125, v126
    v_dot2_f32_bf16 v127, v112, v112, v127
    v_dot2_f32_bf16 v126, v113, v125, v126
    v_dot2_f32_bf16 v127, v113, v113, v127
    v_dot2_f32_bf16 v126, v114, v125, v126
    v_dot2_f32_bf16 v127, v114, v114, v127
    v_dot2_f32_bf16 v126, v115, v125, v126
    v_dot2_f32_bf16 v127, v115, v115, v127
    s_waitcnt vmcnt(4)
    v_dot2_f32_bf16 v126, v116, v125, v126
    v_dot2_f32_bf16 v127, v116, v116, v127
    v_dot2_f32_bf16 v126, v117, v125, v126
    v_dot2_f32_bf16 v127, v117, v117, v127
    v_dot2_f32_bf16 v126, v118, v125, v126
    v_dot2_f32_bf16 v127, v118, v118, v127
    v_dot2_f32_bf16 v126, v119, v125, v126
    v_dot2_f32_bf16 v127, v119, v119, v127
    s_waitcnt vmcnt(3)
    v_dot2_f32_bf16 v126, v120, v125, v126
    v_dot2_f32_bf16 v127, v120, v120, v127
    v_dot2_f32_bf16 v126, v121, v125, v126
    v_dot2_f32_bf16 v127, v121, v121, v127
    v_dot2_f32_bf16 v126, v122, v125, v126
    v_dot2_f32_bf16 v127, v122, v122, v127
    v_dot2_f32_bf16 v126, v123, v125, v126
    v_dot2_f32_bf16 v127, v123, v123, v127
    s_nop 2
    v_add_f32_dpp v126, v126, v126 row_ror:8 row_mask:0xf bank_mask:0xf
    v_add_f32_dpp v127, v127, v127 row_ror:8 row_mask:0xf bank_mask:0xf
    s_nop 0
    v_add_f32_dpp v126, v126, v126 row_ror:4 row_mask:0xf bank_mask:0xf
    v_add_f32_dpp v127, v127, v127 row_ror:4 row_mask:0xf bank_mask:0xf
    s_nop 0
    v_add_f32_dpp v126, v126, v126 row_ror:2 row_mask:0xf bank_mask:0xf
    v_add_f32_dpp v127, v127, v127 row_ror:2 row_mask:0xf bank_mask:0xf
    s_nop 0
    v_add_f32_dpp v126, v126, v126 row_ror:1 row_mask:0xf bank_mask:0xf
    v_add_f32_dpp v127, v127, v127 row_ror:1 row_mask:0xf bank_mask:0xf
    s_nop 0
    v_mul_f32 v126, s76, v126
    v_mul_f32 v104, v126, v126
    v_fma_f32 v127, v127, s76, -v104
    v_max_f32 v127, 0, v127
    v_cvt_pk_bf16_f32 v126, v126, v126
    v_lshlrev_b32 v126, 16, v126
    v_cvt_pk_bf16_f32 v127, v127, v127
    v_lshlrev_b32 v127, 16, v127
    v_add_f32 v127, 0x3727c5ac, v127
    v_cvt_pk_bf16_f32 v127, v127, v127
    v_lshlrev_b32 v127, 16, v127
    v_sqrt_f32 v127, v127
    s_nop 0
    v_cvt_pk_bf16_f32 v127, v127, v127
    v_lshlrev_b32 v127, 16, v127
    v_rcp_f32 v127, v127
    s_mov_b32 exec_lo, 0x00010001
    s_mov_b32 exec_hi, 0x00010001
    buffer_store_dwordx2 v[126:127], v124, s[4:7], 0 offen sc1
    s_mov_b64 exec, -1
L_sideend_53:
    s_waitcnt vmcnt(0)
    s_barrier
    s_cmp_lg_u32 s20, 0
    s_cbranch_scc1 L_initok_55
    s_mov_b32 s25, 19923200
    s_movk_i32 s79, 30000
L_spin_56:
    buffer_load_dword v62, off, s[4:7], s25 offset:0 sc1
    s_waitcnt vmcnt(0)
    v_readfirstlane_b32 s24, v62
    s_cmp_eq_u32 s24, s83
    s_cbranch_scc1 L_initok_55
    s_sub_u32 s79, s79, 1
    s_cbranch_scc0 L_spin_56
    s_branch L_initok_55
L_initok_55:
    v_mov_b32 v18, 1
    v_mul_u32_u24 v6, 256, v1
    s_mov_b32 s25, 19935232
    s_cmp_lg_u32 s20, 0
    s_cbranch_scc1 L_sig_57
    s_mov_b64 exec, 255
    buffer_atomic_add v18, v6, s[4:7], s25 offen offset:0 sc1
    s_mov_b64 exec, -1
L_sig_57:
    s_load_dwordx2 s[32:33], s[0:1], 72
    s_mov_b32 s34, 0x21c000
    s_mov_b32 s35, 0x20000
    s_mul_i32 s29, s20, 5632
    s_add_u32 s29, s29, 131072
    s_movk_i32 s30, 1280
    s_movk_i32 s31, 352
    v_add_u32 v115, 0, v1
    v_mul_u32_u24 v116, 3277, v115
    v_lshrrev_b32 v116, 16, v116
    v_mul_u32_u24 v117, 20, v116
    v_sub_u32 v115, v115, v117
    v_lshlrev_b32 v115, 4, v115
    v_mad_u32_u24 v102, v116, s30, v115
    v_mad_u32_u24 v107, v116, s31, v115
    v_add_u32 v107, s29, v107
    v_add_u32 v115, 64, v1
    v_mul_u32_u24 v116, 3277, v115
    v_lshrrev_b32 v116, 16, v116
    v_mul_u32_u24 v117, 20, v116
    v_sub_u32 v115, v115, v117
    v_lshlrev_b32 v115, 4, v115
    v_mad_u32_u24 v103, v116, s30, v115
    v_mad_u32_u24 v108, v116, s31, v115
    v_add_u32 v108, s29, v108
    v_add_u32 v115, 128, v1
    v_mul_u32_u24 v116, 3277, v115
    v_lshrrev_b32 v116, 16, v116
    v_mul_u32_u24 v117, 20, v116
    v_sub_u32 v115, v115, v117
    v_lshlrev_b32 v115, 4, v115
    v_mad_u32_u24 v104, v116, s30, v115
    v_mad_u32_u24 v109, v116, s31, v115
    v_add_u32 v109, s29, v109
    v_add_u32 v115, 192, v1
    v_mul_u32_u24 v116, 3277, v115
    v_lshrrev_b32 v116, 16, v116
    v_mul_u32_u24 v117, 20, v116
    v_sub_u32 v115, v115, v117
    v_lshlrev_b32 v115, 4, v115
    v_mad_u32_u24 v105, v116, s30, v115
    v_mad_u32_u24 v110, v116, s31, v115
    v_add_u32 v110, s29, v110
    v_add_u32 v115, 256, v1
    v_mul_u32_u24 v116, 3277, v115
    v_lshrrev_b32 v116, 16, v116
    v_mul_u32_u24 v117, 20, v116
    v_sub_u32 v115, v115, v117
    v_lshlrev_b32 v115, 4, v115
    v_mad_u32_u24 v106, v116, s30, v115
    v_mad_u32_u24 v111, v116, s31, v115
    v_add_u32 v111, s29, v111
    v_bfe_u32 v115, v1, 2, 2
    v_bfe_u32 v116, v1, 4, 1
    v_lshl_add_u32 v115, v116, 2, v115
    v_mul_u32_u24 v115, 352, v115
    v_lshrrev_b32 v117, 5, v1
    v_lshl_add_u32 v115, v117, 5, v115
    v_and_b32 v112, 3, v1
    v_lshl_add_u32 v115, v112, 3, v115
    v_add_u32 v112, s29, v115
    v_and_b32 v115, 15, v1
    v_lshlrev_b32 v115, 4, v115
    v_lshl_add_u32 v115, v116, 8, v115
    v_lshl_add_u32 v113, v117, 10, v115
    v_mul_u32_u24 v117, 272384, v117
    v_add_u32 v114, v117, v115
    s_sub_u32 s80, s101, 4
    s_cmp_lt_u32 s101, 24
    s_cselect_b32 s80, 4096, s80
    s_cmp_lt_u32 s101, 20
    s_cselect_b32 s80, s101, s80
    s_sub_u32 s25, s101, 24
    s_add_u32 s81, s25, 92
    s_cmp_lt_u32 s25, 16
    s_cselect_b32 s81, s81, 4096
    s_waitcnt lgkmcnt(0)
    s_mul_i32 s36, s80, 20480
    s_mul_i32 s37, s20, 320
    s_add_u32 s36, s36, s37
    buffer_load_dwordx4 v[120:123], v102, s[32:35], s36 offen
    buffer_load_dwordx4 v[124:127], v103, s[32:35], s36 offen
    buffer_load_dwordx4 v[128:131], v104, s[32:35], s36 offen
    buffer_load_dwordx4 v[132:135], v105, s[32:35], s36 offen
    buffer_load_dwordx4 v[136:139], v106, s[32:35], s36 offen
    s_mul_i32 s36, s81, 20480
    s_mul_i32 s37, s20, 320
    s_add_u32 s36, s36, s37
    buffer_load_dwordx4 v[140:143], v102, s[32:35], s36 offen
    buffer_load_dwordx4 v[144:147], v103, s[32:35], s36 offen
    buffer_load_dwordx4 v[148:151], v104, s[32:35], s36 offen
    buffer_load_dwordx4 v[152:155], v105, s[32:35], s36 offen
    buffer_load_dwordx4 v[156:159], v106, s[32:35], s36 offen
    s_lshr_b32 s24, s2, 3
    s_and_b32 s22, s2, 1
    s_bfe_u32 s21, s2, 0x20001
    s_lshl_b32 s21, s21, 2
    s_lshr_b32 s25, s24, 3
    s_add_u32 s21, s21, s25
    s_and_b32 s23, s24, 7
    s_lshl_b32 s25, s25, 1
    s_add_u32 s25, s25, s23
    v_lshlrev_b32 v2, 4, v1
    v_lshlrev_b32 v3, 4, v0
    v_and_b32 v60, 15, v1
    v_lshrrev_b32 v61, 4, v1
    s_lshl_b32 s26, s21, 7
    s_lshl_b32 s27, s22, 6
    s_add_u32 s27, s27, s26
    s_lshl_b32 s28, s20, 4
    s_add_u32 s27, s27, s28
    v_add_u32 v62, s27, v60
    v_mul_u32_u24 v17, 1280, v62
    s_mul_i32 s28, s23, 160
    v_lshl_add_u32 v63, v61, 3, s28
    v_add_u32 v17, v17, v63
    s_lshl_b32 s71, s27, 3
    s_add_u32 s71, s71, 17825792
    s_mul_i32 s28, s23, 337920
    s_lshl_b32 s29, s27, 1
    s_add_u32 s28, s28, s29
    s_add_u32 s82, s28, 4194304
    s_lshl_b32 s28, s22, 3
    s_add_u32 s28, s28, s23
    s_mul_i32 s30, s28, 5
    s_lshl_b32 s31, s28, 2
    s_add_u32 s31, s31, 12
    s_min_u32 s30, s30, s31
    s_add_u32 s30, s30, 32
    s_lshl_b32 s77, s28, 11
    s_add_u32 s77, s77, 13631488
    s_lshl_b32 s78, s30, 10
    s_add_u32 s78, s78, 13631488
    s_mul_i32 s42, s28, 81920
    s_add_u32 s42, s42, 8388608
    s_mul_i32 s44, s30, 40960
    s_add_u32 s44, s44, 8388608
    s_lshl_b32 s75, s20, 10
    s_add_u32 s75, s75, 90112
    s_sub_u32 s30, s25, 10
    s_cselect_b32 s30, s25, s30
    s_lshl_b32 s32, s30, 12
    s_add_u32 s33, s32, 4096
    s_cmp_eq_u32 s33, 40960
    s_cselect_b32 s33, 0, s33
    s_add_u32 s34, s33, 4096
    s_cmp_eq_u32 s34, 40960
    s_cselect_b32 s34, 0, s34
    s_add_u32 s35, s34, 4096
    s_cmp_eq_u32 s35, 40960
    s_cselect_b32 s35, 0, s35
    s_add_u32 s36, s35, 4096
    s_cmp_eq_u32 s36, 40960
    s_cselect_b32 s36, 0, s36
    s_add_u32 s37, s36, 4096
    s_cmp_eq_u32 s37, 40960
    s_cselect_b32 s37, 0, s37
    s_add_u32 s38, s37, 4096
    s_cmp_eq_u32 s38, 40960
    s_cselect_b32 s38, 0, s38
    s_add_u32 s39, s38, 4096
    s_cmp_eq_u32 s39, 40960
    s_cselect_b32 s39, 0, s39
    s_add_u32 s40, s39, 4096
    s_cmp_eq_u32 s40, 40960
    s_cselect_b32 s40, 0, s40
    s_add_u32 s41, s40, 4096
    s_cmp_eq_u32 s41, 40960
    s_cselect_b32 s41, 0, s41
    v_add_u32 v4, 65536, v2
    v_add_u32 v5, 131072, v2
    s_lshl_b32 s28, s27, 6
    v_lshl_add_u32 v15, v60, 3, s28
    s_lshl_b32 s28, s23, 7
    v_add_u32 v14, s28, v15
    v_lshl_add_u32 v15, v61, 8, v15
    v_add_u32 v15, 18874368, v15
    v_lshrrev_b32 v63, 1, v61
    v_lshlrev_b32 v63, 5, v63
    v_add_u32 v63, v63, v60
    s_and_b32 s28, s20, 1
    s_lshl_b32 s28, s28, 4
    v_add_u32 v63, s28, v63
    v_lshlrev_b32 v63, 4, v63
    v_and_b32 v66, 1, v61
    v_lshl_add_u32 v13, v66, 10, v63
    s_lshr_b32 s28, s27, 5
    s_mul_i32 s28, s28, 40
    s_mul_i32 s29, s23, 5
    s_add_u32 s28, s28, s29
    s_lshl_b32 s72, s28, 10
    s_lshl_b32 s28, s21, 2
    s_add_u32 s28, s28, s20
    s_mul_i32 s73, s28, 40960
    s_lshl_b32 s70, s28, 11
    s_add_u32 s70, s70, 3145728
    v_lshrrev_b32 v66, 5, v1
    v_bfe_u32 v63, v1, 4, 1
    v_lshlrev_b32 v63, 10, v63
    v_lshl_add_u32 v63, v66, 8, v63
    v_lshl_add_u32 v7, v60, 4, v63
    s_mul_i32 s74, s21, 2048
    s_add_u32 s74, s74, 19939328
    s_and_b32 s3, s2, 7
    s_mul_i32 s3, s3, 256
    s_add_u32 s3, s3, 19935232
    s_mov_b32 s76, 0x3acccccd
    s_lshl_b32 s29, s21, 1
    s_add_u32 s29, s29, s22
    s_mul_i32 s29, s29, 276480
    s_add_u32 s29, s29, 4194304
    s_mul_i32 s28, s23, 276480
    s_add_u32 s28, s28, 14680064
    v_add_u32 v16, s28, v2
    v_add_u32 v12, 4096, v16
    v_add_u32 v47, s73, v2
    s_add_u32 s28, s20, 0
    s_and_b32 s28, s28, 3
    s_lshl_b32 s28, s28, 10
    s_add_u32 s28, s28, s29
    v_add_u32 v8, s28, v2
    s_add_u32 s28, s20, 1
    s_and_b32 s28, s28, 3
    s_lshl_b32 s28, s28, 10
    s_add_u32 s28, s28, s29
    v_add_u32 v9, s28, v2
    s_add_u32 s28, s20, 2
    s_and_b32 s28, s28, 3
    s_lshl_b32 s28, s28, 10
    s_add_u32 s28, s28, s29
    v_add_u32 v10, s28, v2
    s_add_u32 s28, s20, 3
    s_and_b32 s28, s28, 3
    s_lshl_b32 s28, s28, 10
    s_add_u32 s28, s28, s29
    v_add_u32 v11, s28, v2
    s_lshl_b32 s28, s22, 3
    s_add_u32 s28, s28, s23
    s_lshl_b32 s30, s28, 1
    s_add_u32 s31, s28, 12
    s_min_u32 s30, s30, s31
    s_lshl_b32 s31, s21, 1
    s_lshr_b32 s26, s20, 1
    s_add_u32 s26, s26, s31
    s_mul_i32 s26, s26, 276480
    s_and_b32 s24, s20, 1
    s_lshl_b32 s24, s24, 11
    s_add_u32 s26, s26, s24
    s_add_u32 s26, s26, 4194304
    s_add_u32 s43, s42, 40960
    s_add_u32 s45, s44, 40960
    s_add_u32 s46, s45, 40960
    s_add_u32 s47, s46, 40960
    s_add_u32 s48, s47, 40960
    s_mul_i32 s24, s28, 3
    s_add_u32 s24, s24, 0
    s_and_b32 s29, s24, 1
    s_lshl_b32 s29, s29, 9
    s_lshr_b32 s24, s24, 1
    s_mul_i32 s24, s24, 5120
    s_add_u32 s24, s24, s29
    s_add_u32 s49, s24, s26
    s_mul_i32 s24, s28, 3
    s_add_u32 s24, s24, 1
    s_and_b32 s29, s24, 1
    s_lshl_b32 s29, s29, 9
    s_lshr_b32 s24, s24, 1
    s_mul_i32 s24, s24, 5120
    s_add_u32 s24, s24, s29
    s_add_u32 s50, s24, s26
    s_mul_i32 s24, s28, 3
    s_add_u32 s24, s24, 2
    s_and_b32 s29, s24, 1
    s_lshl_b32 s29, s29, 9
    s_lshr_b32 s24, s24, 1
    s_mul_i32 s24, s24, 5120
    s_add_u32 s24, s24, s29
    s_add_u32 s51, s24, s26
    s_lshl_b32 s24, s28, 1
    s_add_u32 s24, s24, 48
    s_and_b32 s29, s24, 1
    s_lshl_b32 s29, s29, 9
    s_lshr_b32 s24, s24, 1
    s_mul_i32 s24, s24, 5120
    s_add_u32 s24, s24, s29
    s_add_u32 s52, s24, s26
    s_lshl_b32 s24, s28, 1
    s_add_u32 s24, s24, 49
    s_and_b32 s29, s24, 1
    s_lshl_b32 s29, s29, 9
    s_lshr_b32 s24, s24, 1
    s_mul_i32 s24, s24, 5120
    s_add_u32 s24, s24, s29
    s_add_u32 s53, s24, s26
    s_add_u32 s24, s30, 80
    s_and_b32 s29, s24, 1
    s_lshl_b32 s29, s29, 9
    s_lshr_b32 s24, s24, 1
    s_mul_i32 s24, s24, 5120
    s_add_u32 s24, s24, s29
    s_add_u32 s54, s24, s26
    s_add_u32 s24, s30, 81
    s_and_b32 s29, s24, 1
    s_lshl_b32 s29, s29, 9
    s_lshr_b32 s24, s24, 1
    s_mul_i32 s24, s24, 5120
    s_add_u32 s24, s24, s29
    s_add_u32 s55, s24, s26
    s_cmp_ge_u32 s28, 12
    s_cselect_b32 s48, 134217728, s48
    s_cselect_b32 s55, 134217728, s55
    s_mul_i32 s24, s25, 43
    s_lshr_b32 s24, s24, 8
    s_mul_i32 s24, s24, 6
    s_sub_u32 s24, s25, s24
    s_mul_i32 s26, s20, 6
    s_add_u32 s29, s24, s26
    s_mul_i32 s56, s29, 5120
    s_add_u32 s24, s24, 1
    s_cmp_eq_u32 s24, 6
    s_cselect_b32 s24, 0, s24
    s_add_u32 s29, s24, s26
    s_mul_i32 s57, s29, 5120
    s_add_u32 s24, s24, 1
    s_cmp_eq_u32 s24, 6
    s_cselect_b32 s24, 0, s24
    s_add_u32 s29, s24, s26
    s_mul_i32 s58, s29, 5120
    s_add_u32 s24, s24, 1
    s_cmp_eq_u32 s24, 6
    s_cselect_b32 s24, 0, s24
    s_add_u32 s29, s24, s26
    s_mul_i32 s59, s29, 5120
    s_add_u32 s24, s24, 1
    s_cmp_eq_u32 s24, 6
    s_cselect_b32 s24, 0, s24
    s_add_u32 s29, s24, s26
    s_mul_i32 s60, s29, 5120
    s_add_u32 s24, s24, 1
    s_cmp_eq_u32 s24, 6
    s_cselect_b32 s24, 0, s24
    s_add_u32 s29, s24, s26
    s_mul_i32 s61, s29, 5120
    s_add_u32 s24, s24, 1
    s_cmp_eq_u32 s24, 6
    s_cselect_b32 s24, 0, s24
    s_lshl_b32 s26, s20, 2
    s_add_u32 s26, s26, 24
    s_add_u32 s24, s25, 0
    s_and_b32 s24, s24, 3
    s_add_u32 s24, s24, s26
    s_mul_i32 s62, s24, 5120
    s_add_u32 s24, s25, 1
    s_and_b32 s24, s24, 3
    s_add_u32 s24, s24, s26
    s_mul_i32 s63, s24, 5120
    s_add_u32 s24, s25, 2
    s_and_b32 s24, s24, 3
    s_add_u32 s24, s24, s26
    s_mul_i32 s64, s24, 5120
    s_add_u32 s24, s25, 3
    s_and_b32 s24, s24, 3
    s_add_u32 s24, s24, s26
    s_mul_i32 s65, s24, 5120
    s_lshl_b32 s24, s20, 2
    s_min_u32 s24, s24, 11
    s_add_u32 s24, s24, 40
    s_mul_i32 s66, s24, 5120
    s_add_u32 s67, s66, 5120
    s_add_u32 s68, s67, 5120
    s_add_u32 s69, s68, 5120
    s_cmp_ge_u32 s20, 2
    s_cselect_b32 s69, 134217728, s69
    buffer_load_dwordx2 v[30:31], v17, s[16:19], 0 offen offset:0
    buffer_load_dwordx2 v[32:33], v17, s[16:19], 0 offen offset:32
    buffer_load_dwordx2 v[34:35], v17, s[16:19], 0 offen offset:64
    buffer_load_dwordx2 v[36:37], v17, s[16:19], 0 offen offset:96
    buffer_load_dwordx2 v[38:39], v17, s[16:19], 0 offen offset:128
    s_cmp_eq_u32 s80, 4096
    s_cbranch_scc1 L_now2_54
    s_mov_b32 s25, s80
    s_lshr_b32 s26, s25, 1
    s_and_b32 s27, s25, 1
    s_cmp_lt_u32 s25, 32
    s_cbranch_scc1 L_w2_60
    s_sub_u32 s27, s25, 32
    s_cmp_lt_u32 s27, 60
    s_cbranch_scc0 L_w2_59
    s_mul_i32 s26, s27, 13108
    s_lshr_b32 s26, s26, 16
    s_mul_i32 s30, s26, 5
    s_sub_u32 s27, s27, s30
    s_add_u32 s27, s27, 2
    s_branch L_w2_60
L_w2_59:
    s_sub_u32 s27, s27, 60
    s_lshr_b32 s26, s27, 2
    s_add_u32 s26, s26, 12
    s_and_b32 s27, s27, 3
    s_add_u32 s27, s27, 2
L_w2_60:
    s_lshl_b32 s30, s26, 1
    s_add_u32 s31, s26, 12
    s_min_u32 s31, s31, s30
    s_add_u32 s31, s31, 75
    s_add_u32 s30, s30, 45
    s_cmp_lt_u32 s27, 5
    s_cselect_b32 s30, s30, s31
    s_mul_i32 s31, s26, 3
    s_cmp_lt_u32 s27, 3
    s_cselect_b32 s30, s31, s30
    s_add_u32 s30, s30, s27
    s_lshr_b32 s31, s30, 1
    s_mul_i32 s31, s31, 5120
    s_and_b32 s30, s30, 1
    s_lshl_b32 s30, s30, 9
    s_add_u32 s30, s30, s31
    s_add_u32 s30, s30, 14680064
    s_mul_i32 s31, s20, 552960
    s_add_u32 s30, s30, s31
    s_waitcnt vmcnt(14)
    ds_write_b128 v107, v[120:123]
    s_waitcnt vmcnt(13)
    ds_write_b128 v108, v[124:127]
    s_waitcnt vmcnt(12)
    ds_write_b128 v109, v[128:131]
    s_waitcnt vmcnt(11)
    ds_write_b128 v110, v[132:135]
    s_waitcnt vmcnt(10)
    ds_write_b128 v111, v[136:139]
    s_waitcnt lgkmcnt(0)
    ds_read_b64_tr_b16 v[56:57], v112 offset:0
    ds_read_b64_tr_b16 v[58:59], v112 offset:2816
    ds_read_b64_tr_b16 v[60:61], v112 offset:64
    ds_read_b64_tr_b16 v[62:63], v112 offset:2880
    ds_read_b64_tr_b16 v[64:65], v112 offset:128
    ds_read_b64_tr_b16 v[66:67], v112 offset:2944
    ds_read_b64_tr_b16 v[68:69], v112 offset:192
    ds_read_b64_tr_b16 v[70:71], v112 offset:3008
    ds_read_b64_tr_b16 v[72:73], v112 offset:256
    ds_read_b64_tr_b16 v[74:75], v112 offset:3072
    s_add_u32 s31, s30, 0
    s_waitcnt lgkmcnt(8)
    buffer_store_dwordx4 v[56:59], v113, s[4:7], s31 offen sc1
    s_add_u32 s31, s30, 2048
    s_waitcnt lgkmcnt(6)
    buffer_store_dwordx4 v[60:63], v113, s[4:7], s31 offen sc1
    s_add_u32 s31, s30, 4096
    s_waitcnt lgkmcnt(4)
    buffer_store_dwordx4 v[64:67], v114, s[4:7], s31 offen sc1
    s_add_u32 s31, s30, 277504
    s_waitcnt lgkmcnt(2)
    buffer_store_dwordx4 v[68:71], v113, s[4:7], s31 offen sc1
    s_add_u32 s31, s30, 279552
    s_waitcnt lgkmcnt(0)
    buffer_store_dwordx4 v[72:75], v113, s[4:7], s31 offen sc1
    s_cmp_eq_u32 s81, 4096
    s_cbranch_scc1 L_w2b_58
    s_mov_b32 s25, s81
    s_lshr_b32 s26, s25, 1
    s_and_b32 s27, s25, 1
    s_cmp_lt_u32 s25, 32
    s_cbranch_scc1 L_w2_63
    s_sub_u32 s27, s25, 32
    s_cmp_lt_u32 s27, 60
    s_cbranch_scc0 L_w2_62
    s_mul_i32 s26, s27, 13108
    s_lshr_b32 s26, s26, 16
    s_mul_i32 s30, s26, 5
    s_sub_u32 s27, s27, s30
    s_add_u32 s27, s27, 2
    s_branch L_w2_63
L_w2_62:
    s_sub_u32 s27, s27, 60
    s_lshr_b32 s26, s27, 2
    s_add_u32 s26, s26, 12
    s_and_b32 s27, s27, 3
    s_add_u32 s27, s27, 2
L_w2_63:
    s_lshl_b32 s30, s26, 1
    s_add_u32 s31, s26, 12
    s_min_u32 s31, s31, s30
    s_add_u32 s31, s31, 75
    s_add_u32 s30, s30, 45
    s_cmp_lt_u32 s27, 5
    s_cselect_b32 s30, s30, s31
    s_mul_i32 s31, s26, 3
    s_cmp_lt_u32 s27, 3
    s_cselect_b32 s30, s31, s30
    s_add_u32 s30, s30, s27
    s_lshr_b32 s31, s30, 1
    s_mul_i32 s31, s31, 5120
    s_and_b32 s30, s30, 1
    s_lshl_b32 s30, s30, 9
    s_add_u32 s30, s30, s31
    s_add_u32 s30, s30, 14680064
    s_mul_i32 s31, s20, 552960
    s_add_u32 s30, s30, s31
    s_waitcnt vmcnt(14)
    ds_write_b128 v107, v[140:143]
    s_waitcnt vmcnt(13)
    ds_write_b128 v108, v[144:147]
    s_waitcnt vmcnt(12)
    ds_write_b128 v109, v[148:151]
    s_waitcnt vmcnt(11)
    ds_write_b128 v110, v[152:155]
    s_waitcnt vmcnt(10)
    ds_write_b128 v111, v[156:159]
    s_waitcnt lgkmcnt(0)
    ds_read_b64_tr_b16 v[56:57], v112 offset:0
    ds_read_b64_tr_b16 v[58:59], v112 offset:2816
    ds_read_b64_tr_b16 v[60:61], v112 offset:64
    ds_read_b64_tr_b16 v[62:63], v112 offset:2880
    ds_read_b64_tr_b16 v[64:65], v112 offset:128
    ds_read_b64_tr_b16 v[66:67], v112 offset:2944
    ds_read_b64_tr_b16 v[68:69], v112 offset:192
    ds_read_b64_tr_b16 v[70:71], v112 offset:3008
    ds_read_b64_tr_b16 v[72:73], v112 offset:256
    ds_read_b64_tr_b16 v[74:75], v112 offset:3072
    s_add_u32 s31, s30, 0
    s_waitcnt lgkmcnt(8)
    buffer_store_dwordx4 v[56:59], v113, s[4:7], s31 offen sc1
    s_add_u32 s31, s30, 2048
    s_waitcnt lgkmcnt(6)
    buffer_store_dwordx4 v[60:63], v113, s[4:7], s31 offen sc1
    s_add_u32 s31, s30, 4096
    s_waitcnt lgkmcnt(4)
    buffer_store_dwordx4 v[64:67], v114, s[4:7], s31 offen sc1
    s_add_u32 s31, s30, 277504
    s_waitcnt lgkmcnt(2)
    buffer_store_dwordx4 v[68:71], v113, s[4:7], s31 offen sc1
    s_add_u32 s31, s30, 279552
    s_waitcnt lgkmcnt(0)
    buffer_store_dwordx4 v[72:75], v113, s[4:7], s31 offen sc1
L_w2b_58:
    s_waitcnt vmcnt(0)
    v_mov_b32 v18, 1
    v_mul_u32_u24 v6, 256, v1
    s_mov_b32 s25, 19937280
    s_barrier
    s_cmp_lg_u32 s20, 0
    s_cbranch_scc1 L_sig_65
    s_mov_b64 exec, 255
    buffer_atomic_add v18, v6, s[4:7], s25 offen offset:0 sc1
    s_mov_b64 exec, -1
L_sig_65:
L_now2_54:
    v_mov_b32 v18, 1
    s_cmp_lg_u32 s20, 0
    s_cbranch_scc1 L_got_66
    s_movk_i32 s79, 30000
L_spin_67:
    buffer_load_dword v19, off, s[4:7], s3 offset:0 sc1
    s_waitcnt vmcnt(0)
    v_readfirstlane_b32 s24, v19
    s_cmp_ge_u32 s24, 96
    s_cbranch_scc1 L_got_66
    s_sleep 1
    s_sub_u32 s79, s79, 1
    s_cbranch_scc0 L_spin_67
    s_branch L_got_66
L_got_66:
    s_barrier
    v_and_b32 v44, 15, v1
    v_lshlrev_b32 v44, 3, v44
    buffer_load_dwordx2 v[44:45], v44, s[4:7], s71 offen sc1
    s_cmp_ge_u32 s20, 2
    s_cbranch_scc1 L_ex_68
    s_sub_u32 m0, s75, 90112
    s_nop 0
    buffer_load_dwordx4 v3, s[4:7], s77 offen sc1 lds
L_ex_68:
    s_add_u32 m0, s75, 4294885376
    s_add_u32 s29, s42, s32
    buffer_load_dwordx4 v3, s[4:7], s29 offen sc1 lds
    s_add_u32 m0, s75, 4294889472
    s_add_u32 s29, s43, s32
    buffer_load_dwordx4 v3, s[4:7], s29 offen sc1 lds
    s_add_u32 m0, s75, 4294893568
    s_add_u32 s29, s42, s33
    buffer_load_dwordx4 v3, s[4:7], s29 offen sc1 lds
    s_add_u32 m0, s75, 4294897664
    s_add_u32 s29, s43, s33
    buffer_load_dwordx4 v3, s[4:7], s29 offen sc1 lds
    s_add_u32 m0, s75, 4294901760
    s_add_u32 s29, s42, s34
    buffer_load_dwordx4 v3, s[4:7], s29 offen sc1 lds
    s_add_u32 m0, s75, 4294905856
    s_add_u32 s29, s43, s34
    buffer_load_dwordx4 v3, s[4:7], s29 offen sc1 lds
    s_add_u32 m0, s75, 4294909952
    s_add_u32 s29, s42, s35
    buffer_load_dwordx4 v3, s[4:7], s29 offen sc1 lds
    s_add_u32 m0, s75, 4294914048
    s_add_u32 s29, s43, s35
    buffer_load_dwordx4 v3, s[4:7], s29 offen sc1 lds
    s_add_u32 m0, s75, 4294918144
    s_add_u32 s29, s42, s36
    buffer_load_dwordx4 v3, s[4:7], s29 offen sc1 lds
    s_add_u32 m0, s75, 4294922240
    s_add_u32 s29, s43, s36
    buffer_load_dwordx4 v3, s[4:7], s29 offen sc1 lds
    s_add_u32 m0, s75, 4294926336
    s_add_u32 s29, s42, s37
    buffer_load_dwordx4 v3, s[4:7], s29 offen sc1 lds
    s_add_u32 m0, s75, 4294930432
    s_add_u32 s29, s43, s37
    buffer_load_dwordx4 v3, s[4:7], s29 offen sc1 lds
    s_add_u32 m0, s75, 4294934528
    s_add_u32 s29, s42, s38
    buffer_load_dwordx4 v3, s[4:7], s29 offen sc1 lds
    s_add_u32 m0, s75, 4294938624
    s_add_u32 s29, s43, s38
    buffer_load_dwordx4 v3, s[4:7], s29 offen sc1 lds
    s_add_u32 m0, s75, 4294942720
    s_add_u32 s29, s42, s39
    buffer_load_dwordx4 v3, s[4:7], s29 offen sc1 lds
    s_add_u32 m0, s75, 4294946816
    s_add_u32 s29, s43, s39
    buffer_load_dwordx4 v3, s[4:7], s29 offen sc1 lds
    s_add_u32 m0, s75, 4294950912
    s_add_u32 s29, s42, s40
    buffer_load_dwordx4 v3, s[4:7], s29 offen sc1 lds
    s_add_u32 m0, s75, 4294955008
    s_add_u32 s29, s43, s40
    buffer_load_dwordx4 v3, s[4:7], s29 offen sc1 lds
    s_add_u32 m0, s75, 4294959104
    s_add_u32 s29, s42, s41
    buffer_load_dwordx4 v3, s[4:7], s29 offen sc1 lds
    s_add_u32 m0, s75, 4294963200
    s_add_u32 s29, s43, s41
    buffer_load_dwordx4 v3, s[4:7], s29 offen sc1 lds
    s_waitcnt vmcnt(0)
    s_branch L_ywait
L_code_end:
.section .rodata,"a"
.p2align 6
.amdhsa_kernel interleave_layers__ssm_conv_h3__glu_gated_geglu__prompt_kernel
  .amdhsa_next_free_vgpr 512
  .amdhsa_next_free_sgpr 102
  .amdhsa_accum_offset 256
  .amdhsa_group_segment_fixed_size 0
  .amdhsa_kernarg_size 104
  .amdhsa_user_sgpr_count 2
  .amdhsa_user_sgpr_kernarg_segment_ptr 1
  .amdhsa_system_sgpr_workgroup_id_x 1
  .amdhsa_float_denorm_mode_32 3
.end_amdhsa_kernel
```
